```python
import torch

def _softmax(x, axis=-1):
    return torch.softmax(x, dim=axis)
def _gelu(x):
    return torch.nn.functional.gelu(x, approximate="tanh")
def _silu(x):
    return torch.nn.functional.silu(x)
def _sigmoid(x):
    return torch.sigmoid(x)
def _layernorm(x, axis=-1, eps=1e-5):
    m = x.mean(dim=axis, keepdim=True)
    v = x.var(dim=axis, keepdim=True, unbiased=False)
    return (x - m) / torch.sqrt(v + eps)
def _scatter_add(tgt, idx, src, axis=0):
    return tgt.clone().index_add_(axis, idx, src)
def _segment_sum(src, seg, n):
    out = torch.zeros((n,) + src.shape[1:], dtype=src.dtype)
    return out.index_add_(0, seg, src)
def _pad(x, pw):
    flat = tuple(v for pair in reversed(pw) for v in pair)
    return torch.nn.functional.pad(x, flat)

kernel_name = 'recurrent_scan__mha_block__swiglu_ffn__prompt'

def setup_inputs():

    _w = (lambda a: (lambda t: t.to(torch.bfloat16) if t.is_floating_point() else t)(torch.as_tensor(a)))
    def _A_setup():
        B, S, D, H = 1, 2048, 512, 32
        return {
            "x": _w((lambda *s: torch.randn(*s, dtype=torch.bfloat16) * 0.05)(B, S, D)),
            "wqkv": _w((lambda *s: torch.randn(*s, dtype=torch.bfloat16) * 0.05)(D, 3 * D)),
            "wo": _w((lambda *s: torch.randn(*s, dtype=torch.bfloat16) * 0.05)(D, D)),
        }
    _A_in = _A_setup()

    def _B_setup():
        B, S, D, F = 1, 2048, 512, 1792
        return {
            "x": _w((lambda *s: torch.randn(*s, dtype=torch.bfloat16) * 0.05)(B, S, D)),
            "w_gate": _w((lambda *s: torch.randn(*s, dtype=torch.bfloat16) * 0.05)(D, F)),
            "w_up": _w((lambda *s: torch.randn(*s, dtype=torch.bfloat16) * 0.05)(D, F)),
            "w_down": _w((lambda *s: torch.randn(*s, dtype=torch.bfloat16) * 0.05)(F, D)),
        }
    _B_in = _B_setup()

    return {
        "A_x": _A_in["x"],
        "A_wqkv": _A_in["wqkv"],
        "A_wo": _A_in["wo"],
        "B_x": _B_in["x"],
        "B_w_gate": _B_in["w_gate"],
        "B_w_up": _B_in["w_up"],
        "B_w_down": _B_in["w_down"],
    }

def reference(A_x, A_wqkv, A_wo, B_x, B_w_gate, B_w_up, B_w_down):
    def _A_ref(x, wqkv, wo):
        B, S, D = x.shape
        H = 32
        Dh = D // H
        qkv = (lambda x, *d: x.permute(*d))((x @ wqkv).reshape(B, S, 3, H, Dh), 2, 0, 3, 1, 4)
        q, k, v = qkv[0], qkv[1], qkv[2]
        scores = torch.einsum("bhqd,bhkd->bhqk", q, k) * (Dh ** -0.5)
        p = _softmax(scores, axis=-1)
        o = torch.einsum("bhqk,bhkd->bhqd", p, v)
        return (lambda x, *d: x.permute(*d))(o, 0, 2, 1, 3).reshape(B, S, D) @ wo

    def _B_ref(x, w_gate, w_up, w_down):
        g = _silu(x @ w_gate)
        u = x @ w_up
        return (g * u) @ w_down

    x = A_x
    xn = _layernorm(x, axis=-1)
    s = _A_ref(xn, A_wqkv, A_wo)
    g = _silu(_B_ref(xn, B_w_gate, B_w_up, B_w_down))
    return x + s * g
```

```asm
; @launch grid=(256,1,1) block=(512,1,1) lds=162304
.amdgcn_target "amdgcn-amd-amdhsa--gfx950"
.text
.globl recurrent_scan__mha_block__swiglu_ffn__prompt_kernel
.p2align 8
.type recurrent_scan__mha_block__swiglu_ffn__prompt_kernel,@function
recurrent_scan__mha_block__swiglu_ffn__prompt_kernel:
  s_cmp_ge_u32 s2, 256
  s_cbranch_scc1 L_k1_end
  s_load_dwordx4 s[56:59], s[0:1], 0
  s_load_dwordx4 s[64:67], s[0:1], 32
  s_load_dwordx2 s[70:71], s[0:1], 72
  s_load_dwordx2 s[60:61], s[0:1], 16
  s_load_dwordx2 s[68:69], s[0:1], 48
  s_load_dwordx2 s[4:5], s[0:1], 64
  v_lshrrev_b32 v2, 6, v0
  v_and_b32 v1, 63, v0
  v_readfirstlane_b32 s28, v2
  v_lshlrev_b32 v14, 4, v1
  s_and_b32 s40, s2, 7
  s_lshr_b32 s41, s2, 3
  s_and_b32 s42, s40, 1
  s_lshl_b32 s42, s42, 2
  s_and_b32 s43, s41, 3
  s_add_u32 s29, s42, s43
  s_lshr_b32 s42, s40, 1
  s_sub_u32 s42, 3, s42
  s_lshl_b32 s42, s42, 3
  s_lshr_b32 s43, s41, 2
  s_sub_u32 s43, 7, s43
  s_add_u32 s30, s42, s43
  s_cmp_ge_u32 s30, 24
  s_cselect_b32 s31, 1, 0
  s_and_b32 s32, s28, 3
  s_cmp_ge_u32 s28, 4
  s_cbranch_scc0 L_k1_cons
  v_lshrrev_b32 v2, 3, v1
  v_lshlrev_b32 v2, 10, v2
  v_and_b32 v3, 7, v1
  v_lshrrev_b32 v4, 4, v1
  v_xor_b32 v5, v3, v4
  v_xor_b32 v6, 4, v5
  v_lshlrev_b32 v5, 4, v5
  v_lshlrev_b32 v6, 4, v6
  v_add_u32 v16, v2, v5
  v_add_u32 v6, v2, v6
  v_add_u32 v17, 7168, v6
  v_add_u32 v18, 14336, v16
  v_add_u32 v19, 21504, v6
  s_lshl_b32 s42, s29, 2
  s_add_u32 s42, s42, s32
  s_lshl_b32 s48, s42, 16
  s_lshl_b32 s62, s32, 13
  s_waitcnt lgkmcnt(0)
  s_mov_b32 s8, s56
  s_mov_b32 s9, s57
  s_mov_b32 s10, 2097152
  s_mov_b32 s11, 0x20000
  s_add_u32 m0, s62, 0
  s_add_u32 s42, s48, 0
  buffer_load_dwordx4 v16, s[8:11], s42 offen offset:0 lds
  buffer_load_dwordx4 v17, s[8:11], s42 offen offset:1024 lds
  buffer_load_dwordx4 v18, s[8:11], s42 offen offset:2048 lds
  buffer_load_dwordx4 v19, s[8:11], s42 offen offset:3072 lds
  s_add_u32 m0, s62, 4096
  s_add_u32 s42, s48, 32768
  buffer_load_dwordx4 v16, s[8:11], s42 offen offset:0 lds
  buffer_load_dwordx4 v17, s[8:11], s42 offen offset:1024 lds
  buffer_load_dwordx4 v18, s[8:11], s42 offen offset:2048 lds
  buffer_load_dwordx4 v19, s[8:11], s42 offen offset:3072 lds
  v_lshrrev_b32 v2, 2, v1
  v_and_b32 v3, 3, v1
  v_lshlrev_b32 v3, 4, v3
  v_mul_u32_u24 v4, 3072, v2
  v_add_u32 v21, v4, v3
  v_mul_u32_u24 v5, 3584, v2
  v_add_u32 v20, v5, v3
  v_mov_b32 v6, s31
  v_cmp_eq_u32 vcc, 1, v6
  s_nop 1
  v_cndmask_b32 v13, v20, v21, vcc
  s_mov_b32 s38, 229376
  s_lshl_b32 s46, s32, 4
  s_mul_i32 s47, s46, 3584
  s_lshl_b32 s42, s30, 7
  s_add_u32 s43, s30, 24
  s_lshl_b32 s43, s43, 6
  s_cmp_eq_u32 s31, 1
  s_cselect_b32 s43, s43, s42
  s_add_u32 s49, s47, s43
  s_mul_i32 s47, s46, 3072
  s_sub_u32 s42, s30, 24
  s_lshl_b32 s42, s42, 7
  s_add_u32 s42, s42, 2048
  s_add_u32 s50, s47, s42
  s_mul_i32 s47, s46, 3072
  s_lshl_b32 s42, s30, 6
  s_add_u32 s51, s47, s42
  s_lshl_b32 s42, s32, 10
  s_add_u32 s63, s42, 32768
  s_mov_b32 s39, 0
  s_mov_b32 s24, s58
  s_mov_b32 s25, s59
  s_mov_b32 s26, 1572864
  s_mov_b32 s27, 0x20000
  s_mov_b32 s12, s64
  s_mov_b32 s13, s65
  s_mov_b32 s14, 1835008
  s_mov_b32 s15, 0x20000
  s_mov_b32 s16, s66
  s_mov_b32 s17, s67
  s_mov_b32 s18, 1835008
  s_mov_b32 s19, 0x20000
  s_mov_b32 s42, 1835008
  s_cmp_eq_u32 s31, 1
  s_cselect_b32 s72, s58, s64
  s_cselect_b32 s73, s59, s65
  s_cselect_b32 s74, 1572864, s42
  s_mov_b32 s75, 0x20000
  s_cselect_b32 s52, s58, s66
  s_cselect_b32 s53, s59, s67
  s_cselect_b32 s54, 1572864, s42
  s_mov_b32 s55, 0x20000
  s_lshl_b32 s42, s39, 7
  s_add_u32 s34, s48, s42
  s_mul_i32 s42, s39, s38
  s_add_u32 s35, s49, s42
  s_mul_i32 s42, s39, 196608
  s_add_u32 s37, s51, s42
  s_add_u32 s36, s50, s42
  s_add_u32 s43, s35, 64
  s_cmp_eq_u32 s31, 1
  s_cselect_b32 s36, s36, s43
  s_add_u32 s44, s36, 64
  s_cmp_eq_u32 s31, 1
  s_cselect_b32 s44, s44, s36
  s_add_u32 s39, s39, 1
  s_and_b32 s39, s39, 7
  s_add_u32 m0, s63, 0
  s_nop 0
  buffer_load_dwordx4 v20, s[12:15], s35 offen lds
  s_add_u32 m0, s63, 8192
  s_nop 0
  buffer_load_dwordx4 v13, s[72:75], s36 offen lds
  s_add_u32 m0, s63, 4096
  s_nop 0
  buffer_load_dwordx4 v20, s[16:19], s35 offen lds
  s_add_u32 m0, s63, 12288
  s_nop 0
  buffer_load_dwordx4 v13, s[52:55], s44 offen lds
  s_add_u32 m0, s63, 16384
  s_nop 0
  buffer_load_dwordx4 v21, s[24:27], s37 offen lds
  s_lshl_b32 s42, s39, 7
  s_add_u32 s34, s48, s42
  s_mul_i32 s42, s39, s38
  s_add_u32 s35, s49, s42
  s_mul_i32 s42, s39, 196608
  s_add_u32 s37, s51, s42
  s_add_u32 s36, s50, s42
  s_add_u32 s43, s35, 64
  s_cmp_eq_u32 s31, 1
  s_cselect_b32 s36, s36, s43
  s_add_u32 s44, s36, 64
  s_cmp_eq_u32 s31, 1
  s_cselect_b32 s44, s44, s36
  s_add_u32 s39, s39, 1
  s_and_b32 s39, s39, 7
  s_add_u32 m0, s63, 53248
  s_nop 0
  buffer_load_dwordx4 v20, s[12:15], s35 offen lds
  s_add_u32 m0, s63, 61440
  s_nop 0
  buffer_load_dwordx4 v13, s[72:75], s36 offen lds
  s_add_u32 m0, s63, 57344
  s_nop 0
  buffer_load_dwordx4 v20, s[16:19], s35 offen lds
  s_add_u32 m0, s63, 65536
  s_nop 0
  buffer_load_dwordx4 v13, s[52:55], s44 offen lds
  s_add_u32 m0, s63, 69632
  s_nop 0
  buffer_load_dwordx4 v21, s[24:27], s37 offen lds
  s_add_u32 m0, s62, 53248
  s_add_u32 s42, s34, 0
  buffer_load_dwordx4 v16, s[8:11], s42 offen offset:0 lds
  buffer_load_dwordx4 v17, s[8:11], s42 offen offset:1024 lds
  buffer_load_dwordx4 v18, s[8:11], s42 offen offset:2048 lds
  buffer_load_dwordx4 v19, s[8:11], s42 offen offset:3072 lds
  s_add_u32 m0, s62, 57344
  s_add_u32 s42, s34, 32768
  buffer_load_dwordx4 v16, s[8:11], s42 offen offset:0 lds
  buffer_load_dwordx4 v17, s[8:11], s42 offen offset:1024 lds
  buffer_load_dwordx4 v18, s[8:11], s42 offen offset:2048 lds
  buffer_load_dwordx4 v19, s[8:11], s42 offen offset:3072 lds
  s_waitcnt vmcnt(13)
  s_barrier
  s_mov_b32 s20, s70
  s_mov_b32 s21, s71
  s_mov_b32 s22, 21495808
  s_mov_b32 s23, 0x20000
  s_mov_b32 s6, 256
  s_mov_b32 s7, 0x20000
  v_lshrrev_b32 v3, 5, v1
  v_and_b32 v2, 15, v1
  v_lshrrev_b32 v4, 2, v2
  v_lshl_add_u32 v4, v3, 3, v4
  v_lshlrev_b32 v4, 6, v4
  v_and_b32 v5, 3, v2
  v_lshl_add_u32 v4, v5, 3, v4
  v_bfe_u32 v5, v1, 4, 1
  v_lshl_add_u32 v4, v5, 5, v4
  v_add_u32 v22, s63, v4
  v_add_u32 v23, 53248, v22
  v_add_u32 v15, 106496, v22
  v_mov_b32 v52, 0
  v_mov_b32 v53, 0
  v_mov_b32 v54, 0
  v_mov_b32 v55, 0
  v_mov_b32 v56, 0
  s_cmp_eq_u32 s32, 0
  s_cbranch_scc0 L_k1_flg_9
  v_mov_b32 v4, 0
  v_mov_b32 v5, 0
  v_mov_b32 v6, 0
  v_mov_b32 v7, 0
  s_lshr_b32 s42, s2, 5
  s_lshl_b32 s42, s42, 8
  s_and_b32 s43, s2, 31
  s_add_u32 s42, s42, s43
  s_lshl_b32 s42, s42, 7
  s_add_u32 s42, s42, 21233664
  v_lshrrev_b32 v2, 3, v1
  v_lshlrev_b32 v2, 12, v2
  v_and_b32 v3, 7, v1
  v_lshl_add_u32 v2, v3, 4, v2
  buffer_store_dwordx4 v[4:7], v2, s[20:23], s42 offen sc1
  s_lshl_b32 s42, s29, 5
  s_add_u32 s42, s42, s30
  s_lshl_b32 s42, s42, 7
  s_add_u32 s42, s42, 21102592
  v_lshlrev_b32 v3, 4, v3
  v_mov_b32 v2, 0x7ffffff0
  v_cmp_gt_u32 vcc, 8, v1
  s_nop 1
  v_cndmask_b32 v2, v2, v3, vcc
  buffer_store_dwordx4 v[4:7], v2, s[20:23], s42 offen sc1
  s_cmp_lt_u32 s2, 8
  s_cbranch_scc0 L_k1_z8_10
  s_lshl_b32 s42, s2, 7
  s_add_u32 s42, s42, 21135360
  buffer_store_dwordx4 v[4:7], v2, s[20:23], s42 offen sc1
L_k1_z8_10:
L_k1_flg_9:
  ds_read_b64_tr_b16 v[32:33], v22 offset:0
  ds_read_b64_tr_b16 v[34:35], v22 offset:256
  ds_read_b64_tr_b16 v[36:37], v22 offset:4096
  ds_read_b64_tr_b16 v[38:39], v22 offset:4352
  ds_read_b64_tr_b16 v[40:41], v22 offset:8192
  ds_read_b64_tr_b16 v[42:43], v22 offset:8448
  ds_read_b64_tr_b16 v[44:45], v22 offset:12288
  ds_read_b64_tr_b16 v[46:47], v22 offset:12544
  ds_read_b64_tr_b16 v[48:49], v22 offset:16384
  ds_read_b64_tr_b16 v[50:51], v22 offset:16640
  s_lshl_b32 s42, s39, 7
  s_add_u32 s34, s48, s42
  s_mul_i32 s42, s39, s38
  s_add_u32 s35, s49, s42
  s_mul_i32 s42, s39, 196608
  s_add_u32 s37, s51, s42
  s_add_u32 s36, s50, s42
  s_add_u32 s43, s35, 64
  s_cmp_eq_u32 s31, 1
  s_cselect_b32 s36, s36, s43
  s_add_u32 s44, s36, 64
  s_cmp_eq_u32 s31, 1
  s_cselect_b32 s44, s44, s36
  s_add_u32 s39, s39, 1
  s_and_b32 s39, s39, 7
  s_add_u32 m0, s63, 106496
  s_nop 0
  buffer_load_dwordx4 v20, s[12:15], s35 offen lds
  s_waitcnt lgkmcnt(0)
  v_lshlrev_b32 v58, 16, v32
  v_and_b32 v59, 0xffff0000, v32
  v_lshlrev_b32 v60, 16, v36
  v_and_b32 v61, 0xffff0000, v36
  v_lshlrev_b32 v62, 16, v40
  v_and_b32 v63, 0xffff0000, v40
  s_add_u32 m0, s63, 114688
  s_nop 0
  buffer_load_dwordx4 v13, s[72:75], s36 offen lds
  v_lshlrev_b32 v64, 16, v44
  v_and_b32 v65, 0xffff0000, v44
  v_lshlrev_b32 v66, 16, v48
  v_and_b32 v67, 0xffff0000, v48
  v_add_f32 v52, v52, v58
  v_add_f32 v53, v53, v60
  v_add_f32 v54, v54, v62
  s_add_u32 m0, s63, 110592
  s_nop 0
  buffer_load_dwordx4 v20, s[16:19], s35 offen lds
  v_add_f32 v55, v55, v64
  v_add_f32 v56, v56, v66
  v_add_f32 v52, v52, v59
  v_add_f32 v53, v53, v61
  v_add_f32 v54, v54, v63
  v_add_f32 v55, v55, v65
  v_add_f32 v56, v56, v67
  s_add_u32 m0, s63, 118784
  s_nop 0
  buffer_load_dwordx4 v13, s[52:55], s44 offen lds
  v_lshlrev_b32 v58, 16, v33
  v_and_b32 v59, 0xffff0000, v33
  v_lshlrev_b32 v60, 16, v37
  v_and_b32 v61, 0xffff0000, v37
  v_lshlrev_b32 v62, 16, v41
  v_and_b32 v63, 0xffff0000, v41
  v_lshlrev_b32 v64, 16, v45
  s_add_u32 m0, s63, 122880
  s_nop 0
  buffer_load_dwordx4 v21, s[24:27], s37 offen lds
  v_and_b32 v65, 0xffff0000, v45
  v_lshlrev_b32 v66, 16, v49
  v_and_b32 v67, 0xffff0000, v49
  v_add_f32 v52, v52, v58
  v_add_f32 v53, v53, v60
  v_add_f32 v54, v54, v62
  v_add_f32 v55, v55, v64
  s_add_u32 m0, s62, 106496
  s_add_u32 s42, s34, 0
  buffer_load_dwordx4 v16, s[8:11], s42 offen offset:0 lds
  v_add_f32 v56, v56, v66
  v_add_f32 v52, v52, v59
  v_add_f32 v53, v53, v61
  v_add_f32 v54, v54, v63
  v_add_f32 v55, v55, v65
  v_add_f32 v56, v56, v67
  v_lshlrev_b32 v58, 16, v34
  buffer_load_dwordx4 v17, s[8:11], s42 offen offset:1024 lds
  v_and_b32 v59, 0xffff0000, v34
  v_lshlrev_b32 v60, 16, v38
  v_and_b32 v61, 0xffff0000, v38
  v_lshlrev_b32 v62, 16, v42
  v_and_b32 v63, 0xffff0000, v42
  v_lshlrev_b32 v64, 16, v46
  v_and_b32 v65, 0xffff0000, v46
  buffer_load_dwordx4 v18, s[8:11], s42 offen offset:2048 lds
  v_lshlrev_b32 v66, 16, v50
  v_and_b32 v67, 0xffff0000, v50
  v_add_f32 v52, v52, v58
  v_add_f32 v53, v53, v60
  v_add_f32 v54, v54, v62
  v_add_f32 v55, v55, v64
  v_add_f32 v56, v56, v66
  buffer_load_dwordx4 v19, s[8:11], s42 offen offset:3072 lds
  v_add_f32 v52, v52, v59
  v_add_f32 v53, v53, v61
  v_add_f32 v54, v54, v63
  v_add_f32 v55, v55, v65
  v_add_f32 v56, v56, v67
  v_lshlrev_b32 v58, 16, v35
  v_and_b32 v59, 0xffff0000, v35
  s_add_u32 m0, s62, 110592
  s_add_u32 s42, s34, 32768
  buffer_load_dwordx4 v16, s[8:11], s42 offen offset:0 lds
  v_lshlrev_b32 v60, 16, v39
  v_and_b32 v61, 0xffff0000, v39
  v_lshlrev_b32 v62, 16, v43
  v_and_b32 v63, 0xffff0000, v43
  v_lshlrev_b32 v64, 16, v47
  v_and_b32 v65, 0xffff0000, v47
  v_lshlrev_b32 v66, 16, v51
  buffer_load_dwordx4 v17, s[8:11], s42 offen offset:1024 lds
  v_and_b32 v67, 0xffff0000, v51
  v_add_f32 v52, v52, v58
  v_add_f32 v53, v53, v60
  v_add_f32 v54, v54, v62
  v_add_f32 v55, v55, v64
  v_add_f32 v56, v56, v66
  v_add_f32 v52, v52, v59
  buffer_load_dwordx4 v18, s[8:11], s42 offen offset:2048 lds
  v_add_f32 v53, v53, v61
  v_add_f32 v54, v54, v63
  v_add_f32 v55, v55, v65
  v_add_f32 v56, v56, v67
  buffer_load_dwordx4 v19, s[8:11], s42 offen offset:3072 lds
  s_waitcnt lgkmcnt(0)
  s_waitcnt vmcnt(13)
  s_barrier
  ds_read_b64_tr_b16 v[32:33], v23 offset:0
  ds_read_b64_tr_b16 v[34:35], v23 offset:256
  ds_read_b64_tr_b16 v[36:37], v23 offset:4096
  ds_read_b64_tr_b16 v[38:39], v23 offset:4352
  ds_read_b64_tr_b16 v[40:41], v23 offset:8192
  ds_read_b64_tr_b16 v[42:43], v23 offset:8448
  ds_read_b64_tr_b16 v[44:45], v23 offset:12288
  ds_read_b64_tr_b16 v[46:47], v23 offset:12544
  ds_read_b64_tr_b16 v[48:49], v23 offset:16384
  ds_read_b64_tr_b16 v[50:51], v23 offset:16640
  s_lshl_b32 s42, s39, 7
  s_add_u32 s34, s48, s42
  s_mul_i32 s42, s39, s38
  s_add_u32 s35, s49, s42
  s_mul_i32 s42, s39, 196608
  s_add_u32 s37, s51, s42
  s_add_u32 s36, s50, s42
  s_add_u32 s43, s35, 64
  s_cmp_eq_u32 s31, 1
  s_cselect_b32 s36, s36, s43
  s_add_u32 s44, s36, 64
  s_cmp_eq_u32 s31, 1
  s_cselect_b32 s44, s44, s36
  s_add_u32 s39, s39, 1
  s_and_b32 s39, s39, 7
  s_add_u32 m0, s63, 0
  s_nop 0
  buffer_load_dwordx4 v20, s[12:15], s35 offen lds
  s_waitcnt lgkmcnt(0)
  v_lshlrev_b32 v58, 16, v32
  v_and_b32 v59, 0xffff0000, v32
  v_lshlrev_b32 v60, 16, v36
  v_and_b32 v61, 0xffff0000, v36
  v_lshlrev_b32 v62, 16, v40
  v_and_b32 v63, 0xffff0000, v40
  s_add_u32 m0, s63, 8192
  s_nop 0
  buffer_load_dwordx4 v13, s[72:75], s36 offen lds
  v_lshlrev_b32 v64, 16, v44
  v_and_b32 v65, 0xffff0000, v44
  v_lshlrev_b32 v66, 16, v48
  v_and_b32 v67, 0xffff0000, v48
  v_add_f32 v52, v52, v58
  v_add_f32 v53, v53, v60
  v_add_f32 v54, v54, v62
  s_add_u32 m0, s63, 4096
  s_nop 0
  buffer_load_dwordx4 v20, s[16:19], s35 offen lds
  v_add_f32 v55, v55, v64
  v_add_f32 v56, v56, v66
  v_add_f32 v52, v52, v59
  v_add_f32 v53, v53, v61
  v_add_f32 v54, v54, v63
  v_add_f32 v55, v55, v65
  v_add_f32 v56, v56, v67
  s_add_u32 m0, s63, 12288
  s_nop 0
  buffer_load_dwordx4 v13, s[52:55], s44 offen lds
  v_lshlrev_b32 v58, 16, v33
  v_and_b32 v59, 0xffff0000, v33
  v_lshlrev_b32 v60, 16, v37
  v_and_b32 v61, 0xffff0000, v37
  v_lshlrev_b32 v62, 16, v41
  v_and_b32 v63, 0xffff0000, v41
  v_lshlrev_b32 v64, 16, v45
  s_add_u32 m0, s63, 16384
  s_nop 0
  buffer_load_dwordx4 v21, s[24:27], s37 offen lds
  v_and_b32 v65, 0xffff0000, v45
  v_lshlrev_b32 v66, 16, v49
  v_and_b32 v67, 0xffff0000, v49
  v_add_f32 v52, v52, v58
  v_add_f32 v53, v53, v60
  v_add_f32 v54, v54, v62
  v_add_f32 v55, v55, v64
  s_add_u32 m0, s62, 0
  s_add_u32 s42, s34, 0
  buffer_load_dwordx4 v16, s[8:11], s42 offen offset:0 lds
  v_add_f32 v56, v56, v66
  v_add_f32 v52, v52, v59
  v_add_f32 v53, v53, v61
  v_add_f32 v54, v54, v63
  v_add_f32 v55, v55, v65
  v_add_f32 v56, v56, v67
  v_lshlrev_b32 v58, 16, v34
  buffer_load_dwordx4 v17, s[8:11], s42 offen offset:1024 lds
  v_and_b32 v59, 0xffff0000, v34
  v_lshlrev_b32 v60, 16, v38
  v_and_b32 v61, 0xffff0000, v38
  v_lshlrev_b32 v62, 16, v42
  v_and_b32 v63, 0xffff0000, v42
  v_lshlrev_b32 v64, 16, v46
  v_and_b32 v65, 0xffff0000, v46
  buffer_load_dwordx4 v18, s[8:11], s42 offen offset:2048 lds
  v_lshlrev_b32 v66, 16, v50
  v_and_b32 v67, 0xffff0000, v50
  v_add_f32 v52, v52, v58
  v_add_f32 v53, v53, v60
  v_add_f32 v54, v54, v62
  v_add_f32 v55, v55, v64
  v_add_f32 v56, v56, v66
  buffer_load_dwordx4 v19, s[8:11], s42 offen offset:3072 lds
  v_add_f32 v52, v52, v59
  v_add_f32 v53, v53, v61
  v_add_f32 v54, v54, v63
  v_add_f32 v55, v55, v65
  v_add_f32 v56, v56, v67
  v_lshlrev_b32 v58, 16, v35
  v_and_b32 v59, 0xffff0000, v35
  s_add_u32 m0, s62, 4096
  s_add_u32 s42, s34, 32768
  buffer_load_dwordx4 v16, s[8:11], s42 offen offset:0 lds
  v_lshlrev_b32 v60, 16, v39
  v_and_b32 v61, 0xffff0000, v39
  v_lshlrev_b32 v62, 16, v43
  v_and_b32 v63, 0xffff0000, v43
  v_lshlrev_b32 v64, 16, v47
  v_and_b32 v65, 0xffff0000, v47
  v_lshlrev_b32 v66, 16, v51
  buffer_load_dwordx4 v17, s[8:11], s42 offen offset:1024 lds
  v_and_b32 v67, 0xffff0000, v51
  v_add_f32 v52, v52, v58
  v_add_f32 v53, v53, v60
  v_add_f32 v54, v54, v62
  v_add_f32 v55, v55, v64
  v_add_f32 v56, v56, v66
  v_add_f32 v52, v52, v59
  buffer_load_dwordx4 v18, s[8:11], s42 offen offset:2048 lds
  v_add_f32 v53, v53, v61
  v_add_f32 v54, v54, v63
  v_add_f32 v55, v55, v65
  v_add_f32 v56, v56, v67
  buffer_load_dwordx4 v19, s[8:11], s42 offen offset:3072 lds
  s_waitcnt lgkmcnt(0)
  s_waitcnt vmcnt(13)
  s_barrier
  ds_read_b64_tr_b16 v[32:33], v15 offset:0
  ds_read_b64_tr_b16 v[34:35], v15 offset:256
  ds_read_b64_tr_b16 v[36:37], v15 offset:4096
  ds_read_b64_tr_b16 v[38:39], v15 offset:4352
  ds_read_b64_tr_b16 v[40:41], v15 offset:8192
  ds_read_b64_tr_b16 v[42:43], v15 offset:8448
  ds_read_b64_tr_b16 v[44:45], v15 offset:12288
  ds_read_b64_tr_b16 v[46:47], v15 offset:12544
  ds_read_b64_tr_b16 v[48:49], v15 offset:16384
  ds_read_b64_tr_b16 v[50:51], v15 offset:16640
  s_lshl_b32 s42, s39, 7
  s_add_u32 s34, s48, s42
  s_mul_i32 s42, s39, s38
  s_add_u32 s35, s49, s42
  s_mul_i32 s42, s39, 196608
  s_add_u32 s37, s51, s42
  s_add_u32 s36, s50, s42
  s_add_u32 s43, s35, 64
  s_cmp_eq_u32 s31, 1
  s_cselect_b32 s36, s36, s43
  s_add_u32 s44, s36, 64
  s_cmp_eq_u32 s31, 1
  s_cselect_b32 s44, s44, s36
  s_add_u32 s39, s39, 1
  s_and_b32 s39, s39, 7
  s_add_u32 m0, s63, 53248
  s_nop 0
  buffer_load_dwordx4 v20, s[12:15], s35 offen lds
  s_waitcnt lgkmcnt(0)
  v_lshlrev_b32 v58, 16, v32
  v_and_b32 v59, 0xffff0000, v32
  v_lshlrev_b32 v60, 16, v36
  v_and_b32 v61, 0xffff0000, v36
  v_lshlrev_b32 v62, 16, v40
  v_and_b32 v63, 0xffff0000, v40
  s_add_u32 m0, s63, 61440
  s_nop 0
  buffer_load_dwordx4 v13, s[72:75], s36 offen lds
  v_lshlrev_b32 v64, 16, v44
  v_and_b32 v65, 0xffff0000, v44
  v_lshlrev_b32 v66, 16, v48
  v_and_b32 v67, 0xffff0000, v48
  v_add_f32 v52, v52, v58
  v_add_f32 v53, v53, v60
  v_add_f32 v54, v54, v62
  s_add_u32 m0, s63, 57344
  s_nop 0
  buffer_load_dwordx4 v20, s[16:19], s35 offen lds
  v_add_f32 v55, v55, v64
  v_add_f32 v56, v56, v66
  v_add_f32 v52, v52, v59
  v_add_f32 v53, v53, v61
  v_add_f32 v54, v54, v63
  v_add_f32 v55, v55, v65
  v_add_f32 v56, v56, v67
  s_add_u32 m0, s63, 65536
  s_nop 0
  buffer_load_dwordx4 v13, s[52:55], s44 offen lds
  v_lshlrev_b32 v58, 16, v33
  v_and_b32 v59, 0xffff0000, v33
  v_lshlrev_b32 v60, 16, v37
  v_and_b32 v61, 0xffff0000, v37
  v_lshlrev_b32 v62, 16, v41
  v_and_b32 v63, 0xffff0000, v41
  v_lshlrev_b32 v64, 16, v45
  s_add_u32 m0, s63, 69632
  s_nop 0
  buffer_load_dwordx4 v21, s[24:27], s37 offen lds
  v_and_b32 v65, 0xffff0000, v45
  v_lshlrev_b32 v66, 16, v49
  v_and_b32 v67, 0xffff0000, v49
  v_add_f32 v52, v52, v58
  v_add_f32 v53, v53, v60
  v_add_f32 v54, v54, v62
  v_add_f32 v55, v55, v64
  s_add_u32 m0, s62, 53248
  s_add_u32 s42, s34, 0
  buffer_load_dwordx4 v16, s[8:11], s42 offen offset:0 lds
  v_add_f32 v56, v56, v66
  v_add_f32 v52, v52, v59
  v_add_f32 v53, v53, v61
  v_add_f32 v54, v54, v63
  v_add_f32 v55, v55, v65
  v_add_f32 v56, v56, v67
  v_lshlrev_b32 v58, 16, v34
  buffer_load_dwordx4 v17, s[8:11], s42 offen offset:1024 lds
  v_and_b32 v59, 0xffff0000, v34
  v_lshlrev_b32 v60, 16, v38
  v_and_b32 v61, 0xffff0000, v38
  v_lshlrev_b32 v62, 16, v42
  v_and_b32 v63, 0xffff0000, v42
  v_lshlrev_b32 v64, 16, v46
  v_and_b32 v65, 0xffff0000, v46
  buffer_load_dwordx4 v18, s[8:11], s42 offen offset:2048 lds
  v_lshlrev_b32 v66, 16, v50
  v_and_b32 v67, 0xffff0000, v50
  v_add_f32 v52, v52, v58
  v_add_f32 v53, v53, v60
  v_add_f32 v54, v54, v62
  v_add_f32 v55, v55, v64
  v_add_f32 v56, v56, v66
  buffer_load_dwordx4 v19, s[8:11], s42 offen offset:3072 lds
  v_add_f32 v52, v52, v59
  v_add_f32 v53, v53, v61
  v_add_f32 v54, v54, v63
  v_add_f32 v55, v55, v65
  v_add_f32 v56, v56, v67
  v_lshlrev_b32 v58, 16, v35
  v_and_b32 v59, 0xffff0000, v35
  s_add_u32 m0, s62, 57344
  s_add_u32 s42, s34, 32768
  buffer_load_dwordx4 v16, s[8:11], s42 offen offset:0 lds
  v_lshlrev_b32 v60, 16, v39
  v_and_b32 v61, 0xffff0000, v39
  v_lshlrev_b32 v62, 16, v43
  v_and_b32 v63, 0xffff0000, v43
  v_lshlrev_b32 v64, 16, v47
  v_and_b32 v65, 0xffff0000, v47
  v_lshlrev_b32 v66, 16, v51
  buffer_load_dwordx4 v17, s[8:11], s42 offen offset:1024 lds
  v_and_b32 v67, 0xffff0000, v51
  v_add_f32 v52, v52, v58
  v_add_f32 v53, v53, v60
  v_add_f32 v54, v54, v62
  v_add_f32 v55, v55, v64
  v_add_f32 v56, v56, v66
  v_add_f32 v52, v52, v59
  buffer_load_dwordx4 v18, s[8:11], s42 offen offset:2048 lds
  v_add_f32 v53, v53, v61
  v_add_f32 v54, v54, v63
  v_add_f32 v55, v55, v65
  v_add_f32 v56, v56, v67
  buffer_load_dwordx4 v19, s[8:11], s42 offen offset:3072 lds
  s_waitcnt lgkmcnt(0)
  s_waitcnt vmcnt(13)
  s_barrier
  ds_read_b64_tr_b16 v[32:33], v22 offset:0
  ds_read_b64_tr_b16 v[34:35], v22 offset:256
  ds_read_b64_tr_b16 v[36:37], v22 offset:4096
  ds_read_b64_tr_b16 v[38:39], v22 offset:4352
  ds_read_b64_tr_b16 v[40:41], v22 offset:8192
  ds_read_b64_tr_b16 v[42:43], v22 offset:8448
  ds_read_b64_tr_b16 v[44:45], v22 offset:12288
  ds_read_b64_tr_b16 v[46:47], v22 offset:12544
  ds_read_b64_tr_b16 v[48:49], v22 offset:16384
  ds_read_b64_tr_b16 v[50:51], v22 offset:16640
  s_lshl_b32 s42, s39, 7
  s_add_u32 s34, s48, s42
  s_mul_i32 s42, s39, s38
  s_add_u32 s35, s49, s42
  s_mul_i32 s42, s39, 196608
  s_add_u32 s37, s51, s42
  s_add_u32 s36, s50, s42
  s_add_u32 s43, s35, 64
  s_cmp_eq_u32 s31, 1
  s_cselect_b32 s36, s36, s43
  s_add_u32 s44, s36, 64
  s_cmp_eq_u32 s31, 1
  s_cselect_b32 s44, s44, s36
  s_add_u32 s39, s39, 1
  s_and_b32 s39, s39, 7
  s_add_u32 m0, s63, 106496
  s_nop 0
  buffer_load_dwordx4 v20, s[12:15], s35 offen lds
  s_waitcnt lgkmcnt(0)
  v_lshlrev_b32 v58, 16, v32
  v_and_b32 v59, 0xffff0000, v32
  v_lshlrev_b32 v60, 16, v36
  v_and_b32 v61, 0xffff0000, v36
  v_lshlrev_b32 v62, 16, v40
  v_and_b32 v63, 0xffff0000, v40
  s_add_u32 m0, s63, 114688
  s_nop 0
  buffer_load_dwordx4 v13, s[72:75], s36 offen lds
  v_lshlrev_b32 v64, 16, v44
  v_and_b32 v65, 0xffff0000, v44
  v_lshlrev_b32 v66, 16, v48
  v_and_b32 v67, 0xffff0000, v48
  v_add_f32 v52, v52, v58
  v_add_f32 v53, v53, v60
  v_add_f32 v54, v54, v62
  s_add_u32 m0, s63, 110592
  s_nop 0
  buffer_load_dwordx4 v20, s[16:19], s35 offen lds
  v_add_f32 v55, v55, v64
  v_add_f32 v56, v56, v66
  v_add_f32 v52, v52, v59
  v_add_f32 v53, v53, v61
  v_add_f32 v54, v54, v63
  v_add_f32 v55, v55, v65
  v_add_f32 v56, v56, v67
  s_add_u32 m0, s63, 118784
  s_nop 0
  buffer_load_dwordx4 v13, s[52:55], s44 offen lds
  v_lshlrev_b32 v58, 16, v33
  v_and_b32 v59, 0xffff0000, v33
  v_lshlrev_b32 v60, 16, v37
  v_and_b32 v61, 0xffff0000, v37
  v_lshlrev_b32 v62, 16, v41
  v_and_b32 v63, 0xffff0000, v41
  v_lshlrev_b32 v64, 16, v45
  s_add_u32 m0, s63, 122880
  s_nop 0
  buffer_load_dwordx4 v21, s[24:27], s37 offen lds
  v_and_b32 v65, 0xffff0000, v45
  v_lshlrev_b32 v66, 16, v49
  v_and_b32 v67, 0xffff0000, v49
  v_add_f32 v52, v52, v58
  v_add_f32 v53, v53, v60
  v_add_f32 v54, v54, v62
  v_add_f32 v55, v55, v64
  s_add_u32 m0, s62, 106496
  s_add_u32 s42, s34, 0
  buffer_load_dwordx4 v16, s[8:11], s42 offen offset:0 lds
  v_add_f32 v56, v56, v66
  v_add_f32 v52, v52, v59
  v_add_f32 v53, v53, v61
  v_add_f32 v54, v54, v63
  v_add_f32 v55, v55, v65
  v_add_f32 v56, v56, v67
  v_lshlrev_b32 v58, 16, v34
  buffer_load_dwordx4 v17, s[8:11], s42 offen offset:1024 lds
  v_and_b32 v59, 0xffff0000, v34
  v_lshlrev_b32 v60, 16, v38
  v_and_b32 v61, 0xffff0000, v38
  v_lshlrev_b32 v62, 16, v42
  v_and_b32 v63, 0xffff0000, v42
  v_lshlrev_b32 v64, 16, v46
  v_and_b32 v65, 0xffff0000, v46
  buffer_load_dwordx4 v18, s[8:11], s42 offen offset:2048 lds
  v_lshlrev_b32 v66, 16, v50
  v_and_b32 v67, 0xffff0000, v50
  v_add_f32 v52, v52, v58
  v_add_f32 v53, v53, v60
  v_add_f32 v54, v54, v62
  v_add_f32 v55, v55, v64
  v_add_f32 v56, v56, v66
  buffer_load_dwordx4 v19, s[8:11], s42 offen offset:3072 lds
  v_add_f32 v52, v52, v59
  v_add_f32 v53, v53, v61
  v_add_f32 v54, v54, v63
  v_add_f32 v55, v55, v65
  v_add_f32 v56, v56, v67
  v_lshlrev_b32 v58, 16, v35
  v_and_b32 v59, 0xffff0000, v35
  s_add_u32 m0, s62, 110592
  s_add_u32 s42, s34, 32768
  buffer_load_dwordx4 v16, s[8:11], s42 offen offset:0 lds
  v_lshlrev_b32 v60, 16, v39
  v_and_b32 v61, 0xffff0000, v39
  v_lshlrev_b32 v62, 16, v43
  v_and_b32 v63, 0xffff0000, v43
  v_lshlrev_b32 v64, 16, v47
  v_and_b32 v65, 0xffff0000, v47
  v_lshlrev_b32 v66, 16, v51
  buffer_load_dwordx4 v17, s[8:11], s42 offen offset:1024 lds
  v_and_b32 v67, 0xffff0000, v51
  v_add_f32 v52, v52, v58
  v_add_f32 v53, v53, v60
  v_add_f32 v54, v54, v62
  v_add_f32 v55, v55, v64
  v_add_f32 v56, v56, v66
  v_add_f32 v52, v52, v59
  buffer_load_dwordx4 v18, s[8:11], s42 offen offset:2048 lds
  v_add_f32 v53, v53, v61
  v_add_f32 v54, v54, v63
  v_add_f32 v55, v55, v65
  v_add_f32 v56, v56, v67
  buffer_load_dwordx4 v19, s[8:11], s42 offen offset:3072 lds
  s_waitcnt lgkmcnt(0)
  s_waitcnt vmcnt(13)
  s_barrier
  ds_read_b64_tr_b16 v[32:33], v23 offset:0
  ds_read_b64_tr_b16 v[34:35], v23 offset:256
  ds_read_b64_tr_b16 v[36:37], v23 offset:4096
  ds_read_b64_tr_b16 v[38:39], v23 offset:4352
  ds_read_b64_tr_b16 v[40:41], v23 offset:8192
  ds_read_b64_tr_b16 v[42:43], v23 offset:8448
  ds_read_b64_tr_b16 v[44:45], v23 offset:12288
  ds_read_b64_tr_b16 v[46:47], v23 offset:12544
  ds_read_b64_tr_b16 v[48:49], v23 offset:16384
  ds_read_b64_tr_b16 v[50:51], v23 offset:16640
  s_lshl_b32 s42, s39, 7
  s_add_u32 s34, s48, s42
  s_mul_i32 s42, s39, s38
  s_add_u32 s35, s49, s42
  s_mul_i32 s42, s39, 196608
  s_add_u32 s37, s51, s42
  s_add_u32 s36, s50, s42
  s_add_u32 s43, s35, 64
  s_cmp_eq_u32 s31, 1
  s_cselect_b32 s36, s36, s43
  s_add_u32 s44, s36, 64
  s_cmp_eq_u32 s31, 1
  s_cselect_b32 s44, s44, s36
  s_add_u32 s39, s39, 1
  s_and_b32 s39, s39, 7
  s_add_u32 m0, s63, 0
  s_nop 0
  buffer_load_dwordx4 v20, s[12:15], s35 offen lds
  s_waitcnt lgkmcnt(0)
  v_lshlrev_b32 v58, 16, v32
  v_and_b32 v59, 0xffff0000, v32
  v_lshlrev_b32 v60, 16, v36
  v_and_b32 v61, 0xffff0000, v36
  v_lshlrev_b32 v62, 16, v40
  v_and_b32 v63, 0xffff0000, v40
  s_add_u32 m0, s63, 8192
  s_nop 0
  buffer_load_dwordx4 v13, s[72:75], s36 offen lds
  v_lshlrev_b32 v64, 16, v44
  v_and_b32 v65, 0xffff0000, v44
  v_lshlrev_b32 v66, 16, v48
  v_and_b32 v67, 0xffff0000, v48
  v_add_f32 v52, v52, v58
  v_add_f32 v53, v53, v60
  v_add_f32 v54, v54, v62
  s_add_u32 m0, s63, 4096
  s_nop 0
  buffer_load_dwordx4 v20, s[16:19], s35 offen lds
  v_add_f32 v55, v55, v64
  v_add_f32 v56, v56, v66
  v_add_f32 v52, v52, v59
  v_add_f32 v53, v53, v61
  v_add_f32 v54, v54, v63
  v_add_f32 v55, v55, v65
  v_add_f32 v56, v56, v67
  s_add_u32 m0, s63, 12288
  s_nop 0
  buffer_load_dwordx4 v13, s[52:55], s44 offen lds
  v_lshlrev_b32 v58, 16, v33
  v_and_b32 v59, 0xffff0000, v33
  v_lshlrev_b32 v60, 16, v37
  v_and_b32 v61, 0xffff0000, v37
  v_lshlrev_b32 v62, 16, v41
  v_and_b32 v63, 0xffff0000, v41
  v_lshlrev_b32 v64, 16, v45
  s_add_u32 m0, s63, 16384
  s_nop 0
  buffer_load_dwordx4 v21, s[24:27], s37 offen lds
  v_and_b32 v65, 0xffff0000, v45
  v_lshlrev_b32 v66, 16, v49
  v_and_b32 v67, 0xffff0000, v49
  v_add_f32 v52, v52, v58
  v_add_f32 v53, v53, v60
  v_add_f32 v54, v54, v62
  v_add_f32 v55, v55, v64
  s_add_u32 m0, s62, 0
  s_add_u32 s42, s34, 0
  buffer_load_dwordx4 v16, s[8:11], s42 offen offset:0 lds
  v_add_f32 v56, v56, v66
  v_add_f32 v52, v52, v59
  v_add_f32 v53, v53, v61
  v_add_f32 v54, v54, v63
  v_add_f32 v55, v55, v65
  v_add_f32 v56, v56, v67
  v_lshlrev_b32 v58, 16, v34
  buffer_load_dwordx4 v17, s[8:11], s42 offen offset:1024 lds
  v_and_b32 v59, 0xffff0000, v34
  v_lshlrev_b32 v60, 16, v38
  v_and_b32 v61, 0xffff0000, v38
  v_lshlrev_b32 v62, 16, v42
  v_and_b32 v63, 0xffff0000, v42
  v_lshlrev_b32 v64, 16, v46
  v_and_b32 v65, 0xffff0000, v46
  buffer_load_dwordx4 v18, s[8:11], s42 offen offset:2048 lds
  v_lshlrev_b32 v66, 16, v50
  v_and_b32 v67, 0xffff0000, v50
  v_add_f32 v52, v52, v58
  v_add_f32 v53, v53, v60
  v_add_f32 v54, v54, v62
  v_add_f32 v55, v55, v64
  v_add_f32 v56, v56, v66
  buffer_load_dwordx4 v19, s[8:11], s42 offen offset:3072 lds
  v_add_f32 v52, v52, v59
  v_add_f32 v53, v53, v61
  v_add_f32 v54, v54, v63
  v_add_f32 v55, v55, v65
  v_add_f32 v56, v56, v67
  v_lshlrev_b32 v58, 16, v35
  v_and_b32 v59, 0xffff0000, v35
  s_add_u32 m0, s62, 4096
  s_add_u32 s42, s34, 32768
  buffer_load_dwordx4 v16, s[8:11], s42 offen offset:0 lds
  v_lshlrev_b32 v60, 16, v39
  v_and_b32 v61, 0xffff0000, v39
  v_lshlrev_b32 v62, 16, v43
  v_and_b32 v63, 0xffff0000, v43
  v_lshlrev_b32 v64, 16, v47
  v_and_b32 v65, 0xffff0000, v47
  v_lshlrev_b32 v66, 16, v51
  buffer_load_dwordx4 v17, s[8:11], s42 offen offset:1024 lds
  v_and_b32 v67, 0xffff0000, v51
  v_add_f32 v52, v52, v58
  v_add_f32 v53, v53, v60
  v_add_f32 v54, v54, v62
  v_add_f32 v55, v55, v64
  v_add_f32 v56, v56, v66
  v_add_f32 v52, v52, v59
  buffer_load_dwordx4 v18, s[8:11], s42 offen offset:2048 lds
  v_add_f32 v53, v53, v61
  v_add_f32 v54, v54, v63
  v_add_f32 v55, v55, v65
  v_add_f32 v56, v56, v67
  buffer_load_dwordx4 v19, s[8:11], s42 offen offset:3072 lds
  s_waitcnt lgkmcnt(0)
  s_waitcnt vmcnt(13)
  s_barrier
  ds_read_b64_tr_b16 v[32:33], v15 offset:0
  ds_read_b64_tr_b16 v[34:35], v15 offset:256
  ds_read_b64_tr_b16 v[36:37], v15 offset:4096
  ds_read_b64_tr_b16 v[38:39], v15 offset:4352
  ds_read_b64_tr_b16 v[40:41], v15 offset:8192
  ds_read_b64_tr_b16 v[42:43], v15 offset:8448
  ds_read_b64_tr_b16 v[44:45], v15 offset:12288
  ds_read_b64_tr_b16 v[46:47], v15 offset:12544
  ds_read_b64_tr_b16 v[48:49], v15 offset:16384
  ds_read_b64_tr_b16 v[50:51], v15 offset:16640
  s_lshl_b32 s42, s39, 7
  s_add_u32 s34, s48, s42
  s_mul_i32 s42, s39, s38
  s_add_u32 s35, s49, s42
  s_mul_i32 s42, s39, 196608
  s_add_u32 s37, s51, s42
  s_add_u32 s36, s50, s42
  s_add_u32 s43, s35, 64
  s_cmp_eq_u32 s31, 1
  s_cselect_b32 s36, s36, s43
  s_add_u32 s44, s36, 64
  s_cmp_eq_u32 s31, 1
  s_cselect_b32 s44, s44, s36
  s_add_u32 s39, s39, 1
  s_and_b32 s39, s39, 7
  s_add_u32 m0, s63, 53248
  s_nop 0
  buffer_load_dwordx4 v20, s[12:15], s35 offen lds
  s_waitcnt lgkmcnt(0)
  v_lshlrev_b32 v58, 16, v32
  v_and_b32 v59, 0xffff0000, v32
  v_lshlrev_b32 v60, 16, v36
  v_and_b32 v61, 0xffff0000, v36
  v_lshlrev_b32 v62, 16, v40
  v_and_b32 v63, 0xffff0000, v40
  s_add_u32 m0, s63, 61440
  s_nop 0
  buffer_load_dwordx4 v13, s[72:75], s36 offen lds
  v_lshlrev_b32 v64, 16, v44
  v_and_b32 v65, 0xffff0000, v44
  v_lshlrev_b32 v66, 16, v48
  v_and_b32 v67, 0xffff0000, v48
  v_add_f32 v52, v52, v58
  v_add_f32 v53, v53, v60
  v_add_f32 v54, v54, v62
  s_add_u32 m0, s63, 57344
  s_nop 0
  buffer_load_dwordx4 v20, s[16:19], s35 offen lds
  v_add_f32 v55, v55, v64
  v_add_f32 v56, v56, v66
  v_add_f32 v52, v52, v59
  v_add_f32 v53, v53, v61
  v_add_f32 v54, v54, v63
  v_add_f32 v55, v55, v65
  v_add_f32 v56, v56, v67
  s_add_u32 m0, s63, 65536
  s_nop 0
  buffer_load_dwordx4 v13, s[52:55], s44 offen lds
  v_lshlrev_b32 v58, 16, v33
  v_and_b32 v59, 0xffff0000, v33
  v_lshlrev_b32 v60, 16, v37
  v_and_b32 v61, 0xffff0000, v37
  v_lshlrev_b32 v62, 16, v41
  v_and_b32 v63, 0xffff0000, v41
  v_lshlrev_b32 v64, 16, v45
  s_add_u32 m0, s63, 69632
  s_nop 0
  buffer_load_dwordx4 v21, s[24:27], s37 offen lds
  v_and_b32 v65, 0xffff0000, v45
  v_lshlrev_b32 v66, 16, v49
  v_and_b32 v67, 0xffff0000, v49
  v_add_f32 v52, v52, v58
  v_add_f32 v53, v53, v60
  v_add_f32 v54, v54, v62
  v_add_f32 v55, v55, v64
  s_add_u32 m0, s62, 53248
  s_add_u32 s42, s34, 0
  buffer_load_dwordx4 v16, s[8:11], s42 offen offset:0 lds
  v_add_f32 v56, v56, v66
  v_add_f32 v52, v52, v59
  v_add_f32 v53, v53, v61
  v_add_f32 v54, v54, v63
  v_add_f32 v55, v55, v65
  v_add_f32 v56, v56, v67
  v_lshlrev_b32 v58, 16, v34
  buffer_load_dwordx4 v17, s[8:11], s42 offen offset:1024 lds
  v_and_b32 v59, 0xffff0000, v34
  v_lshlrev_b32 v60, 16, v38
  v_and_b32 v61, 0xffff0000, v38
  v_lshlrev_b32 v62, 16, v42
  v_and_b32 v63, 0xffff0000, v42
  v_lshlrev_b32 v64, 16, v46
  v_and_b32 v65, 0xffff0000, v46
  buffer_load_dwordx4 v18, s[8:11], s42 offen offset:2048 lds
  v_lshlrev_b32 v66, 16, v50
  v_and_b32 v67, 0xffff0000, v50
  v_add_f32 v52, v52, v58
  v_add_f32 v53, v53, v60
  v_add_f32 v54, v54, v62
  v_add_f32 v55, v55, v64
  v_add_f32 v56, v56, v66
  buffer_load_dwordx4 v19, s[8:11], s42 offen offset:3072 lds
  v_add_f32 v52, v52, v59
  v_add_f32 v53, v53, v61
  v_add_f32 v54, v54, v63
  v_add_f32 v55, v55, v65
  v_add_f32 v56, v56, v67
  v_lshlrev_b32 v58, 16, v35
  v_and_b32 v59, 0xffff0000, v35
  s_add_u32 m0, s62, 57344
  s_add_u32 s42, s34, 32768
  buffer_load_dwordx4 v16, s[8:11], s42 offen offset:0 lds
  v_lshlrev_b32 v60, 16, v39
  v_and_b32 v61, 0xffff0000, v39
  v_lshlrev_b32 v62, 16, v43
  v_and_b32 v63, 0xffff0000, v43
  v_lshlrev_b32 v64, 16, v47
  v_and_b32 v65, 0xffff0000, v47
  v_lshlrev_b32 v66, 16, v51
  buffer_load_dwordx4 v17, s[8:11], s42 offen offset:1024 lds
  v_and_b32 v67, 0xffff0000, v51
  v_add_f32 v52, v52, v58
  v_add_f32 v53, v53, v60
  v_add_f32 v54, v54, v62
  v_add_f32 v55, v55, v64
  v_add_f32 v56, v56, v66
  v_add_f32 v52, v52, v59
  buffer_load_dwordx4 v18, s[8:11], s42 offen offset:2048 lds
  v_add_f32 v53, v53, v61
  v_add_f32 v54, v54, v63
  v_add_f32 v55, v55, v65
  v_add_f32 v56, v56, v67
  buffer_load_dwordx4 v19, s[8:11], s42 offen offset:3072 lds
  s_waitcnt lgkmcnt(0)
  s_waitcnt vmcnt(13)
  s_barrier
  ds_read_b64_tr_b16 v[32:33], v22 offset:0
  ds_read_b64_tr_b16 v[34:35], v22 offset:256
  ds_read_b64_tr_b16 v[36:37], v22 offset:4096
  ds_read_b64_tr_b16 v[38:39], v22 offset:4352
  ds_read_b64_tr_b16 v[40:41], v22 offset:8192
  ds_read_b64_tr_b16 v[42:43], v22 offset:8448
  ds_read_b64_tr_b16 v[44:45], v22 offset:12288
  ds_read_b64_tr_b16 v[46:47], v22 offset:12544
  ds_read_b64_tr_b16 v[48:49], v22 offset:16384
  ds_read_b64_tr_b16 v[50:51], v22 offset:16640
  s_waitcnt lgkmcnt(0)
  v_lshlrev_b32 v58, 16, v32
  v_and_b32 v59, 0xffff0000, v32
  v_lshlrev_b32 v60, 16, v36
  v_and_b32 v61, 0xffff0000, v36
  v_lshlrev_b32 v62, 16, v40
  v_and_b32 v63, 0xffff0000, v40
  v_lshlrev_b32 v64, 16, v44
  v_and_b32 v65, 0xffff0000, v44
  v_lshlrev_b32 v66, 16, v48
  v_and_b32 v67, 0xffff0000, v48
  v_add_f32 v52, v52, v58
  v_add_f32 v53, v53, v60
  v_add_f32 v54, v54, v62
  v_add_f32 v55, v55, v64
  v_add_f32 v56, v56, v66
  v_add_f32 v52, v52, v59
  v_add_f32 v53, v53, v61
  v_add_f32 v54, v54, v63
  v_add_f32 v55, v55, v65
  v_add_f32 v56, v56, v67
  v_lshlrev_b32 v58, 16, v33
  v_and_b32 v59, 0xffff0000, v33
  v_lshlrev_b32 v60, 16, v37
  v_and_b32 v61, 0xffff0000, v37
  v_lshlrev_b32 v62, 16, v41
  v_and_b32 v63, 0xffff0000, v41
  v_lshlrev_b32 v64, 16, v45
  v_and_b32 v65, 0xffff0000, v45
  v_lshlrev_b32 v66, 16, v49
  v_and_b32 v67, 0xffff0000, v49
  v_add_f32 v52, v52, v58
  v_add_f32 v53, v53, v60
  v_add_f32 v54, v54, v62
  v_add_f32 v55, v55, v64
  v_add_f32 v56, v56, v66
  v_add_f32 v52, v52, v59
  v_add_f32 v53, v53, v61
  v_add_f32 v54, v54, v63
  v_add_f32 v55, v55, v65
  v_add_f32 v56, v56, v67
  v_lshlrev_b32 v58, 16, v34
  v_and_b32 v59, 0xffff0000, v34
  v_lshlrev_b32 v60, 16, v38
  v_and_b32 v61, 0xffff0000, v38
  v_lshlrev_b32 v62, 16, v42
  v_and_b32 v63, 0xffff0000, v42
  v_lshlrev_b32 v64, 16, v46
  v_and_b32 v65, 0xffff0000, v46
  v_lshlrev_b32 v66, 16, v50
  v_and_b32 v67, 0xffff0000, v50
  v_add_f32 v52, v52, v58
  v_add_f32 v53, v53, v60
  v_add_f32 v54, v54, v62
  v_add_f32 v55, v55, v64
  v_add_f32 v56, v56, v66
  v_add_f32 v52, v52, v59
  v_add_f32 v53, v53, v61
  v_add_f32 v54, v54, v63
  v_add_f32 v55, v55, v65
  v_add_f32 v56, v56, v67
  v_lshlrev_b32 v58, 16, v35
  v_and_b32 v59, 0xffff0000, v35
  v_lshlrev_b32 v60, 16, v39
  v_and_b32 v61, 0xffff0000, v39
  v_lshlrev_b32 v62, 16, v43
  v_and_b32 v63, 0xffff0000, v43
  v_lshlrev_b32 v64, 16, v47
  v_and_b32 v65, 0xffff0000, v47
  v_lshlrev_b32 v66, 16, v51
  v_and_b32 v67, 0xffff0000, v51
  v_add_f32 v52, v52, v58
  v_add_f32 v53, v53, v60
  v_add_f32 v54, v54, v62
  v_add_f32 v55, v55, v64
  v_add_f32 v56, v56, v66
  v_add_f32 v52, v52, v59
  v_add_f32 v53, v53, v61
  v_add_f32 v54, v54, v63
  v_add_f32 v55, v55, v65
  v_add_f32 v56, v56, v67
  s_waitcnt lgkmcnt(0)
  s_waitcnt vmcnt(0)
  ds_read_b64_tr_b16 v[32:33], v23 offset:0
  ds_read_b64_tr_b16 v[34:35], v23 offset:256
  ds_read_b64_tr_b16 v[36:37], v23 offset:4096
  ds_read_b64_tr_b16 v[38:39], v23 offset:4352
  ds_read_b64_tr_b16 v[40:41], v23 offset:8192
  ds_read_b64_tr_b16 v[42:43], v23 offset:8448
  ds_read_b64_tr_b16 v[44:45], v23 offset:12288
  ds_read_b64_tr_b16 v[46:47], v23 offset:12544
  ds_read_b64_tr_b16 v[48:49], v23 offset:16384
  ds_read_b64_tr_b16 v[50:51], v23 offset:16640
  s_waitcnt lgkmcnt(0)
  v_lshlrev_b32 v58, 16, v32
  v_and_b32 v59, 0xffff0000, v32
  v_lshlrev_b32 v60, 16, v36
  v_and_b32 v61, 0xffff0000, v36
  v_lshlrev_b32 v62, 16, v40
  v_and_b32 v63, 0xffff0000, v40
  v_lshlrev_b32 v64, 16, v44
  v_and_b32 v65, 0xffff0000, v44
  v_lshlrev_b32 v66, 16, v48
  v_and_b32 v67, 0xffff0000, v48
  v_add_f32 v52, v52, v58
  v_add_f32 v53, v53, v60
  v_add_f32 v54, v54, v62
  v_add_f32 v55, v55, v64
  v_add_f32 v56, v56, v66
  v_add_f32 v52, v52, v59
  v_add_f32 v53, v53, v61
  v_add_f32 v54, v54, v63
  v_add_f32 v55, v55, v65
  v_add_f32 v56, v56, v67
  v_lshlrev_b32 v58, 16, v33
  v_and_b32 v59, 0xffff0000, v33
  v_lshlrev_b32 v60, 16, v37
  v_and_b32 v61, 0xffff0000, v37
  v_lshlrev_b32 v62, 16, v41
  v_and_b32 v63, 0xffff0000, v41
  v_lshlrev_b32 v64, 16, v45
  v_and_b32 v65, 0xffff0000, v45
  v_lshlrev_b32 v66, 16, v49
  v_and_b32 v67, 0xffff0000, v49
  v_add_f32 v52, v52, v58
  v_add_f32 v53, v53, v60
  v_add_f32 v54, v54, v62
  v_add_f32 v55, v55, v64
  v_add_f32 v56, v56, v66
  v_add_f32 v52, v52, v59
  v_add_f32 v53, v53, v61
  v_add_f32 v54, v54, v63
  v_add_f32 v55, v55, v65
  v_add_f32 v56, v56, v67
  v_lshlrev_b32 v58, 16, v34
  v_and_b32 v59, 0xffff0000, v34
  v_lshlrev_b32 v60, 16, v38
  v_and_b32 v61, 0xffff0000, v38
  v_lshlrev_b32 v62, 16, v42
  v_and_b32 v63, 0xffff0000, v42
  v_lshlrev_b32 v64, 16, v46
  v_and_b32 v65, 0xffff0000, v46
  v_lshlrev_b32 v66, 16, v50
  v_and_b32 v67, 0xffff0000, v50
  v_add_f32 v52, v52, v58
  v_add_f32 v53, v53, v60
  v_add_f32 v54, v54, v62
  v_add_f32 v55, v55, v64
  v_add_f32 v56, v56, v66
  v_add_f32 v52, v52, v59
  v_add_f32 v53, v53, v61
  v_add_f32 v54, v54, v63
  v_add_f32 v55, v55, v65
  v_add_f32 v56, v56, v67
  v_lshlrev_b32 v58, 16, v35
  v_and_b32 v59, 0xffff0000, v35
  v_lshlrev_b32 v60, 16, v39
  v_and_b32 v61, 0xffff0000, v39
  v_lshlrev_b32 v62, 16, v43
  v_and_b32 v63, 0xffff0000, v43
  v_lshlrev_b32 v64, 16, v47
  v_and_b32 v65, 0xffff0000, v47
  v_lshlrev_b32 v66, 16, v51
  v_and_b32 v67, 0xffff0000, v51
  v_add_f32 v52, v52, v58
  v_add_f32 v53, v53, v60
  v_add_f32 v54, v54, v62
  v_add_f32 v55, v55, v64
  v_add_f32 v56, v56, v66
  v_add_f32 v52, v52, v59
  v_add_f32 v53, v53, v61
  v_add_f32 v54, v54, v63
  v_add_f32 v55, v55, v65
  v_add_f32 v56, v56, v67
  v_mov_b32 v58, v52
  v_mov_b32 v59, v53
  v_mov_b32 v60, v54
  v_mov_b32 v61, v55
  v_mov_b32 v62, v56
  v_permlane32_swap_b32 v52, v58
  v_permlane32_swap_b32 v53, v59
  v_permlane32_swap_b32 v54, v60
  v_permlane32_swap_b32 v55, v61
  v_permlane32_swap_b32 v56, v62
  v_add_f32 v52, v52, v58
  v_add_f32 v53, v53, v59
  v_add_f32 v54, v54, v60
  v_add_f32 v55, v55, v61
  v_add_f32 v56, v56, v62
  v_and_b32 v7, 31, v1
  s_lshl_b32 s42, s32, 2
  s_add_u32 s42, s42, 122880
  v_lshl_add_u32 v7, v7, 4, s42
  ds_write_b32 v7, v52 offset:0
  ds_write_b32 v7, v53 offset:512
  ds_write_b32 v7, v54 offset:1024
  ds_write_b32 v7, v55 offset:1536
  ds_write_b32 v7, v56 offset:2048
  s_waitcnt lgkmcnt(0)
  s_barrier
  v_and_b32 v7, 31, v1
  s_lshl_b32 s42, s32, 9
  s_add_u32 s42, s42, 122880
  v_lshl_add_u32 v6, v7, 4, s42
  ds_read_b128 v[2:5], v6
  v_lshlrev_b32 v8, 4, v7
  v_add_u32 v8, 124928, v8
  ds_read_b128 v[8:11], v8
  s_lshl_b32 s42, s32, 9
  s_add_u32 s42, s42, 159744
  v_lshl_add_u32 v6, v7, 4, s42
  v_lshlrev_b32 v7, 4, v7
  v_add_u32 v7, 161792, v7
  s_waitcnt lgkmcnt(0)
  v_add_f32 v2, v2, v3
  v_add_f32 v4, v4, v5
  v_add_f32 v2, v2, v4
  v_cvt_pk_bf16_f32 v3, v2, v2
  v_and_b32 v3, 0xffff0000, v3
  v_sub_f32 v4, v2, v3
  v_cvt_pk_bf16_f32 v2, v3, v4
  v_mov_b32 v3, v2
  v_mov_b32 v4, v2
  v_mov_b32 v5, v2
  v_add_f32 v8, v8, v9
  v_add_f32 v10, v10, v11
  v_add_f32 v8, v8, v10
  v_cvt_pk_bf16_f32 v9, v8, v8
  v_and_b32 v9, 0xffff0000, v9
  v_sub_f32 v10, v8, v9
  v_cvt_pk_bf16_f32 v8, v9, v10
  v_mov_b32 v9, v8
  v_mov_b32 v10, v8
  v_mov_b32 v11, v8
  ds_write_b128 v6, v[2:5]
  s_cmp_eq_u32 s32, 0
  s_cbranch_scc0 L_k1_c4_11
  ds_write_b128 v7, v[8:11]
L_k1_c4_11:
  s_waitcnt lgkmcnt(0)
  s_barrier
  v_lshrrev_b32 v2, 2, v1
  v_lshlrev_b32 v2, 10, v2
  v_and_b32 v3, 3, v1
  v_lshl_add_u32 v12, v3, 4, v2
  s_mul_i32 s41, s2, 9
  s_add_u32 s41, s41, s32
  s_mul_hi_u32 s43, s41, 38347923
  s_mul_i32 s44, s43, 112
  s_sub_u32 s44, s41, s44
  s_sub_u32 s45, s41, 1792
  s_lshr_b32 s46, s45, 5
  s_and_b32 s47, s45, 31
  s_mov_b32 s40, 524288
  s_cmp_lt_u32 s41, 1792
  s_cselect_b32 s43, s43, s46
  s_cselect_b32 s44, s44, s47
  s_cselect_b32 s52, s68, s60
  s_cselect_b32 s53, s69, s61
  s_cselect_b32 s54, 1835008, s40
  s_mov_b32 s55, 0x20000
  s_lshl_b32 s44, s44, 14
  s_lshl_b32 s43, s43, 6
  s_add_u32 s44, s44, s43
  s_lshl_b32 s72, s41, 10
  s_add_u32 s72, s72, 13631488
  s_lshl_b32 s43, s32, 12
  s_add_u32 m0, s43, 106496
  s_nop 0
  buffer_load_dwordx4 v12, s[52:55], s44 offen lds
  s_add_u32 s41, s41, 4
  s_mul_hi_u32 s43, s41, 38347923
  s_mul_i32 s44, s43, 112
  s_sub_u32 s44, s41, s44
  s_sub_u32 s45, s41, 1792
  s_lshr_b32 s46, s45, 5
  s_and_b32 s47, s45, 31
  s_mov_b32 s40, 524288
  s_cmp_lt_u32 s41, 1792
  s_cselect_b32 s43, s43, s46
  s_cselect_b32 s44, s44, s47
  s_cselect_b32 s52, s68, s60
  s_cselect_b32 s53, s69, s61
  s_cselect_b32 s54, 1835008, s40
  s_mov_b32 s55, 0x20000
  s_lshl_b32 s44, s44, 14
  s_lshl_b32 s43, s43, 6
  s_add_u32 s44, s44, s43
  s_lshl_b32 s73, s41, 10
  s_add_u32 s73, s73, 13631488
  s_lshl_b32 s43, s32, 12
  s_add_u32 m0, s43, 107520
  s_nop 0
  buffer_load_dwordx4 v12, s[52:55], s44 offen lds
  s_mul_i32 s41, s2, 9
  s_add_u32 s41, s41, 8
  s_mul_hi_u32 s43, s41, 38347923
  s_mul_i32 s44, s43, 112
  s_sub_u32 s44, s41, s44
  s_sub_u32 s45, s41, 1792
  s_lshr_b32 s46, s45, 5
  s_and_b32 s47, s45, 31
  s_mov_b32 s40, 524288
  s_cmp_lt_u32 s41, 1792
  s_cselect_b32 s43, s43, s46
  s_cselect_b32 s44, s44, s47
  s_cselect_b32 s52, s68, s60
  s_cselect_b32 s53, s69, s61
  s_cselect_b32 s54, 1835008, s40
  s_mov_b32 s55, 0x20000
  s_lshl_b32 s44, s44, 14
  s_lshl_b32 s43, s43, 6
  s_add_u32 s44, s44, s43
  s_lshl_b32 s74, s41, 10
  s_add_u32 s74, s74, 13631488
  s_lshl_b32 s43, s32, 12
  s_add_u32 m0, s43, 108544
  s_nop 0
  buffer_load_dwordx4 v12, s[52:55], s44 offen lds
  v_lshrrev_b32 v3, 5, v1
  v_and_b32 v2, 15, v1
  v_lshrrev_b32 v4, 2, v2
  v_lshl_add_u32 v4, v3, 2, v4
  v_lshlrev_b32 v4, 6, v4
  v_and_b32 v5, 3, v2
  v_lshl_add_u32 v4, v5, 3, v4
  v_bfe_u32 v5, v1, 4, 1
  v_lshl_add_u32 v4, v5, 5, v4
  s_lshl_b32 s43, s32, 12
  s_add_u32 s43, s43, 106496
  v_add_u32 v4, s43, v4
  s_waitcnt vmcnt(0)
  ds_read_b64_tr_b16 v[70:71], v4 offset:0
  ds_read_b64_tr_b16 v[72:73], v4 offset:512
  ds_read_b64_tr_b16 v[74:75], v4 offset:1024
  ds_read_b64_tr_b16 v[76:77], v4 offset:1536
  ds_read_b64_tr_b16 v[78:79], v4 offset:2048
  ds_read_b64_tr_b16 v[80:81], v4 offset:2560
  s_waitcnt lgkmcnt(0)
  buffer_store_dwordx4 v[70:73], v14, s[20:23], s72 offen sc1
  buffer_store_dwordx4 v[74:77], v14, s[20:23], s73 offen sc1
  s_cmp_eq_u32 s32, 3
  s_cbranch_scc0 L_k1_sj3_12
  buffer_store_dwordx4 v[78:81], v14, s[20:23], s74 offen sc1
L_k1_sj3_12:
  s_barrier
  s_cmp_eq_u32 s32, 0
  s_cbranch_scc0 L_k1_f1_13
  s_lshl_b32 s42, s29, 5
  s_add_u32 s42, s42, s30
  s_lshl_b32 s42, s42, 7
  s_add_u32 s42, s42, 21102592
  v_and_b32 v2, 31, v1
  v_lshlrev_b32 v2, 2, v2
  v_mov_b32 v3, 1
  buffer_store_dword v3, v2, s[20:23], s42 offen sc1
L_k1_f1_13:
  s_waitcnt vmcnt(0) lgkmcnt(0)
  s_barrier
  s_cmp_eq_u32 s32, 0
  s_cbranch_scc0 L_k1_f2_14
  s_and_b32 s42, s2, 7
  s_lshl_b32 s42, s42, 7
  s_add_u32 s42, s42, 21135360
  v_mov_b32 v2, 1
  v_cmp_eq_u32 vcc, 0, v1
  v_mov_b32 v3, 0x7ffffff0
  s_nop 0
  v_cndmask_b32 v3, v3, 0, vcc
  buffer_atomic_add v2, v3, s[20:23], s42 offen sc1
L_k1_f2_14:
  s_branch L_p2
L_k1_cons:
  s_lshl_b32 s42, s29, 3
  s_lshl_b32 s43, s28, 1
  s_add_u32 s33, s42, s43
  v_and_b32 v2, 31, v1
  v_lshrrev_b32 v3, 5, v1
  v_lshrrev_b32 v4, 1, v2
  v_and_b32 v4, 7, v4
  v_lshlrev_b32 v5, 7, v2
  s_lshl_b32 s42, s28, 13
  v_add_u32 v5, s42, v5
  v_add_u32 v6, 0, v3
  v_xor_b32 v6, v6, v4
  v_lshlrev_b32 v6, 4, v6
  v_add_u32 v232, v5, v6
  v_add_u32 v236, 106496, v232
  v_add_u32 v6, 2, v3
  v_xor_b32 v6, v6, v4
  v_lshlrev_b32 v6, 4, v6
  v_add_u32 v233, v5, v6
  v_add_u32 v237, 106496, v233
  v_add_u32 v6, 4, v3
  v_xor_b32 v6, v6, v4
  v_lshlrev_b32 v6, 4, v6
  v_add_u32 v234, v5, v6
  v_add_u32 v238, 106496, v234
  v_add_u32 v6, 6, v3
  v_xor_b32 v6, v6, v4
  v_lshlrev_b32 v6, 4, v6
  v_add_u32 v235, v5, v6
  v_add_u32 v239, 106496, v235
  v_and_b32 v2, 15, v1
  v_lshrrev_b32 v4, 2, v2
  v_lshl_add_u32 v4, v3, 3, v4
  v_lshlrev_b32 v4, 6, v4
  v_and_b32 v5, 3, v2
  v_lshl_add_u32 v4, v5, 3, v4
  v_bfe_u32 v5, v1, 4, 1
  v_lshl_add_u32 v4, v5, 5, v4
  v_add_u32 v240, 32768, v4
  v_add_u32 v241, 86016, v4
  v_add_u32 v242, 139264, v4
  s_waitcnt lgkmcnt(0)
  s_mov_b32 s20, s70
  s_mov_b32 s21, s71
  s_mov_b32 s22, 21495808
  s_mov_b32 s23, 0x20000
  s_mov_b32 s8, s56
  s_mov_b32 s9, s57
  s_mov_b32 s10, 2097152
  s_mov_b32 s11, 0x20000
  s_mov_b32 s6, 256
  s_mov_b32 s7, 0x20000
  s_lshl_b32 s42, s29, 5
  s_add_u32 s42, s42, s30
  s_lshl_b32 s42, s42, 2
  s_add_u32 s42, s42, s28
  s_lshl_b32 s42, s42, 11
  buffer_load_dwordx4 v[192:195], v14, s[8:11], s42 offen offset:0
  buffer_load_dwordx4 v[196:199], v14, s[8:11], s42 offen offset:1024
  s_cmp_eq_u32 s31, 1
  s_cbranch_scc1 L_k1_pure
  s_waitcnt vmcnt(0)
  v_lshlrev_b32 v200, 16, v192
  v_and_b32 v201, 0xffff0000, v192
  v_lshlrev_b32 v202, 16, v193
  v_and_b32 v203, 0xffff0000, v193
  v_lshlrev_b32 v204, 16, v194
  v_and_b32 v205, 0xffff0000, v194
  v_lshlrev_b32 v206, 16, v195
  v_and_b32 v207, 0xffff0000, v195
  v_readfirstlane_b32 s40, v200
  s_nop 1
  v_subrev_f32 v200, s40, v200
  v_subrev_f32 v201, s40, v201
  v_subrev_f32 v202, s40, v202
  v_subrev_f32 v203, s40, v203
  v_subrev_f32 v204, s40, v204
  v_subrev_f32 v205, s40, v205
  v_subrev_f32 v206, s40, v206
  v_subrev_f32 v207, s40, v207
  v_add_f32 v208, v200, v201
  v_mul_f32 v209, v200, v200
  v_fmac_f32 v209, v201, v201
  v_add_f32 v208, v208, v202
  v_fmac_f32 v209, v202, v202
  v_add_f32 v208, v208, v203
  v_fmac_f32 v209, v203, v203
  v_add_f32 v208, v208, v204
  v_fmac_f32 v209, v204, v204
  v_add_f32 v208, v208, v205
  v_fmac_f32 v209, v205, v205
  v_add_f32 v208, v208, v206
  v_fmac_f32 v209, v206, v206
  v_add_f32 v208, v208, v207
  v_fmac_f32 v209, v207, v207
  s_nop 0
  v_add_f32_dpp v208, v208, v208 row_shr:1 row_mask:0xf bank_mask:0xf
  v_add_f32_dpp v209, v209, v209 row_shr:1 row_mask:0xf bank_mask:0xf
  s_nop 0
  v_add_f32_dpp v208, v208, v208 row_shr:2 row_mask:0xf bank_mask:0xf
  v_add_f32_dpp v209, v209, v209 row_shr:2 row_mask:0xf bank_mask:0xf
  s_nop 0
  v_add_f32_dpp v208, v208, v208 row_shr:4 row_mask:0xf bank_mask:0xf
  v_add_f32_dpp v209, v209, v209 row_shr:4 row_mask:0xf bank_mask:0xf
  s_nop 0
  v_add_f32_dpp v208, v208, v208 row_shr:8 row_mask:0xf bank_mask:0xf
  v_add_f32_dpp v209, v209, v209 row_shr:8 row_mask:0xf bank_mask:0xf
  s_nop 0
  v_add_f32_dpp v208, v208, v208 row_bcast:15 row_mask:0xa bank_mask:0xf
  v_add_f32_dpp v209, v209, v209 row_bcast:15 row_mask:0xa bank_mask:0xf
  s_nop 0
  v_add_f32_dpp v208, v208, v208 row_bcast:31 row_mask:0xc bank_mask:0xf
  v_add_f32_dpp v209, v209, v209 row_bcast:31 row_mask:0xc bank_mask:0xf
  v_mul_f32 v2, 0x3b000000, v208
  v_mul_f32 v3, 0x3b000000, v209
  v_fma_f32 v3, -v2, v2, v3
  v_max_f32 v3, 0, v3
  v_add_f32 v3, 0x3727c5ac, v3
  v_add_f32 v2, s40, v2
  v_lshlrev_b32 v200, 16, v196
  v_and_b32 v201, 0xffff0000, v196
  v_lshlrev_b32 v202, 16, v197
  v_and_b32 v203, 0xffff0000, v197
  v_lshlrev_b32 v204, 16, v198
  v_and_b32 v205, 0xffff0000, v198
  v_lshlrev_b32 v206, 16, v199
  v_and_b32 v207, 0xffff0000, v199
  v_readfirstlane_b32 s40, v200
  s_nop 1
  v_subrev_f32 v200, s40, v200
  v_subrev_f32 v201, s40, v201
  v_subrev_f32 v202, s40, v202
  v_subrev_f32 v203, s40, v203
  v_subrev_f32 v204, s40, v204
  v_subrev_f32 v205, s40, v205
  v_subrev_f32 v206, s40, v206
  v_subrev_f32 v207, s40, v207
  v_add_f32 v208, v200, v201
  v_mul_f32 v209, v200, v200
  v_fmac_f32 v209, v201, v201
  v_add_f32 v208, v208, v202
  v_fmac_f32 v209, v202, v202
  v_add_f32 v208, v208, v203
  v_fmac_f32 v209, v203, v203
  v_add_f32 v208, v208, v204
  v_fmac_f32 v209, v204, v204
  v_add_f32 v208, v208, v205
  v_fmac_f32 v209, v205, v205
  v_add_f32 v208, v208, v206
  v_fmac_f32 v209, v206, v206
  v_add_f32 v208, v208, v207
  v_fmac_f32 v209, v207, v207
  s_nop 0
  v_add_f32_dpp v208, v208, v208 row_shr:1 row_mask:0xf bank_mask:0xf
  v_add_f32_dpp v209, v209, v209 row_shr:1 row_mask:0xf bank_mask:0xf
  s_nop 0
  v_add_f32_dpp v208, v208, v208 row_shr:2 row_mask:0xf bank_mask:0xf
  v_add_f32_dpp v209, v209, v209 row_shr:2 row_mask:0xf bank_mask:0xf
  s_nop 0
  v_add_f32_dpp v208, v208, v208 row_shr:4 row_mask:0xf bank_mask:0xf
  v_add_f32_dpp v209, v209, v209 row_shr:4 row_mask:0xf bank_mask:0xf
  s_nop 0
  v_add_f32_dpp v208, v208, v208 row_shr:8 row_mask:0xf bank_mask:0xf
  v_add_f32_dpp v209, v209, v209 row_shr:8 row_mask:0xf bank_mask:0xf
  s_nop 0
  v_add_f32_dpp v208, v208, v208 row_bcast:15 row_mask:0xa bank_mask:0xf
  v_add_f32_dpp v209, v209, v209 row_bcast:15 row_mask:0xa bank_mask:0xf
  s_nop 0
  v_add_f32_dpp v208, v208, v208 row_bcast:31 row_mask:0xc bank_mask:0xf
  v_add_f32_dpp v209, v209, v209 row_bcast:31 row_mask:0xc bank_mask:0xf
  v_mul_f32 v4, 0x3b000000, v208
  v_mul_f32 v5, 0x3b000000, v209
  v_fma_f32 v5, -v4, v4, v5
  v_max_f32 v5, 0, v5
  v_add_f32 v5, 0x3727c5ac, v5
  v_add_f32 v4, s40, v4
  s_lshl_b32 s42, s29, 5
  s_add_u32 s42, s42, s30
  s_lshl_b32 s42, s42, 7
  s_lshl_b32 s43, s28, 4
  s_add_u32 s42, s42, s43
  s_add_u32 s42, s42, 20971520
  v_cmp_eq_u32 vcc, 63, v1
  v_mov_b32 v6, 0x7ffffff0
  s_nop 0
  v_cndmask_b32 v6, v6, 0, vcc
  buffer_store_dwordx4 v[2:5], v6, s[20:23], s42 offen sc1
  s_barrier
  ds_read_b128 v[176:179], v232 offset:0
  ds_read_b64_tr_b16 v[192:193], v240 offset:0
  ds_read_b64_tr_b16 v[194:195], v240 offset:256
  ds_read_b128 v[180:183], v232 offset:4096
  ds_read_b64_tr_b16 v[196:197], v240 offset:4096
  ds_read_b64_tr_b16 v[198:199], v240 offset:4352
  ds_read_b64_tr_b16 v[200:201], v240 offset:8192
  ds_read_b64_tr_b16 v[202:203], v240 offset:8448
  ds_read_b64_tr_b16 v[204:205], v240 offset:12288
  ds_read_b64_tr_b16 v[206:207], v240 offset:12544
  ds_read_b64_tr_b16 v[208:209], v240 offset:16384
  ds_read_b64_tr_b16 v[210:211], v240 offset:16640
  s_waitcnt lgkmcnt(9)
  v_mfma_f32_32x32x16_bf16 v[16:31], v[192:195], v[176:179], 0
  ds_read_b128 v[184:187], v233 offset:0
  ds_read_b64_tr_b16 v[212:213], v240 offset:1024
  ds_read_b64_tr_b16 v[214:215], v240 offset:1280
  s_waitcnt lgkmcnt(11)
  v_mfma_f32_32x32x16_bf16 v[32:47], v[192:195], v[180:183], 0
  ds_read_b128 v[188:191], v233 offset:4096
  ds_read_b64_tr_b16 v[216:217], v240 offset:5120
  s_waitcnt lgkmcnt(11)
  v_mfma_f32_32x32x16_bf16 v[48:63], v[196:199], v[176:179], 0
  ds_read_b64_tr_b16 v[218:219], v240 offset:5376
  ds_read_b64_tr_b16 v[220:221], v240 offset:9216
  v_mfma_f32_32x32x16_bf16 v[64:79], v[196:199], v[180:183], 0
  ds_read_b64_tr_b16 v[222:223], v240 offset:9472
  ds_read_b64_tr_b16 v[224:225], v240 offset:13312
  s_waitcnt lgkmcnt(13)
  v_mfma_f32_32x32x16_bf16 v[80:95], v[200:203], v[176:179], 0
  ds_read_b64_tr_b16 v[226:227], v240 offset:13568
  ds_read_b64_tr_b16 v[228:229], v240 offset:17408
  v_mfma_f32_32x32x16_bf16 v[96:111], v[200:203], v[180:183], 0
  ds_read_b64_tr_b16 v[230:231], v240 offset:17664
  s_waitcnt lgkmcnt(14)
  v_mfma_f32_32x32x16_bf16 v[112:127], v[204:207], v[176:179], 0
  v_mfma_f32_32x32x16_bf16 v[128:143], v[204:207], v[180:183], 0
  s_waitcnt lgkmcnt(12)
  v_mfma_f32_32x32x16_bf16 v[144:159], v[208:211], v[176:179], 0
  v_mfma_f32_32x32x16_bf16 v[160:175], v[208:211], v[180:183], 0
  s_waitcnt lgkmcnt(9)
  v_mfma_f32_32x32x16_bf16 v[16:31], v[212:215], v[184:187], v[16:31]
  ds_read_b128 v[176:179], v234 offset:0
  ds_read_b64_tr_b16 v[192:193], v240 offset:2048
  ds_read_b64_tr_b16 v[194:195], v240 offset:2304
  s_waitcnt lgkmcnt(11)
  v_mfma_f32_32x32x16_bf16 v[32:47], v[212:215], v[188:191], v[32:47]
  ds_read_b128 v[180:183], v234 offset:4096
  ds_read_b64_tr_b16 v[196:197], v240 offset:6144
  s_waitcnt lgkmcnt(11)
  v_mfma_f32_32x32x16_bf16 v[48:63], v[216:219], v[184:187], v[48:63]
  ds_read_b64_tr_b16 v[198:199], v240 offset:6400
  ds_read_b64_tr_b16 v[200:201], v240 offset:10240
  v_mfma_f32_32x32x16_bf16 v[64:79], v[216:219], v[188:191], v[64:79]
  ds_read_b64_tr_b16 v[202:203], v240 offset:10496
  ds_read_b64_tr_b16 v[204:205], v240 offset:14336
  s_waitcnt lgkmcnt(13)
  v_mfma_f32_32x32x16_bf16 v[80:95], v[220:223], v[184:187], v[80:95]
  ds_read_b64_tr_b16 v[206:207], v240 offset:14592
  ds_read_b64_tr_b16 v[208:209], v240 offset:18432
  v_mfma_f32_32x32x16_bf16 v[96:111], v[220:223], v[188:191], v[96:111]
  ds_read_b64_tr_b16 v[210:211], v240 offset:18688
  s_waitcnt lgkmcnt(14)
  v_mfma_f32_32x32x16_bf16 v[112:127], v[224:227], v[184:187], v[112:127]
  v_mfma_f32_32x32x16_bf16 v[128:143], v[224:227], v[188:191], v[128:143]
  s_waitcnt lgkmcnt(12)
  v_mfma_f32_32x32x16_bf16 v[144:159], v[228:231], v[184:187], v[144:159]
  v_mfma_f32_32x32x16_bf16 v[160:175], v[228:231], v[188:191], v[160:175]
  s_waitcnt lgkmcnt(9)
  v_mfma_f32_32x32x16_bf16 v[16:31], v[192:195], v[176:179], v[16:31]
  ds_read_b128 v[184:187], v235 offset:0
  ds_read_b64_tr_b16 v[212:213], v240 offset:3072
  ds_read_b64_tr_b16 v[214:215], v240 offset:3328
  s_waitcnt lgkmcnt(11)
  v_mfma_f32_32x32x16_bf16 v[32:47], v[192:195], v[180:183], v[32:47]
  ds_read_b128 v[188:191], v235 offset:4096
  ds_read_b64_tr_b16 v[216:217], v240 offset:7168
  s_waitcnt lgkmcnt(11)
  v_mfma_f32_32x32x16_bf16 v[48:63], v[196:199], v[176:179], v[48:63]
  ds_read_b64_tr_b16 v[218:219], v240 offset:7424
  ds_read_b64_tr_b16 v[220:221], v240 offset:11264
  v_mfma_f32_32x32x16_bf16 v[64:79], v[196:199], v[180:183], v[64:79]
  ds_read_b64_tr_b16 v[222:223], v240 offset:11520
  ds_read_b64_tr_b16 v[224:225], v240 offset:15360
  s_waitcnt lgkmcnt(13)
  v_mfma_f32_32x32x16_bf16 v[80:95], v[200:203], v[176:179], v[80:95]
  ds_read_b64_tr_b16 v[226:227], v240 offset:15616
  ds_read_b64_tr_b16 v[228:229], v240 offset:19456
  v_mfma_f32_32x32x16_bf16 v[96:111], v[200:203], v[180:183], v[96:111]
  ds_read_b64_tr_b16 v[230:231], v240 offset:19712
  s_waitcnt lgkmcnt(14)
  v_mfma_f32_32x32x16_bf16 v[112:127], v[204:207], v[176:179], v[112:127]
  v_mfma_f32_32x32x16_bf16 v[128:143], v[204:207], v[180:183], v[128:143]
  s_waitcnt lgkmcnt(12)
  v_mfma_f32_32x32x16_bf16 v[144:159], v[208:211], v[176:179], v[144:159]
  v_mfma_f32_32x32x16_bf16 v[160:175], v[208:211], v[180:183], v[160:175]
  s_waitcnt lgkmcnt(0)
  s_barrier
  v_mfma_f32_32x32x16_bf16 v[16:31], v[212:215], v[184:187], v[16:31]
  ds_read_b128 v[176:179], v232 offset:53248
  ds_read_b64_tr_b16 v[192:193], v241 offset:0
  ds_read_b64_tr_b16 v[194:195], v241 offset:256
  v_mfma_f32_32x32x16_bf16 v[32:47], v[212:215], v[188:191], v[32:47]
  ds_read_b128 v[180:183], v232 offset:57344
  ds_read_b64_tr_b16 v[196:197], v241 offset:4096
  v_mfma_f32_32x32x16_bf16 v[48:63], v[216:219], v[184:187], v[48:63]
  ds_read_b64_tr_b16 v[198:199], v241 offset:4352
  ds_read_b64_tr_b16 v[200:201], v241 offset:8192
  v_mfma_f32_32x32x16_bf16 v[64:79], v[216:219], v[188:191], v[64:79]
  ds_read_b64_tr_b16 v[202:203], v241 offset:8448
  ds_read_b64_tr_b16 v[204:205], v241 offset:12288
  v_mfma_f32_32x32x16_bf16 v[80:95], v[220:223], v[184:187], v[80:95]
  ds_read_b64_tr_b16 v[206:207], v241 offset:12544
  ds_read_b64_tr_b16 v[208:209], v241 offset:16384
  v_mfma_f32_32x32x16_bf16 v[96:111], v[220:223], v[188:191], v[96:111]
  ds_read_b64_tr_b16 v[210:211], v241 offset:16640
  v_mfma_f32_32x32x16_bf16 v[112:127], v[224:227], v[184:187], v[112:127]
  v_mfma_f32_32x32x16_bf16 v[128:143], v[224:227], v[188:191], v[128:143]
  v_mfma_f32_32x32x16_bf16 v[144:159], v[228:231], v[184:187], v[144:159]
  v_mfma_f32_32x32x16_bf16 v[160:175], v[228:231], v[188:191], v[160:175]
  s_waitcnt lgkmcnt(9)
  v_mfma_f32_32x32x16_bf16 v[16:31], v[192:195], v[176:179], v[16:31]
  ds_read_b128 v[184:187], v233 offset:53248
  ds_read_b64_tr_b16 v[212:213], v241 offset:1024
  ds_read_b64_tr_b16 v[214:215], v241 offset:1280
  s_waitcnt lgkmcnt(11)
  v_mfma_f32_32x32x16_bf16 v[32:47], v[192:195], v[180:183], v[32:47]
  ds_read_b128 v[188:191], v233 offset:57344
  ds_read_b64_tr_b16 v[216:217], v241 offset:5120
  s_waitcnt lgkmcnt(11)
  v_mfma_f32_32x32x16_bf16 v[48:63], v[196:199], v[176:179], v[48:63]
  ds_read_b64_tr_b16 v[218:219], v241 offset:5376
  ds_read_b64_tr_b16 v[220:221], v241 offset:9216
  v_mfma_f32_32x32x16_bf16 v[64:79], v[196:199], v[180:183], v[64:79]
  ds_read_b64_tr_b16 v[222:223], v241 offset:9472
  ds_read_b64_tr_b16 v[224:225], v241 offset:13312
  s_waitcnt lgkmcnt(13)
  v_mfma_f32_32x32x16_bf16 v[80:95], v[200:203], v[176:179], v[80:95]
  ds_read_b64_tr_b16 v[226:227], v241 offset:13568
  ds_read_b64_tr_b16 v[228:229], v241 offset:17408
  v_mfma_f32_32x32x16_bf16 v[96:111], v[200:203], v[180:183], v[96:111]
  ds_read_b64_tr_b16 v[230:231], v241 offset:17664
  s_waitcnt lgkmcnt(14)
  v_mfma_f32_32x32x16_bf16 v[112:127], v[204:207], v[176:179], v[112:127]
  v_mfma_f32_32x32x16_bf16 v[128:143], v[204:207], v[180:183], v[128:143]
  s_waitcnt lgkmcnt(12)
  v_mfma_f32_32x32x16_bf16 v[144:159], v[208:211], v[176:179], v[144:159]
  v_mfma_f32_32x32x16_bf16 v[160:175], v[208:211], v[180:183], v[160:175]
  s_waitcnt lgkmcnt(9)
  v_mfma_f32_32x32x16_bf16 v[16:31], v[212:215], v[184:187], v[16:31]
  ds_read_b128 v[176:179], v234 offset:53248
  ds_read_b64_tr_b16 v[192:193], v241 offset:2048
  ds_read_b64_tr_b16 v[194:195], v241 offset:2304
  s_waitcnt lgkmcnt(11)
  v_mfma_f32_32x32x16_bf16 v[32:47], v[212:215], v[188:191], v[32:47]
  ds_read_b128 v[180:183], v234 offset:57344
  ds_read_b64_tr_b16 v[196:197], v241 offset:6144
  s_waitcnt lgkmcnt(11)
  v_mfma_f32_32x32x16_bf16 v[48:63], v[216:219], v[184:187], v[48:63]
  ds_read_b64_tr_b16 v[198:199], v241 offset:6400
  ds_read_b64_tr_b16 v[200:201], v241 offset:10240
  v_mfma_f32_32x32x16_bf16 v[64:79], v[216:219], v[188:191], v[64:79]
  ds_read_b64_tr_b16 v[202:203], v241 offset:10496
  ds_read_b64_tr_b16 v[204:205], v241 offset:14336
  s_waitcnt lgkmcnt(13)
  v_mfma_f32_32x32x16_bf16 v[80:95], v[220:223], v[184:187], v[80:95]
  ds_read_b64_tr_b16 v[206:207], v241 offset:14592
  ds_read_b64_tr_b16 v[208:209], v241 offset:18432
  v_mfma_f32_32x32x16_bf16 v[96:111], v[220:223], v[188:191], v[96:111]
  ds_read_b64_tr_b16 v[210:211], v241 offset:18688
  s_waitcnt lgkmcnt(14)
  v_mfma_f32_32x32x16_bf16 v[112:127], v[224:227], v[184:187], v[112:127]
  v_mfma_f32_32x32x16_bf16 v[128:143], v[224:227], v[188:191], v[128:143]
  s_waitcnt lgkmcnt(12)
  v_mfma_f32_32x32x16_bf16 v[144:159], v[228:231], v[184:187], v[144:159]
  v_mfma_f32_32x32x16_bf16 v[160:175], v[228:231], v[188:191], v[160:175]
  s_waitcnt lgkmcnt(9)
  v_mfma_f32_32x32x16_bf16 v[16:31], v[192:195], v[176:179], v[16:31]
  ds_read_b128 v[184:187], v235 offset:53248
  ds_read_b64_tr_b16 v[212:213], v241 offset:3072
  ds_read_b64_tr_b16 v[214:215], v241 offset:3328
  s_waitcnt lgkmcnt(11)
  v_mfma_f32_32x32x16_bf16 v[32:47], v[192:195], v[180:183], v[32:47]
  ds_read_b128 v[188:191], v235 offset:57344
  ds_read_b64_tr_b16 v[216:217], v241 offset:7168
  s_waitcnt lgkmcnt(11)
  v_mfma_f32_32x32x16_bf16 v[48:63], v[196:199], v[176:179], v[48:63]
  ds_read_b64_tr_b16 v[218:219], v241 offset:7424
  ds_read_b64_tr_b16 v[220:221], v241 offset:11264
  v_mfma_f32_32x32x16_bf16 v[64:79], v[196:199], v[180:183], v[64:79]
  ds_read_b64_tr_b16 v[222:223], v241 offset:11520
  ds_read_b64_tr_b16 v[224:225], v241 offset:15360
  s_waitcnt lgkmcnt(13)
  v_mfma_f32_32x32x16_bf16 v[80:95], v[200:203], v[176:179], v[80:95]
  ds_read_b64_tr_b16 v[226:227], v241 offset:15616
  ds_read_b64_tr_b16 v[228:229], v241 offset:19456
  v_mfma_f32_32x32x16_bf16 v[96:111], v[200:203], v[180:183], v[96:111]
  ds_read_b64_tr_b16 v[230:231], v241 offset:19712
  s_waitcnt lgkmcnt(14)
  v_mfma_f32_32x32x16_bf16 v[112:127], v[204:207], v[176:179], v[112:127]
  v_mfma_f32_32x32x16_bf16 v[128:143], v[204:207], v[180:183], v[128:143]
  s_waitcnt lgkmcnt(12)
  v_mfma_f32_32x32x16_bf16 v[144:159], v[208:211], v[176:179], v[144:159]
  v_mfma_f32_32x32x16_bf16 v[160:175], v[208:211], v[180:183], v[160:175]
  s_waitcnt lgkmcnt(0)
  s_waitcnt vmcnt(0)
  s_barrier
  s_cmp_eq_u32 s28, 0
  s_cbranch_scc0 L_k1_sig_1
  s_lshl_b32 s47, s29, 2
  v_mov_b32 v2, 1
  v_cmp_eq_u32 vcc, 0, v1
  v_mov_b32 v3, 0x7ffffff0
  s_nop 0
  v_cndmask_b32 v3, v3, 0, vcc
  buffer_atomic_add v2, v3, s[4:7], s47 offen sc1
L_k1_sig_1:
  v_mfma_f32_32x32x16_bf16 v[16:31], v[212:215], v[184:187], v[16:31]
  ds_read_b128 v[176:179], v236 offset:0
  ds_read_b64_tr_b16 v[192:193], v242 offset:0
  ds_read_b64_tr_b16 v[194:195], v242 offset:256
  v_mfma_f32_32x32x16_bf16 v[32:47], v[212:215], v[188:191], v[32:47]
  ds_read_b128 v[180:183], v236 offset:4096
  ds_read_b64_tr_b16 v[196:197], v242 offset:4096
  v_mfma_f32_32x32x16_bf16 v[48:63], v[216:219], v[184:187], v[48:63]
  ds_read_b64_tr_b16 v[198:199], v242 offset:4352
  ds_read_b64_tr_b16 v[200:201], v242 offset:8192
  v_mfma_f32_32x32x16_bf16 v[64:79], v[216:219], v[188:191], v[64:79]
  ds_read_b64_tr_b16 v[202:203], v242 offset:8448
  ds_read_b64_tr_b16 v[204:205], v242 offset:12288
  v_mfma_f32_32x32x16_bf16 v[80:95], v[220:223], v[184:187], v[80:95]
  ds_read_b64_tr_b16 v[206:207], v242 offset:12544
  ds_read_b64_tr_b16 v[208:209], v242 offset:16384
  v_mfma_f32_32x32x16_bf16 v[96:111], v[220:223], v[188:191], v[96:111]
  ds_read_b64_tr_b16 v[210:211], v242 offset:16640
  v_mfma_f32_32x32x16_bf16 v[112:127], v[224:227], v[184:187], v[112:127]
  v_mfma_f32_32x32x16_bf16 v[128:143], v[224:227], v[188:191], v[128:143]
  v_mfma_f32_32x32x16_bf16 v[144:159], v[228:231], v[184:187], v[144:159]
  v_mfma_f32_32x32x16_bf16 v[160:175], v[228:231], v[188:191], v[160:175]
  s_waitcnt lgkmcnt(9)
  v_mfma_f32_32x32x16_bf16 v[16:31], v[192:195], v[176:179], v[16:31]
  ds_read_b128 v[184:187], v237 offset:0
  ds_read_b64_tr_b16 v[212:213], v242 offset:1024
  ds_read_b64_tr_b16 v[214:215], v242 offset:1280
  s_waitcnt lgkmcnt(11)
  v_mfma_f32_32x32x16_bf16 v[32:47], v[192:195], v[180:183], v[32:47]
  ds_read_b128 v[188:191], v237 offset:4096
  ds_read_b64_tr_b16 v[216:217], v242 offset:5120
  s_waitcnt lgkmcnt(11)
  v_mfma_f32_32x32x16_bf16 v[48:63], v[196:199], v[176:179], v[48:63]
  ds_read_b64_tr_b16 v[218:219], v242 offset:5376
  ds_read_b64_tr_b16 v[220:221], v242 offset:9216
  v_mfma_f32_32x32x16_bf16 v[64:79], v[196:199], v[180:183], v[64:79]
  ds_read_b64_tr_b16 v[222:223], v242 offset:9472
  ds_read_b64_tr_b16 v[224:225], v242 offset:13312
  s_waitcnt lgkmcnt(13)
  v_mfma_f32_32x32x16_bf16 v[80:95], v[200:203], v[176:179], v[80:95]
  ds_read_b64_tr_b16 v[226:227], v242 offset:13568
  ds_read_b64_tr_b16 v[228:229], v242 offset:17408
  v_mfma_f32_32x32x16_bf16 v[96:111], v[200:203], v[180:183], v[96:111]
  ds_read_b64_tr_b16 v[230:231], v242 offset:17664
  s_waitcnt lgkmcnt(14)
  v_mfma_f32_32x32x16_bf16 v[112:127], v[204:207], v[176:179], v[112:127]
  v_mfma_f32_32x32x16_bf16 v[128:143], v[204:207], v[180:183], v[128:143]
  s_waitcnt lgkmcnt(12)
  v_mfma_f32_32x32x16_bf16 v[144:159], v[208:211], v[176:179], v[144:159]
  v_mfma_f32_32x32x16_bf16 v[160:175], v[208:211], v[180:183], v[160:175]
  s_waitcnt lgkmcnt(9)
  v_mfma_f32_32x32x16_bf16 v[16:31], v[212:215], v[184:187], v[16:31]
  ds_read_b128 v[176:179], v238 offset:0
  ds_read_b64_tr_b16 v[192:193], v242 offset:2048
  ds_read_b64_tr_b16 v[194:195], v242 offset:2304
  s_waitcnt lgkmcnt(11)
  v_mfma_f32_32x32x16_bf16 v[32:47], v[212:215], v[188:191], v[32:47]
  ds_read_b128 v[180:183], v238 offset:4096
  ds_read_b64_tr_b16 v[196:197], v242 offset:6144
  s_waitcnt lgkmcnt(11)
  v_mfma_f32_32x32x16_bf16 v[48:63], v[216:219], v[184:187], v[48:63]
  ds_read_b64_tr_b16 v[198:199], v242 offset:6400
  ds_read_b64_tr_b16 v[200:201], v242 offset:10240
  v_mfma_f32_32x32x16_bf16 v[64:79], v[216:219], v[188:191], v[64:79]
  ds_read_b64_tr_b16 v[202:203], v242 offset:10496
  ds_read_b64_tr_b16 v[204:205], v242 offset:14336
  s_waitcnt lgkmcnt(13)
  v_mfma_f32_32x32x16_bf16 v[80:95], v[220:223], v[184:187], v[80:95]
  ds_read_b64_tr_b16 v[206:207], v242 offset:14592
  ds_read_b64_tr_b16 v[208:209], v242 offset:18432
  v_mfma_f32_32x32x16_bf16 v[96:111], v[220:223], v[188:191], v[96:111]
  ds_read_b64_tr_b16 v[210:211], v242 offset:18688
  s_waitcnt lgkmcnt(14)
  v_mfma_f32_32x32x16_bf16 v[112:127], v[224:227], v[184:187], v[112:127]
  v_mfma_f32_32x32x16_bf16 v[128:143], v[224:227], v[188:191], v[128:143]
  s_waitcnt lgkmcnt(12)
  v_mfma_f32_32x32x16_bf16 v[144:159], v[228:231], v[184:187], v[144:159]
  v_mfma_f32_32x32x16_bf16 v[160:175], v[228:231], v[188:191], v[160:175]
  s_waitcnt lgkmcnt(9)
  v_mfma_f32_32x32x16_bf16 v[16:31], v[192:195], v[176:179], v[16:31]
  ds_read_b128 v[184:187], v239 offset:0
  ds_read_b64_tr_b16 v[212:213], v242 offset:3072
  ds_read_b64_tr_b16 v[214:215], v242 offset:3328
  s_waitcnt lgkmcnt(11)
  v_mfma_f32_32x32x16_bf16 v[32:47], v[192:195], v[180:183], v[32:47]
  ds_read_b128 v[188:191], v239 offset:4096
  ds_read_b64_tr_b16 v[216:217], v242 offset:7168
  s_waitcnt lgkmcnt(11)
  v_mfma_f32_32x32x16_bf16 v[48:63], v[196:199], v[176:179], v[48:63]
  ds_read_b64_tr_b16 v[218:219], v242 offset:7424
  ds_read_b64_tr_b16 v[220:221], v242 offset:11264
  v_mfma_f32_32x32x16_bf16 v[64:79], v[196:199], v[180:183], v[64:79]
  ds_read_b64_tr_b16 v[222:223], v242 offset:11520
  ds_read_b64_tr_b16 v[224:225], v242 offset:15360
  s_waitcnt lgkmcnt(13)
  v_mfma_f32_32x32x16_bf16 v[80:95], v[200:203], v[176:179], v[80:95]
  ds_read_b64_tr_b16 v[226:227], v242 offset:15616
  ds_read_b64_tr_b16 v[228:229], v242 offset:19456
  v_mfma_f32_32x32x16_bf16 v[96:111], v[200:203], v[180:183], v[96:111]
  ds_read_b64_tr_b16 v[230:231], v242 offset:19712
  s_waitcnt lgkmcnt(14)
  v_mfma_f32_32x32x16_bf16 v[112:127], v[204:207], v[176:179], v[112:127]
  v_mfma_f32_32x32x16_bf16 v[128:143], v[204:207], v[180:183], v[128:143]
  s_waitcnt lgkmcnt(12)
  v_mfma_f32_32x32x16_bf16 v[144:159], v[208:211], v[176:179], v[144:159]
  v_mfma_f32_32x32x16_bf16 v[160:175], v[208:211], v[180:183], v[160:175]
  s_waitcnt lgkmcnt(0)
  s_barrier
  v_mfma_f32_32x32x16_bf16 v[16:31], v[212:215], v[184:187], v[16:31]
  ds_read_b128 v[176:179], v232 offset:0
  ds_read_b64_tr_b16 v[192:193], v240 offset:0
  ds_read_b64_tr_b16 v[194:195], v240 offset:256
  v_mfma_f32_32x32x16_bf16 v[32:47], v[212:215], v[188:191], v[32:47]
  ds_read_b128 v[180:183], v232 offset:4096
  ds_read_b64_tr_b16 v[196:197], v240 offset:4096
  v_mfma_f32_32x32x16_bf16 v[48:63], v[216:219], v[184:187], v[48:63]
  ds_read_b64_tr_b16 v[198:199], v240 offset:4352
  ds_read_b64_tr_b16 v[200:201], v240 offset:8192
  v_mfma_f32_32x32x16_bf16 v[64:79], v[216:219], v[188:191], v[64:79]
  ds_read_b64_tr_b16 v[202:203], v240 offset:8448
  ds_read_b64_tr_b16 v[204:205], v240 offset:12288
  v_mfma_f32_32x32x16_bf16 v[80:95], v[220:223], v[184:187], v[80:95]
  ds_read_b64_tr_b16 v[206:207], v240 offset:12544
  ds_read_b64_tr_b16 v[208:209], v240 offset:16384
  v_mfma_f32_32x32x16_bf16 v[96:111], v[220:223], v[188:191], v[96:111]
  ds_read_b64_tr_b16 v[210:211], v240 offset:16640
  v_mfma_f32_32x32x16_bf16 v[112:127], v[224:227], v[184:187], v[112:127]
  v_mfma_f32_32x32x16_bf16 v[128:143], v[224:227], v[188:191], v[128:143]
  v_mfma_f32_32x32x16_bf16 v[144:159], v[228:231], v[184:187], v[144:159]
  v_mfma_f32_32x32x16_bf16 v[160:175], v[228:231], v[188:191], v[160:175]
  s_waitcnt lgkmcnt(9)
  v_mfma_f32_32x32x16_bf16 v[16:31], v[192:195], v[176:179], v[16:31]
  ds_read_b128 v[184:187], v233 offset:0
  ds_read_b64_tr_b16 v[212:213], v240 offset:1024
  ds_read_b64_tr_b16 v[214:215], v240 offset:1280
  s_waitcnt lgkmcnt(11)
  v_mfma_f32_32x32x16_bf16 v[32:47], v[192:195], v[180:183], v[32:47]
  ds_read_b128 v[188:191], v233 offset:4096
  ds_read_b64_tr_b16 v[216:217], v240 offset:5120
  s_waitcnt lgkmcnt(11)
  v_mfma_f32_32x32x16_bf16 v[48:63], v[196:199], v[176:179], v[48:63]
  ds_read_b64_tr_b16 v[218:219], v240 offset:5376
  ds_read_b64_tr_b16 v[220:221], v240 offset:9216
  v_mfma_f32_32x32x16_bf16 v[64:79], v[196:199], v[180:183], v[64:79]
  ds_read_b64_tr_b16 v[222:223], v240 offset:9472
  ds_read_b64_tr_b16 v[224:225], v240 offset:13312
  s_waitcnt lgkmcnt(13)
  v_mfma_f32_32x32x16_bf16 v[80:95], v[200:203], v[176:179], v[80:95]
  ds_read_b64_tr_b16 v[226:227], v240 offset:13568
  ds_read_b64_tr_b16 v[228:229], v240 offset:17408
  v_mfma_f32_32x32x16_bf16 v[96:111], v[200:203], v[180:183], v[96:111]
  ds_read_b64_tr_b16 v[230:231], v240 offset:17664
  s_waitcnt lgkmcnt(14)
  v_mfma_f32_32x32x16_bf16 v[112:127], v[204:207], v[176:179], v[112:127]
  v_mfma_f32_32x32x16_bf16 v[128:143], v[204:207], v[180:183], v[128:143]
  s_waitcnt lgkmcnt(12)
  v_mfma_f32_32x32x16_bf16 v[144:159], v[208:211], v[176:179], v[144:159]
  v_mfma_f32_32x32x16_bf16 v[160:175], v[208:211], v[180:183], v[160:175]
  s_waitcnt lgkmcnt(9)
  v_mfma_f32_32x32x16_bf16 v[16:31], v[212:215], v[184:187], v[16:31]
  ds_read_b128 v[176:179], v234 offset:0
  ds_read_b64_tr_b16 v[192:193], v240 offset:2048
  ds_read_b64_tr_b16 v[194:195], v240 offset:2304
  s_waitcnt lgkmcnt(11)
  v_mfma_f32_32x32x16_bf16 v[32:47], v[212:215], v[188:191], v[32:47]
  ds_read_b128 v[180:183], v234 offset:4096
  ds_read_b64_tr_b16 v[196:197], v240 offset:6144
  s_waitcnt lgkmcnt(11)
  v_mfma_f32_32x32x16_bf16 v[48:63], v[216:219], v[184:187], v[48:63]
  ds_read_b64_tr_b16 v[198:199], v240 offset:6400
  ds_read_b64_tr_b16 v[200:201], v240 offset:10240
  v_mfma_f32_32x32x16_bf16 v[64:79], v[216:219], v[188:191], v[64:79]
  ds_read_b64_tr_b16 v[202:203], v240 offset:10496
  ds_read_b64_tr_b16 v[204:205], v240 offset:14336
  s_waitcnt lgkmcnt(13)
  v_mfma_f32_32x32x16_bf16 v[80:95], v[220:223], v[184:187], v[80:95]
  ds_read_b64_tr_b16 v[206:207], v240 offset:14592
  ds_read_b64_tr_b16 v[208:209], v240 offset:18432
  v_mfma_f32_32x32x16_bf16 v[96:111], v[220:223], v[188:191], v[96:111]
  ds_read_b64_tr_b16 v[210:211], v240 offset:18688
  s_waitcnt lgkmcnt(14)
  v_mfma_f32_32x32x16_bf16 v[112:127], v[224:227], v[184:187], v[112:127]
  v_mfma_f32_32x32x16_bf16 v[128:143], v[224:227], v[188:191], v[128:143]
  s_waitcnt lgkmcnt(12)
  v_mfma_f32_32x32x16_bf16 v[144:159], v[228:231], v[184:187], v[144:159]
  v_mfma_f32_32x32x16_bf16 v[160:175], v[228:231], v[188:191], v[160:175]
  s_waitcnt lgkmcnt(9)
  v_mfma_f32_32x32x16_bf16 v[16:31], v[192:195], v[176:179], v[16:31]
  ds_read_b128 v[184:187], v235 offset:0
  ds_read_b64_tr_b16 v[212:213], v240 offset:3072
  ds_read_b64_tr_b16 v[214:215], v240 offset:3328
  s_waitcnt lgkmcnt(11)
  v_mfma_f32_32x32x16_bf16 v[32:47], v[192:195], v[180:183], v[32:47]
  ds_read_b128 v[188:191], v235 offset:4096
  ds_read_b64_tr_b16 v[216:217], v240 offset:7168
  s_waitcnt lgkmcnt(11)
  v_mfma_f32_32x32x16_bf16 v[48:63], v[196:199], v[176:179], v[48:63]
  ds_read_b64_tr_b16 v[218:219], v240 offset:7424
  ds_read_b64_tr_b16 v[220:221], v240 offset:11264
  v_mfma_f32_32x32x16_bf16 v[64:79], v[196:199], v[180:183], v[64:79]
  ds_read_b64_tr_b16 v[222:223], v240 offset:11520
  ds_read_b64_tr_b16 v[224:225], v240 offset:15360
  s_waitcnt lgkmcnt(13)
  v_mfma_f32_32x32x16_bf16 v[80:95], v[200:203], v[176:179], v[80:95]
  ds_read_b64_tr_b16 v[226:227], v240 offset:15616
  ds_read_b64_tr_b16 v[228:229], v240 offset:19456
  v_mfma_f32_32x32x16_bf16 v[96:111], v[200:203], v[180:183], v[96:111]
  ds_read_b64_tr_b16 v[230:231], v240 offset:19712
  s_waitcnt lgkmcnt(14)
  v_mfma_f32_32x32x16_bf16 v[112:127], v[204:207], v[176:179], v[112:127]
  v_mfma_f32_32x32x16_bf16 v[128:143], v[204:207], v[180:183], v[128:143]
  s_waitcnt lgkmcnt(12)
  v_mfma_f32_32x32x16_bf16 v[144:159], v[208:211], v[176:179], v[144:159]
  v_mfma_f32_32x32x16_bf16 v[160:175], v[208:211], v[180:183], v[160:175]
  s_waitcnt lgkmcnt(0)
  s_barrier
  v_and_b32 v2, 7, v1
  v_lshlrev_b32 v249, 2, v2
  v_mov_b32 v250, 32
  v_mov_b32 v248, 0
  s_cmp_eq_u32 s28, 0
  s_cbranch_scc0 L_k1_pi_2
  buffer_load_dword v248, v249, s[4:7], 0 offen sc1
L_k1_pi_2:
  v_mfma_f32_32x32x16_bf16 v[16:31], v[212:215], v[184:187], v[16:31]
  ds_read_b128 v[176:179], v232 offset:53248
  ds_read_b64_tr_b16 v[192:193], v241 offset:0
  ds_read_b64_tr_b16 v[194:195], v241 offset:256
  v_mfma_f32_32x32x16_bf16 v[32:47], v[212:215], v[188:191], v[32:47]
  ds_read_b128 v[180:183], v232 offset:57344
  ds_read_b64_tr_b16 v[196:197], v241 offset:4096
  v_mfma_f32_32x32x16_bf16 v[48:63], v[216:219], v[184:187], v[48:63]
  ds_read_b64_tr_b16 v[198:199], v241 offset:4352
  ds_read_b64_tr_b16 v[200:201], v241 offset:8192
  v_mfma_f32_32x32x16_bf16 v[64:79], v[216:219], v[188:191], v[64:79]
  ds_read_b64_tr_b16 v[202:203], v241 offset:8448
  ds_read_b64_tr_b16 v[204:205], v241 offset:12288
  v_mfma_f32_32x32x16_bf16 v[80:95], v[220:223], v[184:187], v[80:95]
  ds_read_b64_tr_b16 v[206:207], v241 offset:12544
  ds_read_b64_tr_b16 v[208:209], v241 offset:16384
  v_mfma_f32_32x32x16_bf16 v[96:111], v[220:223], v[188:191], v[96:111]
  ds_read_b64_tr_b16 v[210:211], v241 offset:16640
  v_mfma_f32_32x32x16_bf16 v[112:127], v[224:227], v[184:187], v[112:127]
  v_mfma_f32_32x32x16_bf16 v[128:143], v[224:227], v[188:191], v[128:143]
  v_mfma_f32_32x32x16_bf16 v[144:159], v[228:231], v[184:187], v[144:159]
  v_mfma_f32_32x32x16_bf16 v[160:175], v[228:231], v[188:191], v[160:175]
  s_waitcnt lgkmcnt(9)
  v_mfma_f32_32x32x16_bf16 v[16:31], v[192:195], v[176:179], v[16:31]
  ds_read_b128 v[184:187], v233 offset:53248
  ds_read_b64_tr_b16 v[212:213], v241 offset:1024
  ds_read_b64_tr_b16 v[214:215], v241 offset:1280
  s_waitcnt lgkmcnt(11)
  v_mfma_f32_32x32x16_bf16 v[32:47], v[192:195], v[180:183], v[32:47]
  ds_read_b128 v[188:191], v233 offset:57344
  ds_read_b64_tr_b16 v[216:217], v241 offset:5120
  s_waitcnt lgkmcnt(11)
  v_mfma_f32_32x32x16_bf16 v[48:63], v[196:199], v[176:179], v[48:63]
  ds_read_b64_tr_b16 v[218:219], v241 offset:5376
  ds_read_b64_tr_b16 v[220:221], v241 offset:9216
  v_mfma_f32_32x32x16_bf16 v[64:79], v[196:199], v[180:183], v[64:79]
  ds_read_b64_tr_b16 v[222:223], v241 offset:9472
  ds_read_b64_tr_b16 v[224:225], v241 offset:13312
  s_waitcnt lgkmcnt(13)
  v_mfma_f32_32x32x16_bf16 v[80:95], v[200:203], v[176:179], v[80:95]
  ds_read_b64_tr_b16 v[226:227], v241 offset:13568
  ds_read_b64_tr_b16 v[228:229], v241 offset:17408
  v_mfma_f32_32x32x16_bf16 v[96:111], v[200:203], v[180:183], v[96:111]
  ds_read_b64_tr_b16 v[230:231], v241 offset:17664
  s_waitcnt lgkmcnt(14)
  v_mfma_f32_32x32x16_bf16 v[112:127], v[204:207], v[176:179], v[112:127]
  v_mfma_f32_32x32x16_bf16 v[128:143], v[204:207], v[180:183], v[128:143]
  s_waitcnt lgkmcnt(12)
  v_mfma_f32_32x32x16_bf16 v[144:159], v[208:211], v[176:179], v[144:159]
  v_mfma_f32_32x32x16_bf16 v[160:175], v[208:211], v[180:183], v[160:175]
  s_waitcnt lgkmcnt(9)
  v_mfma_f32_32x32x16_bf16 v[16:31], v[212:215], v[184:187], v[16:31]
  ds_read_b128 v[176:179], v234 offset:53248
  ds_read_b64_tr_b16 v[192:193], v241 offset:2048
  ds_read_b64_tr_b16 v[194:195], v241 offset:2304
  s_waitcnt lgkmcnt(11)
  v_mfma_f32_32x32x16_bf16 v[32:47], v[212:215], v[188:191], v[32:47]
  ds_read_b128 v[180:183], v234 offset:57344
  ds_read_b64_tr_b16 v[196:197], v241 offset:6144
  s_waitcnt lgkmcnt(11)
  v_mfma_f32_32x32x16_bf16 v[48:63], v[216:219], v[184:187], v[48:63]
  ds_read_b64_tr_b16 v[198:199], v241 offset:6400
  ds_read_b64_tr_b16 v[200:201], v241 offset:10240
  v_mfma_f32_32x32x16_bf16 v[64:79], v[216:219], v[188:191], v[64:79]
  ds_read_b64_tr_b16 v[202:203], v241 offset:10496
  ds_read_b64_tr_b16 v[204:205], v241 offset:14336
  s_waitcnt lgkmcnt(13)
  v_mfma_f32_32x32x16_bf16 v[80:95], v[220:223], v[184:187], v[80:95]
  ds_read_b64_tr_b16 v[206:207], v241 offset:14592
  ds_read_b64_tr_b16 v[208:209], v241 offset:18432
  v_mfma_f32_32x32x16_bf16 v[96:111], v[220:223], v[188:191], v[96:111]
  ds_read_b64_tr_b16 v[210:211], v241 offset:18688
  s_waitcnt lgkmcnt(14)
  v_mfma_f32_32x32x16_bf16 v[112:127], v[224:227], v[184:187], v[112:127]
  v_mfma_f32_32x32x16_bf16 v[128:143], v[224:227], v[188:191], v[128:143]
  s_waitcnt lgkmcnt(12)
  v_mfma_f32_32x32x16_bf16 v[144:159], v[228:231], v[184:187], v[144:159]
  v_mfma_f32_32x32x16_bf16 v[160:175], v[228:231], v[188:191], v[160:175]
  s_waitcnt lgkmcnt(9)
  v_mfma_f32_32x32x16_bf16 v[16:31], v[192:195], v[176:179], v[16:31]
  ds_read_b128 v[184:187], v235 offset:53248
  ds_read_b64_tr_b16 v[212:213], v241 offset:3072
  ds_read_b64_tr_b16 v[214:215], v241 offset:3328
  s_waitcnt lgkmcnt(11)
  v_mfma_f32_32x32x16_bf16 v[32:47], v[192:195], v[180:183], v[32:47]
  ds_read_b128 v[188:191], v235 offset:57344
  ds_read_b64_tr_b16 v[216:217], v241 offset:7168
  s_waitcnt lgkmcnt(11)
  v_mfma_f32_32x32x16_bf16 v[48:63], v[196:199], v[176:179], v[48:63]
  ds_read_b64_tr_b16 v[218:219], v241 offset:7424
  ds_read_b64_tr_b16 v[220:221], v241 offset:11264
  v_mfma_f32_32x32x16_bf16 v[64:79], v[196:199], v[180:183], v[64:79]
  ds_read_b64_tr_b16 v[222:223], v241 offset:11520
  ds_read_b64_tr_b16 v[224:225], v241 offset:15360
  s_waitcnt lgkmcnt(13)
  v_mfma_f32_32x32x16_bf16 v[80:95], v[200:203], v[176:179], v[80:95]
  ds_read_b64_tr_b16 v[226:227], v241 offset:15616
  ds_read_b64_tr_b16 v[228:229], v241 offset:19456
  v_mfma_f32_32x32x16_bf16 v[96:111], v[200:203], v[180:183], v[96:111]
  ds_read_b64_tr_b16 v[230:231], v241 offset:19712
  s_waitcnt lgkmcnt(14)
  v_mfma_f32_32x32x16_bf16 v[112:127], v[204:207], v[176:179], v[112:127]
  v_mfma_f32_32x32x16_bf16 v[128:143], v[204:207], v[180:183], v[128:143]
  s_waitcnt lgkmcnt(12)
  v_mfma_f32_32x32x16_bf16 v[144:159], v[208:211], v[176:179], v[144:159]
  v_mfma_f32_32x32x16_bf16 v[160:175], v[208:211], v[180:183], v[160:175]
  s_waitcnt lgkmcnt(0)
  s_waitcnt vmcnt(0)
  s_cmp_eq_u32 s28, 0
  s_cbranch_scc0 L_k1_rdy_3
  v_cmp_ge_u32 vcc, v248, v250
  s_nop 3
  s_cmp_eq_u64 vcc, exec
  s_cbranch_scc1 L_k1_rdy_3
  s_mov_b32 s46, 0
L_k1_spin_4:
  s_sleep 8
  buffer_load_dword v248, v249, s[4:7], 0 offen sc1
  s_waitcnt vmcnt(0)
  v_cmp_ge_u32 vcc, v248, v250
  s_nop 3
  s_cmp_eq_u64 vcc, exec
  s_cbranch_scc1 L_k1_rdy_3
  s_add_u32 s46, s46, 1
  s_cmp_lt_u32 s46, 262144
  s_cbranch_scc1 L_k1_spin_4
L_k1_rdy_3:
  s_barrier
  v_and_b32 v2, 31, v1
  v_lshrrev_b32 v3, 3, v2
  v_lshlrev_b32 v3, 7, v3
  v_and_b32 v2, 7, v2
  v_lshl_add_u32 v3, v2, 3, v3
  s_lshl_b32 s42, s29, 5
  s_lshl_b32 s43, s28, 3
  s_add_u32 s42, s42, s43
  s_lshl_b32 s42, s42, 7
  s_add_u32 s42, s42, 20971520
  buffer_load_dwordx2 v[244:245], v3, s[20:23], s42 offen offset:0 sc1
  buffer_load_dwordx2 v[246:247], v3, s[20:23], s42 offen offset:512 sc1
  v_mfma_f32_32x32x16_bf16 v[16:31], v[212:215], v[184:187], v[16:31]
  ds_read_b128 v[176:179], v236 offset:0
  ds_read_b64_tr_b16 v[192:193], v242 offset:0
  ds_read_b64_tr_b16 v[194:195], v242 offset:256
  v_mfma_f32_32x32x16_bf16 v[32:47], v[212:215], v[188:191], v[32:47]
  ds_read_b128 v[180:183], v236 offset:4096
  ds_read_b64_tr_b16 v[196:197], v242 offset:4096
  v_mfma_f32_32x32x16_bf16 v[48:63], v[216:219], v[184:187], v[48:63]
  ds_read_b64_tr_b16 v[198:199], v242 offset:4352
  ds_read_b64_tr_b16 v[200:201], v242 offset:8192
  v_mfma_f32_32x32x16_bf16 v[64:79], v[216:219], v[188:191], v[64:79]
  ds_read_b64_tr_b16 v[202:203], v242 offset:8448
  ds_read_b64_tr_b16 v[204:205], v242 offset:12288
  v_mfma_f32_32x32x16_bf16 v[80:95], v[220:223], v[184:187], v[80:95]
  ds_read_b64_tr_b16 v[206:207], v242 offset:12544
  ds_read_b64_tr_b16 v[208:209], v242 offset:16384
  v_mfma_f32_32x32x16_bf16 v[96:111], v[220:223], v[188:191], v[96:111]
  ds_read_b64_tr_b16 v[210:211], v242 offset:16640
  v_mfma_f32_32x32x16_bf16 v[112:127], v[224:227], v[184:187], v[112:127]
  v_mfma_f32_32x32x16_bf16 v[128:143], v[224:227], v[188:191], v[128:143]
  v_mfma_f32_32x32x16_bf16 v[144:159], v[228:231], v[184:187], v[144:159]
  v_mfma_f32_32x32x16_bf16 v[160:175], v[228:231], v[188:191], v[160:175]
  s_waitcnt lgkmcnt(9)
  v_mfma_f32_32x32x16_bf16 v[16:31], v[192:195], v[176:179], v[16:31]
  ds_read_b128 v[184:187], v237 offset:0
  ds_read_b64_tr_b16 v[212:213], v242 offset:1024
  ds_read_b64_tr_b16 v[214:215], v242 offset:1280
  s_waitcnt lgkmcnt(11)
  v_mfma_f32_32x32x16_bf16 v[32:47], v[192:195], v[180:183], v[32:47]
  ds_read_b128 v[188:191], v237 offset:4096
  ds_read_b64_tr_b16 v[216:217], v242 offset:5120
  s_waitcnt lgkmcnt(11)
  v_mfma_f32_32x32x16_bf16 v[48:63], v[196:199], v[176:179], v[48:63]
  ds_read_b64_tr_b16 v[218:219], v242 offset:5376
  ds_read_b64_tr_b16 v[220:221], v242 offset:9216
  v_mfma_f32_32x32x16_bf16 v[64:79], v[196:199], v[180:183], v[64:79]
  ds_read_b64_tr_b16 v[222:223], v242 offset:9472
  ds_read_b64_tr_b16 v[224:225], v242 offset:13312
  s_waitcnt lgkmcnt(13)
  v_mfma_f32_32x32x16_bf16 v[80:95], v[200:203], v[176:179], v[80:95]
  ds_read_b64_tr_b16 v[226:227], v242 offset:13568
  ds_read_b64_tr_b16 v[228:229], v242 offset:17408
  v_mfma_f32_32x32x16_bf16 v[96:111], v[200:203], v[180:183], v[96:111]
  ds_read_b64_tr_b16 v[230:231], v242 offset:17664
  s_waitcnt lgkmcnt(14)
  v_mfma_f32_32x32x16_bf16 v[112:127], v[204:207], v[176:179], v[112:127]
  v_mfma_f32_32x32x16_bf16 v[128:143], v[204:207], v[180:183], v[128:143]
  s_waitcnt lgkmcnt(12)
  v_mfma_f32_32x32x16_bf16 v[144:159], v[208:211], v[176:179], v[144:159]
  v_mfma_f32_32x32x16_bf16 v[160:175], v[208:211], v[180:183], v[160:175]
  s_waitcnt lgkmcnt(9)
  v_mfma_f32_32x32x16_bf16 v[16:31], v[212:215], v[184:187], v[16:31]
  ds_read_b128 v[176:179], v238 offset:0
  ds_read_b64_tr_b16 v[192:193], v242 offset:2048
  ds_read_b64_tr_b16 v[194:195], v242 offset:2304
  s_waitcnt lgkmcnt(11)
  v_mfma_f32_32x32x16_bf16 v[32:47], v[212:215], v[188:191], v[32:47]
  ds_read_b128 v[180:183], v238 offset:4096
  ds_read_b64_tr_b16 v[196:197], v242 offset:6144
  s_waitcnt lgkmcnt(11)
  v_mfma_f32_32x32x16_bf16 v[48:63], v[216:219], v[184:187], v[48:63]
  ds_read_b64_tr_b16 v[198:199], v242 offset:6400
  ds_read_b64_tr_b16 v[200:201], v242 offset:10240
  v_mfma_f32_32x32x16_bf16 v[64:79], v[216:219], v[188:191], v[64:79]
  ds_read_b64_tr_b16 v[202:203], v242 offset:10496
  ds_read_b64_tr_b16 v[204:205], v242 offset:14336
  s_waitcnt lgkmcnt(13)
  v_mfma_f32_32x32x16_bf16 v[80:95], v[220:223], v[184:187], v[80:95]
  ds_read_b64_tr_b16 v[206:207], v242 offset:14592
  ds_read_b64_tr_b16 v[208:209], v242 offset:18432
  v_mfma_f32_32x32x16_bf16 v[96:111], v[220:223], v[188:191], v[96:111]
  ds_read_b64_tr_b16 v[210:211], v242 offset:18688
  s_waitcnt lgkmcnt(14)
  v_mfma_f32_32x32x16_bf16 v[112:127], v[224:227], v[184:187], v[112:127]
  v_mfma_f32_32x32x16_bf16 v[128:143], v[224:227], v[188:191], v[128:143]
  s_waitcnt lgkmcnt(12)
  v_mfma_f32_32x32x16_bf16 v[144:159], v[228:231], v[184:187], v[144:159]
  v_mfma_f32_32x32x16_bf16 v[160:175], v[228:231], v[188:191], v[160:175]
  s_waitcnt lgkmcnt(9)
  v_mfma_f32_32x32x16_bf16 v[16:31], v[192:195], v[176:179], v[16:31]
  ds_read_b128 v[184:187], v239 offset:0
  ds_read_b64_tr_b16 v[212:213], v242 offset:3072
  ds_read_b64_tr_b16 v[214:215], v242 offset:3328
  s_waitcnt lgkmcnt(11)
  v_mfma_f32_32x32x16_bf16 v[32:47], v[192:195], v[180:183], v[32:47]
  ds_read_b128 v[188:191], v239 offset:4096
  ds_read_b64_tr_b16 v[216:217], v242 offset:7168
  s_waitcnt lgkmcnt(11)
  v_mfma_f32_32x32x16_bf16 v[48:63], v[196:199], v[176:179], v[48:63]
  ds_read_b64_tr_b16 v[218:219], v242 offset:7424
  ds_read_b64_tr_b16 v[220:221], v242 offset:11264
  v_mfma_f32_32x32x16_bf16 v[64:79], v[196:199], v[180:183], v[64:79]
  ds_read_b64_tr_b16 v[222:223], v242 offset:11520
  ds_read_b64_tr_b16 v[224:225], v242 offset:15360
  s_waitcnt lgkmcnt(13)
  v_mfma_f32_32x32x16_bf16 v[80:95], v[200:203], v[176:179], v[80:95]
  ds_read_b64_tr_b16 v[226:227], v242 offset:15616
  ds_read_b64_tr_b16 v[228:229], v242 offset:19456
  v_mfma_f32_32x32x16_bf16 v[96:111], v[200:203], v[180:183], v[96:111]
  ds_read_b64_tr_b16 v[230:231], v242 offset:19712
  s_waitcnt lgkmcnt(14)
  v_mfma_f32_32x32x16_bf16 v[112:127], v[204:207], v[176:179], v[112:127]
  v_mfma_f32_32x32x16_bf16 v[128:143], v[204:207], v[180:183], v[128:143]
  s_waitcnt lgkmcnt(12)
  v_mfma_f32_32x32x16_bf16 v[144:159], v[208:211], v[176:179], v[144:159]
  v_mfma_f32_32x32x16_bf16 v[160:175], v[208:211], v[180:183], v[160:175]
  s_waitcnt lgkmcnt(0)
  s_barrier
  v_mfma_f32_32x32x16_bf16 v[16:31], v[212:215], v[184:187], v[16:31]
  ds_read_b128 v[176:179], v232 offset:0
  ds_read_b64_tr_b16 v[192:193], v240 offset:0
  ds_read_b64_tr_b16 v[194:195], v240 offset:256
  v_mfma_f32_32x32x16_bf16 v[32:47], v[212:215], v[188:191], v[32:47]
  ds_read_b128 v[180:183], v232 offset:4096
  ds_read_b64_tr_b16 v[196:197], v240 offset:4096
  v_mfma_f32_32x32x16_bf16 v[48:63], v[216:219], v[184:187], v[48:63]
  ds_read_b64_tr_b16 v[198:199], v240 offset:4352
  ds_read_b64_tr_b16 v[200:201], v240 offset:8192
  v_mfma_f32_32x32x16_bf16 v[64:79], v[216:219], v[188:191], v[64:79]
  ds_read_b64_tr_b16 v[202:203], v240 offset:8448
  ds_read_b64_tr_b16 v[204:205], v240 offset:12288
  v_mfma_f32_32x32x16_bf16 v[80:95], v[220:223], v[184:187], v[80:95]
  ds_read_b64_tr_b16 v[206:207], v240 offset:12544
  ds_read_b64_tr_b16 v[208:209], v240 offset:16384
  v_mfma_f32_32x32x16_bf16 v[96:111], v[220:223], v[188:191], v[96:111]
  ds_read_b64_tr_b16 v[210:211], v240 offset:16640
  v_mfma_f32_32x32x16_bf16 v[112:127], v[224:227], v[184:187], v[112:127]
  v_mfma_f32_32x32x16_bf16 v[128:143], v[224:227], v[188:191], v[128:143]
  v_mfma_f32_32x32x16_bf16 v[144:159], v[228:231], v[184:187], v[144:159]
  v_mfma_f32_32x32x16_bf16 v[160:175], v[228:231], v[188:191], v[160:175]
  s_waitcnt lgkmcnt(9)
  v_mfma_f32_32x32x16_bf16 v[16:31], v[192:195], v[176:179], v[16:31]
  ds_read_b128 v[184:187], v233 offset:0
  ds_read_b64_tr_b16 v[212:213], v240 offset:1024
  ds_read_b64_tr_b16 v[214:215], v240 offset:1280
  s_waitcnt lgkmcnt(11)
  v_mfma_f32_32x32x16_bf16 v[32:47], v[192:195], v[180:183], v[32:47]
  ds_read_b128 v[188:191], v233 offset:4096
  ds_read_b64_tr_b16 v[216:217], v240 offset:5120
  s_waitcnt lgkmcnt(11)
  v_mfma_f32_32x32x16_bf16 v[48:63], v[196:199], v[176:179], v[48:63]
  ds_read_b64_tr_b16 v[218:219], v240 offset:5376
  ds_read_b64_tr_b16 v[220:221], v240 offset:9216
  v_mfma_f32_32x32x16_bf16 v[64:79], v[196:199], v[180:183], v[64:79]
  ds_read_b64_tr_b16 v[222:223], v240 offset:9472
  ds_read_b64_tr_b16 v[224:225], v240 offset:13312
  s_waitcnt lgkmcnt(13)
  v_mfma_f32_32x32x16_bf16 v[80:95], v[200:203], v[176:179], v[80:95]
  ds_read_b64_tr_b16 v[226:227], v240 offset:13568
  ds_read_b64_tr_b16 v[228:229], v240 offset:17408
  v_mfma_f32_32x32x16_bf16 v[96:111], v[200:203], v[180:183], v[96:111]
  ds_read_b64_tr_b16 v[230:231], v240 offset:17664
  s_waitcnt vmcnt(0)
  v_cmp_gt_u32 vcc, 32, v1
  s_waitcnt lgkmcnt(14)
  v_mfma_f32_32x32x16_bf16 v[112:127], v[204:207], v[176:179], v[112:127]
  v_sub_f32 v15, 0, v244
  v_cndmask_b32 v15, 0, v15, vcc
  v_mfma_f32_32x32x16_bf16 v[128:143], v[204:207], v[180:183], v[128:143]
  v_cvt_pk_bf16_f32 v2, v15, v15
  v_mov_b32 v4, 0
  s_waitcnt lgkmcnt(12)
  v_mfma_f32_32x32x16_bf16 v[144:159], v[208:211], v[176:179], v[144:159]
  v_and_b32 v5, 0xffff0000, v2
  v_sub_f32 v15, v15, v5
  v_mfma_f32_32x32x16_bf16 v[160:175], v[208:211], v[180:183], v[160:175]
  v_cvt_pk_bf16_f32 v3, v15, v15
  v_mov_b32 v5, 0
  s_waitcnt lgkmcnt(9)
  v_mfma_f32_32x32x16_bf16 v[16:31], v[212:215], v[184:187], v[16:31]
  ds_read_b128 v[176:179], v234 offset:0
  ds_read_b64_tr_b16 v[192:193], v240 offset:2048
  ds_read_b64_tr_b16 v[194:195], v240 offset:2304
  s_waitcnt lgkmcnt(11)
  v_mfma_f32_32x32x16_bf16 v[32:47], v[212:215], v[188:191], v[32:47]
  ds_read_b128 v[180:183], v234 offset:4096
  ds_read_b64_tr_b16 v[196:197], v240 offset:6144
  s_waitcnt lgkmcnt(11)
  v_mfma_f32_32x32x16_bf16 v[48:63], v[216:219], v[184:187], v[48:63]
  ds_read_b64_tr_b16 v[198:199], v240 offset:6400
  ds_read_b64_tr_b16 v[200:201], v240 offset:10240
  v_mfma_f32_32x32x16_bf16 v[64:79], v[216:219], v[188:191], v[64:79]
  ds_read_b64_tr_b16 v[202:203], v240 offset:10496
  ds_read_b64_tr_b16 v[204:205], v240 offset:14336
  s_waitcnt lgkmcnt(13)
  v_mfma_f32_32x32x16_bf16 v[80:95], v[220:223], v[184:187], v[80:95]
  ds_read_b64_tr_b16 v[206:207], v240 offset:14592
  ds_read_b64_tr_b16 v[208:209], v240 offset:18432
  v_mfma_f32_32x32x16_bf16 v[96:111], v[220:223], v[188:191], v[96:111]
  ds_read_b64_tr_b16 v[210:211], v240 offset:18688
  v_mov_b32 v10, v245
  v_rsq_f32 v12, v245
  s_waitcnt lgkmcnt(14)
  v_mfma_f32_32x32x16_bf16 v[112:127], v[224:227], v[184:187], v[112:127]
  v_sub_f32 v15, 0, v246
  v_cndmask_b32 v15, 0, v15, vcc
  v_mfma_f32_32x32x16_bf16 v[128:143], v[224:227], v[188:191], v[128:143]
  v_cvt_pk_bf16_f32 v6, v15, v15
  v_mov_b32 v8, 0
  s_waitcnt lgkmcnt(12)
  v_mfma_f32_32x32x16_bf16 v[144:159], v[228:231], v[184:187], v[144:159]
  v_and_b32 v9, 0xffff0000, v6
  v_sub_f32 v15, v15, v9
  v_mfma_f32_32x32x16_bf16 v[160:175], v[228:231], v[188:191], v[160:175]
  v_cvt_pk_bf16_f32 v7, v15, v15
  v_mov_b32 v9, 0
  s_waitcnt lgkmcnt(9)
  v_mfma_f32_32x32x16_bf16 v[16:31], v[192:195], v[176:179], v[16:31]
  ds_read_b128 v[184:187], v235 offset:0
  ds_read_b64_tr_b16 v[212:213], v240 offset:3072
  ds_read_b64_tr_b16 v[214:215], v240 offset:3328
  s_waitcnt lgkmcnt(11)
  v_mfma_f32_32x32x16_bf16 v[32:47], v[192:195], v[180:183], v[32:47]
  ds_read_b128 v[188:191], v235 offset:4096
  ds_read_b64_tr_b16 v[216:217], v240 offset:7168
  s_waitcnt lgkmcnt(11)
  v_mfma_f32_32x32x16_bf16 v[48:63], v[196:199], v[176:179], v[48:63]
  ds_read_b64_tr_b16 v[218:219], v240 offset:7424
  ds_read_b64_tr_b16 v[220:221], v240 offset:11264
  v_mfma_f32_32x32x16_bf16 v[64:79], v[196:199], v[180:183], v[64:79]
  ds_read_b64_tr_b16 v[222:223], v240 offset:11520
  ds_read_b64_tr_b16 v[224:225], v240 offset:15360
  s_waitcnt lgkmcnt(13)
  v_mfma_f32_32x32x16_bf16 v[80:95], v[200:203], v[176:179], v[80:95]
  ds_read_b64_tr_b16 v[226:227], v240 offset:15616
  ds_read_b64_tr_b16 v[228:229], v240 offset:19456
  v_mfma_f32_32x32x16_bf16 v[96:111], v[200:203], v[180:183], v[96:111]
  ds_read_b64_tr_b16 v[230:231], v240 offset:19712
  v_mov_b32 v11, v247
  v_rsq_f32 v13, v247
  s_waitcnt lgkmcnt(14)
  v_mfma_f32_32x32x16_bf16 v[112:127], v[204:207], v[176:179], v[112:127]
  v_mfma_f32_32x32x16_bf16 v[128:143], v[204:207], v[180:183], v[128:143]
  s_waitcnt lgkmcnt(12)
  v_mfma_f32_32x32x16_bf16 v[144:159], v[208:211], v[176:179], v[144:159]
  v_mfma_f32_32x32x16_bf16 v[160:175], v[208:211], v[180:183], v[160:175]
  s_waitcnt lgkmcnt(0)
  s_barrier
  v_mfma_f32_32x32x16_bf16 v[16:31], v[212:215], v[184:187], v[16:31]
  ds_read_b128 v[176:179], v232 offset:53248
  ds_read_b128 v[180:183], v232 offset:57344
  ds_read_b64_tr_b16 v[192:193], v241 offset:16384
  v_mfma_f32_32x32x16_bf16 v[32:47], v[212:215], v[188:191], v[32:47]
  ds_read_b64_tr_b16 v[194:195], v241 offset:16640
  v_mfma_f32_32x32x16_bf16 v[48:63], v[216:219], v[184:187], v[48:63]
  v_mfma_f32_32x32x16_bf16 v[64:79], v[216:219], v[188:191], v[64:79]
  v_mfma_f32_32x32x16_bf16 v[80:95], v[220:223], v[184:187], v[80:95]
  v_mfma_f32_32x32x16_bf16 v[96:111], v[220:223], v[188:191], v[96:111]
  v_mfma_f32_32x32x16_bf16 v[112:127], v[224:227], v[184:187], v[112:127]
  v_mfma_f32_32x32x16_bf16 v[128:143], v[224:227], v[188:191], v[128:143]
  v_mfma_f32_32x32x16_bf16 v[144:159], v[228:231], v[184:187], v[144:159]
  v_mfma_f32_32x32x16_bf16 v[160:175], v[228:231], v[188:191], v[160:175]
  v_and_b32 v15, 0x33, v1
  v_bfe_u32 v246, v1, 2, 1
  v_lshl_or_b32 v15, v246, 3, v15
  v_bfe_u32 v246, v1, 3, 1
  v_lshl_or_b32 v15, v246, 2, v15
  v_lshlrev_b32 v15, 4, v15
  s_cmp_lt_u32 s30, 16
  s_cselect_b64 vcc, -1, 0
  v_cndmask_b32 v246, v15, v14, vcc
  v_and_b32 v15, 31, v1
  v_lshlrev_b32 v15, 4, v15
  v_add_u32 v242, 159744, v15
  s_waitcnt lgkmcnt(0)
  v_mfma_f32_32x32x16_bf16 v[144:159], v[192:195], v[176:179], v[144:159]
  ds_read_b128 v[184:187], v233 offset:53248
  ds_read_b128 v[188:191], v233 offset:57344
  v_mfma_f32_32x32x16_bf16 v[160:175], v[192:195], v[180:183], v[160:175]
  ds_read_b64_tr_b16 v[200:201], v241 offset:17408
  ds_read_b64_tr_b16 v[202:203], v241 offset:17664
  s_waitcnt lgkmcnt(0)
  v_mfma_f32_32x32x16_bf16 v[144:159], v[200:203], v[184:187], v[144:159]
  ds_read_b128 v[176:179], v234 offset:53248
  ds_read_b128 v[180:183], v234 offset:57344
  v_mfma_f32_32x32x16_bf16 v[160:175], v[200:203], v[188:191], v[160:175]
  ds_read_b64_tr_b16 v[192:193], v241 offset:18432
  ds_read_b64_tr_b16 v[194:195], v241 offset:18688
  s_waitcnt lgkmcnt(0)
  v_mfma_f32_32x32x16_bf16 v[144:159], v[192:195], v[176:179], v[144:159]
  ds_read_b128 v[184:187], v235 offset:53248
  ds_read_b128 v[188:191], v235 offset:57344
  v_mfma_f32_32x32x16_bf16 v[160:175], v[192:195], v[180:183], v[160:175]
  ds_read_b64_tr_b16 v[200:201], v241 offset:19456
  ds_read_b64_tr_b16 v[202:203], v241 offset:19712
  s_barrier
  s_waitcnt lgkmcnt(0)
  v_mfma_f32_32x32x16_bf16 v[144:159], v[200:203], v[184:187], v[144:159]
  ds_read_b128 v[192:195], v242 offset:2048
  v_mfma_f32_32x32x16_bf16 v[160:175], v[200:203], v[188:191], v[160:175]
  s_waitcnt lgkmcnt(0)
  v_mfma_f32_32x32x16_bf16 v[144:159], v[192:195], v[2:5], v[144:159]
  ds_read_b128 v[184:187], v232 offset:53248
  ds_read_b128 v[188:191], v232 offset:57344
  ds_read_b64_tr_b16 v[200:201], v241 offset:0
  v_mfma_f32_32x32x16_bf16 v[160:175], v[192:195], v[6:9], v[160:175]
  ds_read_b64_tr_b16 v[202:203], v241 offset:256
  ds_read_b64_tr_b16 v[204:205], v241 offset:4096
  ds_read_b64_tr_b16 v[206:207], v241 offset:4352
  s_waitcnt lgkmcnt(2)
  v_mfma_f32_32x32x16_bf16 v[16:31], v[200:203], v[184:187], v[16:31]
  ds_read_b128 v[176:179], v233 offset:53248
  ds_read_b128 v[180:183], v233 offset:57344
  v_mfma_f32_32x32x16_bf16 v[32:47], v[200:203], v[188:191], v[32:47]
  ds_read_b64_tr_b16 v[192:193], v241 offset:1024
  ds_read_b64_tr_b16 v[194:195], v241 offset:1280
  s_waitcnt lgkmcnt(4)
  v_mfma_f32_32x32x16_bf16 v[48:63], v[204:207], v[184:187], v[48:63]
  ds_read_b64_tr_b16 v[196:197], v241 offset:5120
  ds_read_b64_tr_b16 v[198:199], v241 offset:5376
  s_cmp_lt_u32 s30, 16
  s_cselect_b32 s42, 0x3eb8aa3b, 0x3f800000
  s_lshl_b32 s43, s30, 17
  s_lshl_b32 s44, s33, 10
  s_add_u32 s43, s43, s44
  s_add_u32 s43, s43, 0
  s_add_u32 s44, s43, 65536
  v_mfma_f32_32x32x16_bf16 v[64:79], v[204:207], v[188:191], v[64:79]
  v_mul_f32 v15, s42, v12
  v_mul_f32 v144, v144, v15
  v_mul_f32 v145, v145, v15
  v_mul_f32 v146, v146, v15
  v_mul_f32 v147, v147, v15
  v_mul_f32 v148, v148, v15
  v_mul_f32 v149, v149, v15
  s_waitcnt lgkmcnt(2)
  v_mfma_f32_32x32x16_bf16 v[16:31], v[192:195], v[176:179], v[16:31]
  ds_read_b128 v[184:187], v234 offset:53248
  ds_read_b128 v[188:191], v234 offset:57344
  v_mul_f32 v150, v150, v15
  v_mul_f32 v151, v151, v15
  v_mul_f32 v152, v152, v15
  v_mul_f32 v153, v153, v15
  v_mul_f32 v154, v154, v15
  v_mul_f32 v155, v155, v15
  v_mul_f32 v156, v156, v15
  v_mfma_f32_32x32x16_bf16 v[32:47], v[192:195], v[180:183], v[32:47]
  ds_read_b64_tr_b16 v[200:201], v241 offset:2048
  ds_read_b64_tr_b16 v[202:203], v241 offset:2304
  v_mul_f32 v157, v157, v15
  v_mul_f32 v158, v158, v15
  v_mul_f32 v159, v159, v15
  v_cvt_pk_bf16_f32 v224, v144, v145
  v_cvt_pk_bf16_f32 v225, v146, v147
  v_cvt_pk_bf16_f32 v226, v148, v149
  v_cvt_pk_bf16_f32 v227, v150, v151
  s_waitcnt lgkmcnt(4)
  v_mfma_f32_32x32x16_bf16 v[48:63], v[196:199], v[176:179], v[48:63]
  ds_read_b64_tr_b16 v[204:205], v241 offset:6144
  ds_read_b64_tr_b16 v[206:207], v241 offset:6400
  buffer_store_dwordx4 v[224:227], v246, s[20:23], s43 offen offset:0 sc1
  v_cvt_pk_bf16_f32 v228, v152, v153
  v_cvt_pk_bf16_f32 v229, v154, v155
  v_cvt_pk_bf16_f32 v230, v156, v157
  v_cvt_pk_bf16_f32 v231, v158, v159
  buffer_store_dwordx4 v[228:231], v246, s[20:23], s44 offen offset:0 sc1
  v_mul_f32 v15, s42, v13
  v_mfma_f32_32x32x16_bf16 v[64:79], v[196:199], v[180:183], v[64:79]
  v_mul_f32 v160, v160, v15
  v_mul_f32 v161, v161, v15
  v_mul_f32 v162, v162, v15
  v_mul_f32 v163, v163, v15
  v_mul_f32 v164, v164, v15
  v_mul_f32 v165, v165, v15
  v_mul_f32 v166, v166, v15
  s_waitcnt lgkmcnt(2)
  v_mfma_f32_32x32x16_bf16 v[16:31], v[200:203], v[184:187], v[16:31]
  ds_read_b128 v[176:179], v235 offset:53248
  ds_read_b128 v[180:183], v235 offset:57344
  v_mul_f32 v167, v167, v15
  v_mul_f32 v168, v168, v15
  v_mul_f32 v169, v169, v15
  v_mul_f32 v170, v170, v15
  v_mul_f32 v171, v171, v15
  v_mul_f32 v172, v172, v15
  v_mul_f32 v173, v173, v15
  v_mfma_f32_32x32x16_bf16 v[32:47], v[200:203], v[188:191], v[32:47]
  ds_read_b64_tr_b16 v[192:193], v241 offset:3072
  ds_read_b64_tr_b16 v[194:195], v241 offset:3328
  v_mul_f32 v174, v174, v15
  v_mul_f32 v175, v175, v15
  v_cvt_pk_bf16_f32 v224, v160, v161
  v_cvt_pk_bf16_f32 v225, v162, v163
  v_cvt_pk_bf16_f32 v226, v164, v165
  v_cvt_pk_bf16_f32 v227, v166, v167
  buffer_store_dwordx4 v[224:227], v246, s[20:23], s43 offen offset:1024 sc1
  s_waitcnt lgkmcnt(4)
  v_mfma_f32_32x32x16_bf16 v[48:63], v[204:207], v[184:187], v[48:63]
  ds_read_b64_tr_b16 v[196:197], v241 offset:7168
  ds_read_b64_tr_b16 v[198:199], v241 offset:7424
  v_cvt_pk_bf16_f32 v228, v168, v169
  v_cvt_pk_bf16_f32 v229, v170, v171
  v_cvt_pk_bf16_f32 v230, v172, v173
  v_cvt_pk_bf16_f32 v231, v174, v175
  buffer_store_dwordx4 v[228:231], v246, s[20:23], s44 offen offset:1024 sc1
  v_mfma_f32_32x32x16_bf16 v[64:79], v[204:207], v[188:191], v[64:79]
  s_waitcnt lgkmcnt(2)
  v_mfma_f32_32x32x16_bf16 v[16:31], v[192:195], v[176:179], v[16:31]
  ds_read_b128 v[200:203], v242 offset:0
  v_mfma_f32_32x32x16_bf16 v[32:47], v[192:195], v[180:183], v[32:47]
  ds_read_b128 v[204:207], v242 offset:512
  s_waitcnt lgkmcnt(2)
  v_mfma_f32_32x32x16_bf16 v[48:63], v[196:199], v[176:179], v[48:63]
  v_mfma_f32_32x32x16_bf16 v[64:79], v[196:199], v[180:183], v[64:79]
  s_waitcnt lgkmcnt(1)
  v_mfma_f32_32x32x16_bf16 v[16:31], v[200:203], v[2:5], v[16:31]
  ds_read_b128 v[176:179], v232 offset:53248
  ds_read_b128 v[180:183], v232 offset:57344
  v_mfma_f32_32x32x16_bf16 v[32:47], v[200:203], v[6:9], v[32:47]
  ds_read_b64_tr_b16 v[192:193], v241 offset:8192
  ds_read_b64_tr_b16 v[194:195], v241 offset:8448
  s_waitcnt lgkmcnt(4)
  v_mfma_f32_32x32x16_bf16 v[48:63], v[204:207], v[2:5], v[48:63]
  ds_read_b64_tr_b16 v[196:197], v241 offset:12288
  ds_read_b64_tr_b16 v[198:199], v241 offset:12544
  v_mfma_f32_32x32x16_bf16 v[64:79], v[204:207], v[6:9], v[64:79]
  s_waitcnt lgkmcnt(2)
  v_mfma_f32_32x32x16_bf16 v[80:95], v[192:195], v[176:179], v[80:95]
  ds_read_b128 v[184:187], v233 offset:53248
  ds_read_b128 v[188:191], v233 offset:57344
  v_mfma_f32_32x32x16_bf16 v[96:111], v[192:195], v[180:183], v[96:111]
  ds_read_b64_tr_b16 v[200:201], v241 offset:9216
  ds_read_b64_tr_b16 v[202:203], v241 offset:9472
  s_waitcnt lgkmcnt(4)
  v_mfma_f32_32x32x16_bf16 v[112:127], v[196:199], v[176:179], v[112:127]
  ds_read_b64_tr_b16 v[204:205], v241 offset:13312
  ds_read_b64_tr_b16 v[206:207], v241 offset:13568
  v_mul_f32 v15, 0xbfb8aa3b, v12
  s_add_u32 s42, s33, 0
  s_mul_i32 s42, s42, 112
  s_lshl_b32 s43, s30, 2
  s_add_u32 s42, s42, s43
  s_add_u32 s42, s42, 0
  s_lshl_b32 s42, s42, 10
  s_add_u32 s42, s42, 6291456
  v_mul_f32 v208, v16, v15
  v_mul_f32 v209, v17, v15
  v_mul_f32 v210, v18, v15
  v_mul_f32 v211, v19, v15
  v_mfma_f32_32x32x16_bf16 v[128:143], v[196:199], v[180:183], v[128:143]
  v_mul_f32 v212, v20, v15
  v_mul_f32 v213, v21, v15
  v_mul_f32 v214, v22, v15
  v_mul_f32 v215, v23, v15
  v_mul_f32 v216, v24, v15
  v_mul_f32 v217, v25, v15
  v_mul_f32 v218, v26, v15
  v_mul_f32 v219, v27, v15
  v_mul_f32 v220, v28, v15
  v_mul_f32 v221, v29, v15
  v_mul_f32 v222, v30, v15
  v_mul_f32 v223, v31, v15
  v_exp_f32 v208, v208
  s_waitcnt lgkmcnt(2)
  v_mfma_f32_32x32x16_bf16 v[80:95], v[200:203], v[184:187], v[80:95]
  ds_read_b128 v[176:179], v234 offset:53248
  ds_read_b128 v[180:183], v234 offset:57344
  v_exp_f32 v209, v209
  v_exp_f32 v210, v210
  v_exp_f32 v211, v211
  v_exp_f32 v212, v212
  v_exp_f32 v213, v213
  v_exp_f32 v214, v214
  v_exp_f32 v215, v215
  v_exp_f32 v216, v216
  v_exp_f32 v217, v217
  v_exp_f32 v218, v218
  v_exp_f32 v219, v219
  v_exp_f32 v220, v220
  v_exp_f32 v221, v221
  v_mfma_f32_32x32x16_bf16 v[96:111], v[200:203], v[188:191], v[96:111]
  ds_read_b64_tr_b16 v[192:193], v241 offset:10240
  ds_read_b64_tr_b16 v[194:195], v241 offset:10496
  v_exp_f32 v222, v222
  v_exp_f32 v223, v223
  v_mul_f32 v16, v16, v48
  v_mul_f32 v17, v17, v49
  v_mul_f32 v18, v18, v50
  v_mul_f32 v19, v19, v51
  v_mul_f32 v20, v20, v52
  v_mul_f32 v21, v21, v53
  v_mul_f32 v22, v22, v54
  v_mul_f32 v23, v23, v55
  v_mul_f32 v24, v24, v56
  v_mul_f32 v25, v25, v57
  s_waitcnt lgkmcnt(4)
  v_mfma_f32_32x32x16_bf16 v[112:127], v[204:207], v[184:187], v[112:127]
  ds_read_b64_tr_b16 v[196:197], v241 offset:14336
  ds_read_b64_tr_b16 v[198:199], v241 offset:14592
  v_mul_f32 v26, v26, v58
  v_mul_f32 v27, v27, v59
  v_mul_f32 v28, v28, v60
  v_mul_f32 v29, v29, v61
  v_mul_f32 v30, v30, v62
  v_mul_f32 v31, v31, v63
  v_fma_f32 v208, v208, v10, v10
  v_fma_f32 v209, v209, v10, v10
  v_fma_f32 v210, v210, v10, v10
  v_fma_f32 v211, v211, v10, v10
  v_fma_f32 v212, v212, v10, v10
  v_fma_f32 v213, v213, v10, v10
  v_fma_f32 v214, v214, v10, v10
  v_mfma_f32_32x32x16_bf16 v[128:143], v[204:207], v[188:191], v[128:143]
  v_fma_f32 v215, v215, v10, v10
  v_fma_f32 v216, v216, v10, v10
  v_fma_f32 v217, v217, v10, v10
  v_fma_f32 v218, v218, v10, v10
  v_fma_f32 v219, v219, v10, v10
  v_fma_f32 v220, v220, v10, v10
  v_fma_f32 v221, v221, v10, v10
  v_fma_f32 v222, v222, v10, v10
  v_fma_f32 v223, v223, v10, v10
  v_rcp_f32 v208, v208
  v_rcp_f32 v209, v209
  v_rcp_f32 v210, v210
  v_rcp_f32 v211, v211
  s_waitcnt lgkmcnt(2)
  v_mfma_f32_32x32x16_bf16 v[80:95], v[192:195], v[176:179], v[80:95]
  ds_read_b128 v[184:187], v235 offset:53248
  ds_read_b128 v[188:191], v235 offset:57344
  v_rcp_f32 v212, v212
  v_rcp_f32 v213, v213
  v_rcp_f32 v214, v214
  v_rcp_f32 v215, v215
  v_rcp_f32 v216, v216
  v_rcp_f32 v217, v217
  v_rcp_f32 v218, v218
  v_rcp_f32 v219, v219
  v_rcp_f32 v220, v220
  v_rcp_f32 v221, v221
  v_rcp_f32 v222, v222
  v_rcp_f32 v223, v223
  v_mfma_f32_32x32x16_bf16 v[96:111], v[192:195], v[180:183], v[96:111]
  ds_read_b64_tr_b16 v[200:201], v241 offset:11264
  ds_read_b64_tr_b16 v[202:203], v241 offset:11520
  v_mul_f32 v16, v16, v208
  v_mul_f32 v17, v17, v209
  v_mul_f32 v18, v18, v210
  v_mul_f32 v19, v19, v211
  v_mul_f32 v20, v20, v212
  v_mul_f32 v21, v21, v213
  v_mul_f32 v22, v22, v214
  v_mul_f32 v23, v23, v215
  v_mul_f32 v24, v24, v216
  v_mul_f32 v25, v25, v217
  v_mul_f32 v26, v26, v218
  v_mul_f32 v27, v27, v219
  v_mul_f32 v28, v28, v220
  s_waitcnt lgkmcnt(4)
  v_mfma_f32_32x32x16_bf16 v[112:127], v[196:199], v[176:179], v[112:127]
  ds_read_b64_tr_b16 v[204:205], v241 offset:15360
  ds_read_b64_tr_b16 v[206:207], v241 offset:15616
  v_mul_f32 v29, v29, v221
  v_mul_f32 v30, v30, v222
  v_mul_f32 v31, v31, v223
  v_cvt_pk_bf16_f32 v224, v16, v17
  v_cvt_pk_bf16_f32 v225, v18, v19
  v_cvt_pk_bf16_f32 v226, v20, v21
  v_cvt_pk_bf16_f32 v227, v22, v23
  buffer_store_dwordx4 v[224:227], v14, s[20:23], s42 offen offset:0 sc1
  v_cvt_pk_bf16_f32 v228, v24, v25
  v_cvt_pk_bf16_f32 v229, v26, v27
  v_cvt_pk_bf16_f32 v230, v28, v29
  v_cvt_pk_bf16_f32 v231, v30, v31
  buffer_store_dwordx4 v[228:231], v14, s[20:23], s42 offen offset:1024 sc1
  v_mfma_f32_32x32x16_bf16 v[128:143], v[196:199], v[180:183], v[128:143]
  v_mul_f32 v15, 0xbfb8aa3b, v13
  s_add_u32 s42, s33, 1
  s_mul_i32 s42, s42, 112
  s_lshl_b32 s43, s30, 2
  s_add_u32 s42, s42, s43
  s_add_u32 s42, s42, 0
  s_lshl_b32 s42, s42, 10
  s_add_u32 s42, s42, 6291456
  v_mul_f32 v208, v32, v15
  v_mul_f32 v209, v33, v15
  v_mul_f32 v210, v34, v15
  v_mul_f32 v211, v35, v15
  s_waitcnt lgkmcnt(2)
  v_mfma_f32_32x32x16_bf16 v[80:95], v[200:203], v[184:187], v[80:95]
  ds_read_b128 v[192:195], v242 offset:1024
  v_mul_f32 v212, v36, v15
  v_mul_f32 v213, v37, v15
  v_mul_f32 v214, v38, v15
  v_mul_f32 v215, v39, v15
  v_mul_f32 v216, v40, v15
  v_mul_f32 v217, v41, v15
  v_mul_f32 v218, v42, v15
  v_mul_f32 v219, v43, v15
  v_mul_f32 v220, v44, v15
  v_mul_f32 v221, v45, v15
  v_mul_f32 v222, v46, v15
  v_mul_f32 v223, v47, v15
  v_exp_f32 v208, v208
  v_mfma_f32_32x32x16_bf16 v[96:111], v[200:203], v[188:191], v[96:111]
  ds_read_b128 v[196:199], v242 offset:1536
  v_exp_f32 v209, v209
  v_exp_f32 v210, v210
  v_exp_f32 v211, v211
  v_exp_f32 v212, v212
  v_exp_f32 v213, v213
  v_exp_f32 v214, v214
  v_exp_f32 v215, v215
  v_exp_f32 v216, v216
  v_exp_f32 v217, v217
  v_exp_f32 v218, v218
  v_exp_f32 v219, v219
  v_exp_f32 v220, v220
  v_exp_f32 v221, v221
  s_waitcnt lgkmcnt(2)
  v_mfma_f32_32x32x16_bf16 v[112:127], v[204:207], v[184:187], v[112:127]
  v_exp_f32 v222, v222
  v_exp_f32 v223, v223
  v_mul_f32 v32, v32, v64
  v_mul_f32 v33, v33, v65
  v_mul_f32 v34, v34, v66
  v_mul_f32 v35, v35, v67
  v_mul_f32 v36, v36, v68
  v_mul_f32 v37, v37, v69
  v_mul_f32 v38, v38, v70
  v_mul_f32 v39, v39, v71
  v_mul_f32 v40, v40, v72
  v_mul_f32 v41, v41, v73
  v_mfma_f32_32x32x16_bf16 v[128:143], v[204:207], v[188:191], v[128:143]
  v_mul_f32 v42, v42, v74
  v_mul_f32 v43, v43, v75
  v_mul_f32 v44, v44, v76
  v_mul_f32 v45, v45, v77
  v_mul_f32 v46, v46, v78
  v_mul_f32 v47, v47, v79
  v_fma_f32 v208, v208, v11, v11
  v_fma_f32 v209, v209, v11, v11
  v_fma_f32 v210, v210, v11, v11
  v_fma_f32 v211, v211, v11, v11
  v_fma_f32 v212, v212, v11, v11
  v_fma_f32 v213, v213, v11, v11
  v_fma_f32 v214, v214, v11, v11
  s_waitcnt lgkmcnt(1)
  v_mfma_f32_32x32x16_bf16 v[80:95], v[192:195], v[2:5], v[80:95]
  v_fma_f32 v215, v215, v11, v11
  v_fma_f32 v216, v216, v11, v11
  v_fma_f32 v217, v217, v11, v11
  v_fma_f32 v218, v218, v11, v11
  v_fma_f32 v219, v219, v11, v11
  v_fma_f32 v220, v220, v11, v11
  v_fma_f32 v221, v221, v11, v11
  v_fma_f32 v222, v222, v11, v11
  v_fma_f32 v223, v223, v11, v11
  v_rcp_f32 v208, v208
  v_rcp_f32 v209, v209
  v_rcp_f32 v210, v210
  v_rcp_f32 v211, v211
  v_mfma_f32_32x32x16_bf16 v[96:111], v[192:195], v[6:9], v[96:111]
  v_rcp_f32 v212, v212
  v_rcp_f32 v213, v213
  v_rcp_f32 v214, v214
  v_rcp_f32 v215, v215
  v_rcp_f32 v216, v216
  v_rcp_f32 v217, v217
  v_rcp_f32 v218, v218
  v_rcp_f32 v219, v219
  v_rcp_f32 v220, v220
  v_rcp_f32 v221, v221
  v_rcp_f32 v222, v222
  v_rcp_f32 v223, v223
  s_waitcnt lgkmcnt(0)
  v_mfma_f32_32x32x16_bf16 v[112:127], v[196:199], v[2:5], v[112:127]
  v_mul_f32 v32, v32, v208
  v_mul_f32 v33, v33, v209
  v_mul_f32 v34, v34, v210
  v_mul_f32 v35, v35, v211
  v_mul_f32 v36, v36, v212
  v_mul_f32 v37, v37, v213
  v_mul_f32 v38, v38, v214
  v_mul_f32 v39, v39, v215
  v_mul_f32 v40, v40, v216
  v_mul_f32 v41, v41, v217
  v_mul_f32 v42, v42, v218
  v_mul_f32 v43, v43, v219
  v_mul_f32 v44, v44, v220
  v_mfma_f32_32x32x16_bf16 v[128:143], v[196:199], v[6:9], v[128:143]
  v_mul_f32 v45, v45, v221
  v_mul_f32 v46, v46, v222
  v_mul_f32 v47, v47, v223
  v_cvt_pk_bf16_f32 v224, v32, v33
  v_cvt_pk_bf16_f32 v225, v34, v35
  v_cvt_pk_bf16_f32 v226, v36, v37
  v_cvt_pk_bf16_f32 v227, v38, v39
  buffer_store_dwordx4 v[224:227], v14, s[20:23], s42 offen offset:0 sc1
  v_cvt_pk_bf16_f32 v228, v40, v41
  v_cvt_pk_bf16_f32 v229, v42, v43
  v_cvt_pk_bf16_f32 v230, v44, v45
  v_cvt_pk_bf16_f32 v231, v46, v47
  buffer_store_dwordx4 v[228:231], v14, s[20:23], s42 offen offset:1024 sc1
  s_waitcnt vmcnt(4)
  s_barrier
  v_mul_f32 v15, 0xbfb8aa3b, v12
  s_add_u32 s42, s33, 0
  s_mul_i32 s42, s42, 112
  s_lshl_b32 s43, s30, 2
  s_add_u32 s42, s42, s43
  s_add_u32 s42, s42, 2
  s_lshl_b32 s42, s42, 10
  s_add_u32 s42, s42, 6291456
  v_mul_f32 v208, v80, v15
  v_mul_f32 v209, v81, v15
  v_mul_f32 v210, v82, v15
  v_mul_f32 v211, v83, v15
  v_mul_f32 v212, v84, v15
  v_mul_f32 v213, v85, v15
  v_mul_f32 v214, v86, v15
  v_mul_f32 v215, v87, v15
  v_mul_f32 v216, v88, v15
  v_mul_f32 v217, v89, v15
  v_mul_f32 v218, v90, v15
  v_mul_f32 v219, v91, v15
  v_mul_f32 v220, v92, v15
  v_mul_f32 v221, v93, v15
  v_mul_f32 v222, v94, v15
  v_mul_f32 v223, v95, v15
  v_exp_f32 v208, v208
  v_exp_f32 v209, v209
  v_exp_f32 v210, v210
  v_exp_f32 v211, v211
  v_exp_f32 v212, v212
  v_exp_f32 v213, v213
  v_exp_f32 v214, v214
  v_exp_f32 v215, v215
  v_exp_f32 v216, v216
  v_exp_f32 v217, v217
  v_exp_f32 v218, v218
  v_exp_f32 v219, v219
  v_exp_f32 v220, v220
  v_exp_f32 v221, v221
  v_exp_f32 v222, v222
  v_exp_f32 v223, v223
  v_mul_f32 v80, v80, v112
  v_mul_f32 v81, v81, v113
  v_mul_f32 v82, v82, v114
  v_mul_f32 v83, v83, v115
  v_mul_f32 v84, v84, v116
  v_mul_f32 v85, v85, v117
  v_mul_f32 v86, v86, v118
  v_mul_f32 v87, v87, v119
  v_mul_f32 v88, v88, v120
  v_mul_f32 v89, v89, v121
  v_mul_f32 v90, v90, v122
  v_mul_f32 v91, v91, v123
  v_mul_f32 v92, v92, v124
  v_mul_f32 v93, v93, v125
  v_mul_f32 v94, v94, v126
  v_mul_f32 v95, v95, v127
  v_fma_f32 v208, v208, v10, v10
  v_fma_f32 v209, v209, v10, v10
  v_fma_f32 v210, v210, v10, v10
  v_fma_f32 v211, v211, v10, v10
  v_fma_f32 v212, v212, v10, v10
  v_fma_f32 v213, v213, v10, v10
  v_fma_f32 v214, v214, v10, v10
  v_fma_f32 v215, v215, v10, v10
  v_fma_f32 v216, v216, v10, v10
  v_fma_f32 v217, v217, v10, v10
  v_fma_f32 v218, v218, v10, v10
  v_fma_f32 v219, v219, v10, v10
  v_fma_f32 v220, v220, v10, v10
  v_fma_f32 v221, v221, v10, v10
  v_fma_f32 v222, v222, v10, v10
  v_fma_f32 v223, v223, v10, v10
  v_rcp_f32 v208, v208
  v_rcp_f32 v209, v209
  v_rcp_f32 v210, v210
  v_rcp_f32 v211, v211
  v_rcp_f32 v212, v212
  v_rcp_f32 v213, v213
  v_rcp_f32 v214, v214
  v_rcp_f32 v215, v215
  v_rcp_f32 v216, v216
  v_rcp_f32 v217, v217
  v_rcp_f32 v218, v218
  v_rcp_f32 v219, v219
  v_rcp_f32 v220, v220
  v_rcp_f32 v221, v221
  v_rcp_f32 v222, v222
  v_rcp_f32 v223, v223
  v_mul_f32 v80, v80, v208
  v_mul_f32 v81, v81, v209
  v_mul_f32 v82, v82, v210
  v_mul_f32 v83, v83, v211
  v_mul_f32 v84, v84, v212
  v_mul_f32 v85, v85, v213
  v_mul_f32 v86, v86, v214
  v_mul_f32 v87, v87, v215
  v_mul_f32 v88, v88, v216
  v_mul_f32 v89, v89, v217
  v_mul_f32 v90, v90, v218
  v_mul_f32 v91, v91, v219
  v_mul_f32 v92, v92, v220
  v_mul_f32 v93, v93, v221
  v_mul_f32 v94, v94, v222
  v_mul_f32 v95, v95, v223
  v_cvt_pk_bf16_f32 v224, v80, v81
  v_cvt_pk_bf16_f32 v225, v82, v83
  v_cvt_pk_bf16_f32 v226, v84, v85
  v_cvt_pk_bf16_f32 v227, v86, v87
  buffer_store_dwordx4 v[224:227], v14, s[20:23], s42 offen offset:0 sc1
  v_cvt_pk_bf16_f32 v228, v88, v89
  v_cvt_pk_bf16_f32 v229, v90, v91
  v_cvt_pk_bf16_f32 v230, v92, v93
  v_cvt_pk_bf16_f32 v231, v94, v95
  buffer_store_dwordx4 v[228:231], v14, s[20:23], s42 offen offset:1024 sc1
  v_mul_f32 v15, 0xbfb8aa3b, v13
  s_add_u32 s42, s33, 1
  s_mul_i32 s42, s42, 112
  s_lshl_b32 s43, s30, 2
  s_add_u32 s42, s42, s43
  s_add_u32 s42, s42, 2
  s_lshl_b32 s42, s42, 10
  s_add_u32 s42, s42, 6291456
  v_mul_f32 v208, v96, v15
  v_mul_f32 v209, v97, v15
  v_mul_f32 v210, v98, v15
  v_mul_f32 v211, v99, v15
  v_mul_f32 v212, v100, v15
  v_mul_f32 v213, v101, v15
  v_mul_f32 v214, v102, v15
  v_mul_f32 v215, v103, v15
  v_mul_f32 v216, v104, v15
  v_mul_f32 v217, v105, v15
  v_mul_f32 v218, v106, v15
  v_mul_f32 v219, v107, v15
  v_mul_f32 v220, v108, v15
  v_mul_f32 v221, v109, v15
  v_mul_f32 v222, v110, v15
  v_mul_f32 v223, v111, v15
  v_exp_f32 v208, v208
  v_exp_f32 v209, v209
  v_exp_f32 v210, v210
  v_exp_f32 v211, v211
  v_exp_f32 v212, v212
  v_exp_f32 v213, v213
  v_exp_f32 v214, v214
  v_exp_f32 v215, v215
  v_exp_f32 v216, v216
  v_exp_f32 v217, v217
  v_exp_f32 v218, v218
  v_exp_f32 v219, v219
  v_exp_f32 v220, v220
  v_exp_f32 v221, v221
  v_exp_f32 v222, v222
  v_exp_f32 v223, v223
  v_mul_f32 v96, v96, v128
  v_mul_f32 v97, v97, v129
  v_mul_f32 v98, v98, v130
  v_mul_f32 v99, v99, v131
  v_mul_f32 v100, v100, v132
  v_mul_f32 v101, v101, v133
  v_mul_f32 v102, v102, v134
  v_mul_f32 v103, v103, v135
  v_mul_f32 v104, v104, v136
  v_mul_f32 v105, v105, v137
  v_mul_f32 v106, v106, v138
  v_mul_f32 v107, v107, v139
  v_mul_f32 v108, v108, v140
  v_mul_f32 v109, v109, v141
  v_mul_f32 v110, v110, v142
  v_mul_f32 v111, v111, v143
  v_fma_f32 v208, v208, v11, v11
  v_fma_f32 v209, v209, v11, v11
  v_fma_f32 v210, v210, v11, v11
  v_fma_f32 v211, v211, v11, v11
  v_fma_f32 v212, v212, v11, v11
  v_fma_f32 v213, v213, v11, v11
  v_fma_f32 v214, v214, v11, v11
  v_fma_f32 v215, v215, v11, v11
  v_fma_f32 v216, v216, v11, v11
  v_fma_f32 v217, v217, v11, v11
  v_fma_f32 v218, v218, v11, v11
  v_fma_f32 v219, v219, v11, v11
  v_fma_f32 v220, v220, v11, v11
  v_fma_f32 v221, v221, v11, v11
  v_fma_f32 v222, v222, v11, v11
  v_fma_f32 v223, v223, v11, v11
  v_rcp_f32 v208, v208
  v_rcp_f32 v209, v209
  v_rcp_f32 v210, v210
  v_rcp_f32 v211, v211
  v_rcp_f32 v212, v212
  v_rcp_f32 v213, v213
  v_rcp_f32 v214, v214
  v_rcp_f32 v215, v215
  v_rcp_f32 v216, v216
  v_rcp_f32 v217, v217
  v_rcp_f32 v218, v218
  v_rcp_f32 v219, v219
  v_rcp_f32 v220, v220
  v_rcp_f32 v221, v221
  v_rcp_f32 v222, v222
  v_rcp_f32 v223, v223
  v_mul_f32 v96, v96, v208
  v_mul_f32 v97, v97, v209
  v_mul_f32 v98, v98, v210
  v_mul_f32 v99, v99, v211
  v_mul_f32 v100, v100, v212
  v_mul_f32 v101, v101, v213
  v_mul_f32 v102, v102, v214
  v_mul_f32 v103, v103, v215
  v_mul_f32 v104, v104, v216
  v_mul_f32 v105, v105, v217
  v_mul_f32 v106, v106, v218
  v_mul_f32 v107, v107, v219
  v_mul_f32 v108, v108, v220
  v_mul_f32 v109, v109, v221
  v_mul_f32 v110, v110, v222
  v_mul_f32 v111, v111, v223
  v_cvt_pk_bf16_f32 v224, v96, v97
  v_cvt_pk_bf16_f32 v225, v98, v99
  v_cvt_pk_bf16_f32 v226, v100, v101
  v_cvt_pk_bf16_f32 v227, v102, v103
  buffer_store_dwordx4 v[224:227], v14, s[20:23], s42 offen offset:0 sc1
  v_cvt_pk_bf16_f32 v228, v104, v105
  v_cvt_pk_bf16_f32 v229, v106, v107
  v_cvt_pk_bf16_f32 v230, v108, v109
  v_cvt_pk_bf16_f32 v231, v110, v111
  buffer_store_dwordx4 v[228:231], v14, s[20:23], s42 offen offset:1024 sc1
  s_waitcnt vmcnt(0) lgkmcnt(0)
  s_barrier
  s_branch L_p2
L_k1_pure:
  s_nop 1
  s_waitcnt vmcnt(0)
  v_lshlrev_b32 v200, 16, v192
  v_and_b32 v201, 0xffff0000, v192
  v_lshlrev_b32 v202, 16, v193
  v_and_b32 v203, 0xffff0000, v193
  v_lshlrev_b32 v204, 16, v194
  v_and_b32 v205, 0xffff0000, v194
  v_lshlrev_b32 v206, 16, v195
  v_and_b32 v207, 0xffff0000, v195
  v_readfirstlane_b32 s40, v200
  s_nop 1
  v_subrev_f32 v200, s40, v200
  v_subrev_f32 v201, s40, v201
  v_subrev_f32 v202, s40, v202
  v_subrev_f32 v203, s40, v203
  v_subrev_f32 v204, s40, v204
  v_subrev_f32 v205, s40, v205
  v_subrev_f32 v206, s40, v206
  v_subrev_f32 v207, s40, v207
  v_add_f32 v208, v200, v201
  v_mul_f32 v209, v200, v200
  v_fmac_f32 v209, v201, v201
  v_add_f32 v208, v208, v202
  v_fmac_f32 v209, v202, v202
  v_add_f32 v208, v208, v203
  v_fmac_f32 v209, v203, v203
  v_add_f32 v208, v208, v204
  v_fmac_f32 v209, v204, v204
  v_add_f32 v208, v208, v205
  v_fmac_f32 v209, v205, v205
  v_add_f32 v208, v208, v206
  v_fmac_f32 v209, v206, v206
  v_add_f32 v208, v208, v207
  v_fmac_f32 v209, v207, v207
  s_nop 0
  v_add_f32_dpp v208, v208, v208 row_shr:1 row_mask:0xf bank_mask:0xf
  v_add_f32_dpp v209, v209, v209 row_shr:1 row_mask:0xf bank_mask:0xf
  s_nop 0
  v_add_f32_dpp v208, v208, v208 row_shr:2 row_mask:0xf bank_mask:0xf
  v_add_f32_dpp v209, v209, v209 row_shr:2 row_mask:0xf bank_mask:0xf
  s_nop 0
  v_add_f32_dpp v208, v208, v208 row_shr:4 row_mask:0xf bank_mask:0xf
  v_add_f32_dpp v209, v209, v209 row_shr:4 row_mask:0xf bank_mask:0xf
  s_nop 0
  v_add_f32_dpp v208, v208, v208 row_shr:8 row_mask:0xf bank_mask:0xf
  v_add_f32_dpp v209, v209, v209 row_shr:8 row_mask:0xf bank_mask:0xf
  s_nop 0
  v_add_f32_dpp v208, v208, v208 row_bcast:15 row_mask:0xa bank_mask:0xf
  v_add_f32_dpp v209, v209, v209 row_bcast:15 row_mask:0xa bank_mask:0xf
  s_nop 0
  v_add_f32_dpp v208, v208, v208 row_bcast:31 row_mask:0xc bank_mask:0xf
  v_add_f32_dpp v209, v209, v209 row_bcast:31 row_mask:0xc bank_mask:0xf
  v_mul_f32 v2, 0x3b000000, v208
  v_mul_f32 v3, 0x3b000000, v209
  v_fma_f32 v3, -v2, v2, v3
  v_max_f32 v3, 0, v3
  v_add_f32 v3, 0x3727c5ac, v3
  v_add_f32 v2, s40, v2
  v_lshlrev_b32 v200, 16, v196
  v_and_b32 v201, 0xffff0000, v196
  v_lshlrev_b32 v202, 16, v197
  v_and_b32 v203, 0xffff0000, v197
  v_lshlrev_b32 v204, 16, v198
  v_and_b32 v205, 0xffff0000, v198
  v_lshlrev_b32 v206, 16, v199
  v_and_b32 v207, 0xffff0000, v199
  v_readfirstlane_b32 s40, v200
  s_nop 1
  v_subrev_f32 v200, s40, v200
  v_subrev_f32 v201, s40, v201
  v_subrev_f32 v202, s40, v202
  v_subrev_f32 v203, s40, v203
  v_subrev_f32 v204, s40, v204
  v_subrev_f32 v205, s40, v205
  v_subrev_f32 v206, s40, v206
  v_subrev_f32 v207, s40, v207
  v_add_f32 v208, v200, v201
  v_mul_f32 v209, v200, v200
  v_fmac_f32 v209, v201, v201
  v_add_f32 v208, v208, v202
  v_fmac_f32 v209, v202, v202
  v_add_f32 v208, v208, v203
  v_fmac_f32 v209, v203, v203
  v_add_f32 v208, v208, v204
  v_fmac_f32 v209, v204, v204
  v_add_f32 v208, v208, v205
  v_fmac_f32 v209, v205, v205
  v_add_f32 v208, v208, v206
  v_fmac_f32 v209, v206, v206
  v_add_f32 v208, v208, v207
  v_fmac_f32 v209, v207, v207
  s_nop 0
  v_add_f32_dpp v208, v208, v208 row_shr:1 row_mask:0xf bank_mask:0xf
  v_add_f32_dpp v209, v209, v209 row_shr:1 row_mask:0xf bank_mask:0xf
  s_nop 0
  v_add_f32_dpp v208, v208, v208 row_shr:2 row_mask:0xf bank_mask:0xf
  v_add_f32_dpp v209, v209, v209 row_shr:2 row_mask:0xf bank_mask:0xf
  s_nop 0
  v_add_f32_dpp v208, v208, v208 row_shr:4 row_mask:0xf bank_mask:0xf
  v_add_f32_dpp v209, v209, v209 row_shr:4 row_mask:0xf bank_mask:0xf
  s_nop 0
  v_add_f32_dpp v208, v208, v208 row_shr:8 row_mask:0xf bank_mask:0xf
  v_add_f32_dpp v209, v209, v209 row_shr:8 row_mask:0xf bank_mask:0xf
  s_nop 0
  v_add_f32_dpp v208, v208, v208 row_bcast:15 row_mask:0xa bank_mask:0xf
  v_add_f32_dpp v209, v209, v209 row_bcast:15 row_mask:0xa bank_mask:0xf
  s_nop 0
  v_add_f32_dpp v208, v208, v208 row_bcast:31 row_mask:0xc bank_mask:0xf
  v_add_f32_dpp v209, v209, v209 row_bcast:31 row_mask:0xc bank_mask:0xf
  v_mul_f32 v4, 0x3b000000, v208
  v_mul_f32 v5, 0x3b000000, v209
  v_fma_f32 v5, -v4, v4, v5
  v_max_f32 v5, 0, v5
  v_add_f32 v5, 0x3727c5ac, v5
  v_add_f32 v4, s40, v4
  s_lshl_b32 s42, s29, 5
  s_add_u32 s42, s42, s30
  s_lshl_b32 s42, s42, 7
  s_lshl_b32 s43, s28, 4
  s_add_u32 s42, s42, s43
  s_add_u32 s42, s42, 20971520
  v_cmp_eq_u32 vcc, 63, v1
  v_mov_b32 v6, 0x7ffffff0
  s_nop 0
  v_cndmask_b32 v6, v6, 0, vcc
  buffer_store_dwordx4 v[2:5], v6, s[20:23], s42 offen sc1
  s_barrier
  ds_read_b128 v[176:179], v232 offset:0
  ds_read_b64_tr_b16 v[192:193], v240 offset:0
  ds_read_b64_tr_b16 v[194:195], v240 offset:256
  ds_read_b128 v[180:183], v232 offset:4096
  ds_read_b64_tr_b16 v[196:197], v240 offset:4096
  ds_read_b64_tr_b16 v[198:199], v240 offset:4352
  ds_read_b64_tr_b16 v[200:201], v240 offset:8192
  ds_read_b64_tr_b16 v[202:203], v240 offset:8448
  ds_read_b64_tr_b16 v[204:205], v240 offset:12288
  ds_read_b64_tr_b16 v[206:207], v240 offset:12544
  ds_read_b64_tr_b16 v[208:209], v240 offset:16384
  ds_read_b64_tr_b16 v[210:211], v240 offset:16640
  s_waitcnt lgkmcnt(9)
  v_mfma_f32_32x32x16_bf16 v[16:31], v[192:195], v[176:179], 0
  ds_read_b128 v[184:187], v233 offset:0
  ds_read_b64_tr_b16 v[212:213], v240 offset:1024
  ds_read_b64_tr_b16 v[214:215], v240 offset:1280
  s_waitcnt lgkmcnt(11)
  v_mfma_f32_32x32x16_bf16 v[32:47], v[192:195], v[180:183], 0
  ds_read_b128 v[188:191], v233 offset:4096
  ds_read_b64_tr_b16 v[216:217], v240 offset:5120
  s_waitcnt lgkmcnt(11)
  v_mfma_f32_32x32x16_bf16 v[48:63], v[196:199], v[176:179], 0
  ds_read_b64_tr_b16 v[218:219], v240 offset:5376
  ds_read_b64_tr_b16 v[220:221], v240 offset:9216
  v_mfma_f32_32x32x16_bf16 v[64:79], v[196:199], v[180:183], 0
  ds_read_b64_tr_b16 v[222:223], v240 offset:9472
  ds_read_b64_tr_b16 v[224:225], v240 offset:13312
  s_waitcnt lgkmcnt(13)
  v_mfma_f32_32x32x16_bf16 v[80:95], v[176:179], v[200:203], 0
  ds_read_b64_tr_b16 v[226:227], v240 offset:13568
  ds_read_b64_tr_b16 v[228:229], v240 offset:17408
  v_mfma_f32_32x32x16_bf16 v[96:111], v[180:183], v[200:203], 0
  ds_read_b64_tr_b16 v[230:231], v240 offset:17664
  s_waitcnt lgkmcnt(14)
  v_mfma_f32_32x32x16_bf16 v[112:127], v[176:179], v[204:207], 0
  v_mfma_f32_32x32x16_bf16 v[128:143], v[180:183], v[204:207], 0
  s_waitcnt lgkmcnt(12)
  v_mfma_f32_32x32x16_bf16 v[144:159], v[208:211], v[176:179], 0
  v_mfma_f32_32x32x16_bf16 v[160:175], v[208:211], v[180:183], 0
  s_waitcnt lgkmcnt(9)
  v_mfma_f32_32x32x16_bf16 v[16:31], v[212:215], v[184:187], v[16:31]
  ds_read_b128 v[176:179], v234 offset:0
  ds_read_b64_tr_b16 v[192:193], v240 offset:2048
  ds_read_b64_tr_b16 v[194:195], v240 offset:2304
  s_waitcnt lgkmcnt(11)
  v_mfma_f32_32x32x16_bf16 v[32:47], v[212:215], v[188:191], v[32:47]
  ds_read_b128 v[180:183], v234 offset:4096
  ds_read_b64_tr_b16 v[196:197], v240 offset:6144
  s_waitcnt lgkmcnt(11)
  v_mfma_f32_32x32x16_bf16 v[48:63], v[216:219], v[184:187], v[48:63]
  ds_read_b64_tr_b16 v[198:199], v240 offset:6400
  ds_read_b64_tr_b16 v[200:201], v240 offset:10240
  v_mfma_f32_32x32x16_bf16 v[64:79], v[216:219], v[188:191], v[64:79]
  ds_read_b64_tr_b16 v[202:203], v240 offset:10496
  ds_read_b64_tr_b16 v[204:205], v240 offset:14336
  s_waitcnt lgkmcnt(13)
  v_mfma_f32_32x32x16_bf16 v[80:95], v[184:187], v[220:223], v[80:95]
  ds_read_b64_tr_b16 v[206:207], v240 offset:14592
  ds_read_b64_tr_b16 v[208:209], v240 offset:18432
  v_mfma_f32_32x32x16_bf16 v[96:111], v[188:191], v[220:223], v[96:111]
  ds_read_b64_tr_b16 v[210:211], v240 offset:18688
  s_waitcnt lgkmcnt(14)
  v_mfma_f32_32x32x16_bf16 v[112:127], v[184:187], v[224:227], v[112:127]
  v_mfma_f32_32x32x16_bf16 v[128:143], v[188:191], v[224:227], v[128:143]
  s_waitcnt lgkmcnt(12)
  v_mfma_f32_32x32x16_bf16 v[144:159], v[228:231], v[184:187], v[144:159]
  v_mfma_f32_32x32x16_bf16 v[160:175], v[228:231], v[188:191], v[160:175]
  s_waitcnt lgkmcnt(9)
  v_mfma_f32_32x32x16_bf16 v[16:31], v[192:195], v[176:179], v[16:31]
  ds_read_b128 v[184:187], v235 offset:0
  ds_read_b64_tr_b16 v[212:213], v240 offset:3072
  ds_read_b64_tr_b16 v[214:215], v240 offset:3328
  s_waitcnt lgkmcnt(11)
  v_mfma_f32_32x32x16_bf16 v[32:47], v[192:195], v[180:183], v[32:47]
  ds_read_b128 v[188:191], v235 offset:4096
  ds_read_b64_tr_b16 v[216:217], v240 offset:7168
  s_waitcnt lgkmcnt(11)
  v_mfma_f32_32x32x16_bf16 v[48:63], v[196:199], v[176:179], v[48:63]
  ds_read_b64_tr_b16 v[218:219], v240 offset:7424
  ds_read_b64_tr_b16 v[220:221], v240 offset:11264
  v_mfma_f32_32x32x16_bf16 v[64:79], v[196:199], v[180:183], v[64:79]
  ds_read_b64_tr_b16 v[222:223], v240 offset:11520
  ds_read_b64_tr_b16 v[224:225], v240 offset:15360
  s_waitcnt lgkmcnt(13)
  v_mfma_f32_32x32x16_bf16 v[80:95], v[176:179], v[200:203], v[80:95]
  ds_read_b64_tr_b16 v[226:227], v240 offset:15616
  ds_read_b64_tr_b16 v[228:229], v240 offset:19456
  v_mfma_f32_32x32x16_bf16 v[96:111], v[180:183], v[200:203], v[96:111]
  ds_read_b64_tr_b16 v[230:231], v240 offset:19712
  s_waitcnt lgkmcnt(14)
  v_mfma_f32_32x32x16_bf16 v[112:127], v[176:179], v[204:207], v[112:127]
  v_mfma_f32_32x32x16_bf16 v[128:143], v[180:183], v[204:207], v[128:143]
  s_waitcnt lgkmcnt(12)
  v_mfma_f32_32x32x16_bf16 v[144:159], v[208:211], v[176:179], v[144:159]
  v_mfma_f32_32x32x16_bf16 v[160:175], v[208:211], v[180:183], v[160:175]
  s_waitcnt lgkmcnt(0)
  s_barrier
  v_mfma_f32_32x32x16_bf16 v[16:31], v[212:215], v[184:187], v[16:31]
  ds_read_b128 v[176:179], v232 offset:53248
  ds_read_b64_tr_b16 v[192:193], v241 offset:0
  ds_read_b64_tr_b16 v[194:195], v241 offset:256
  v_mfma_f32_32x32x16_bf16 v[32:47], v[212:215], v[188:191], v[32:47]
  ds_read_b128 v[180:183], v232 offset:57344
  ds_read_b64_tr_b16 v[196:197], v241 offset:4096
  v_mfma_f32_32x32x16_bf16 v[48:63], v[216:219], v[184:187], v[48:63]
  ds_read_b64_tr_b16 v[198:199], v241 offset:4352
  ds_read_b64_tr_b16 v[200:201], v241 offset:8192
  v_mfma_f32_32x32x16_bf16 v[64:79], v[216:219], v[188:191], v[64:79]
  ds_read_b64_tr_b16 v[202:203], v241 offset:8448
  ds_read_b64_tr_b16 v[204:205], v241 offset:12288
  v_mfma_f32_32x32x16_bf16 v[80:95], v[184:187], v[220:223], v[80:95]
  ds_read_b64_tr_b16 v[206:207], v241 offset:12544
  ds_read_b64_tr_b16 v[208:209], v241 offset:16384
  v_mfma_f32_32x32x16_bf16 v[96:111], v[188:191], v[220:223], v[96:111]
  ds_read_b64_tr_b16 v[210:211], v241 offset:16640
  v_mfma_f32_32x32x16_bf16 v[112:127], v[184:187], v[224:227], v[112:127]
  v_mfma_f32_32x32x16_bf16 v[128:143], v[188:191], v[224:227], v[128:143]
  v_mfma_f32_32x32x16_bf16 v[144:159], v[228:231], v[184:187], v[144:159]
  v_mfma_f32_32x32x16_bf16 v[160:175], v[228:231], v[188:191], v[160:175]
  s_waitcnt lgkmcnt(9)
  v_mfma_f32_32x32x16_bf16 v[16:31], v[192:195], v[176:179], v[16:31]
  ds_read_b128 v[184:187], v233 offset:53248
  ds_read_b64_tr_b16 v[212:213], v241 offset:1024
  ds_read_b64_tr_b16 v[214:215], v241 offset:1280
  s_waitcnt lgkmcnt(11)
  v_mfma_f32_32x32x16_bf16 v[32:47], v[192:195], v[180:183], v[32:47]
  ds_read_b128 v[188:191], v233 offset:57344
  ds_read_b64_tr_b16 v[216:217], v241 offset:5120
  s_waitcnt lgkmcnt(11)
  v_mfma_f32_32x32x16_bf16 v[48:63], v[196:199], v[176:179], v[48:63]
  ds_read_b64_tr_b16 v[218:219], v241 offset:5376
  ds_read_b64_tr_b16 v[220:221], v241 offset:9216
  v_mfma_f32_32x32x16_bf16 v[64:79], v[196:199], v[180:183], v[64:79]
  ds_read_b64_tr_b16 v[222:223], v241 offset:9472
  ds_read_b64_tr_b16 v[224:225], v241 offset:13312
  s_waitcnt lgkmcnt(13)
  v_mfma_f32_32x32x16_bf16 v[80:95], v[176:179], v[200:203], v[80:95]
  ds_read_b64_tr_b16 v[226:227], v241 offset:13568
  ds_read_b64_tr_b16 v[228:229], v241 offset:17408
  v_mfma_f32_32x32x16_bf16 v[96:111], v[180:183], v[200:203], v[96:111]
  ds_read_b64_tr_b16 v[230:231], v241 offset:17664
  s_waitcnt lgkmcnt(14)
  v_mfma_f32_32x32x16_bf16 v[112:127], v[176:179], v[204:207], v[112:127]
  v_mfma_f32_32x32x16_bf16 v[128:143], v[180:183], v[204:207], v[128:143]
  s_waitcnt lgkmcnt(12)
  v_mfma_f32_32x32x16_bf16 v[144:159], v[208:211], v[176:179], v[144:159]
  v_mfma_f32_32x32x16_bf16 v[160:175], v[208:211], v[180:183], v[160:175]
  s_waitcnt lgkmcnt(9)
  v_mfma_f32_32x32x16_bf16 v[16:31], v[212:215], v[184:187], v[16:31]
  ds_read_b128 v[176:179], v234 offset:53248
  ds_read_b64_tr_b16 v[192:193], v241 offset:2048
  ds_read_b64_tr_b16 v[194:195], v241 offset:2304
  s_waitcnt lgkmcnt(11)
  v_mfma_f32_32x32x16_bf16 v[32:47], v[212:215], v[188:191], v[32:47]
  ds_read_b128 v[180:183], v234 offset:57344
  ds_read_b64_tr_b16 v[196:197], v241 offset:6144
  s_waitcnt lgkmcnt(11)
  v_mfma_f32_32x32x16_bf16 v[48:63], v[216:219], v[184:187], v[48:63]
  ds_read_b64_tr_b16 v[198:199], v241 offset:6400
  ds_read_b64_tr_b16 v[200:201], v241 offset:10240
  v_mfma_f32_32x32x16_bf16 v[64:79], v[216:219], v[188:191], v[64:79]
  ds_read_b64_tr_b16 v[202:203], v241 offset:10496
  ds_read_b64_tr_b16 v[204:205], v241 offset:14336
  s_waitcnt lgkmcnt(13)
  v_mfma_f32_32x32x16_bf16 v[80:95], v[184:187], v[220:223], v[80:95]
  ds_read_b64_tr_b16 v[206:207], v241 offset:14592
  ds_read_b64_tr_b16 v[208:209], v241 offset:18432
  v_mfma_f32_32x32x16_bf16 v[96:111], v[188:191], v[220:223], v[96:111]
  ds_read_b64_tr_b16 v[210:211], v241 offset:18688
  s_waitcnt lgkmcnt(14)
  v_mfma_f32_32x32x16_bf16 v[112:127], v[184:187], v[224:227], v[112:127]
  v_mfma_f32_32x32x16_bf16 v[128:143], v[188:191], v[224:227], v[128:143]
  s_waitcnt lgkmcnt(12)
  v_mfma_f32_32x32x16_bf16 v[144:159], v[228:231], v[184:187], v[144:159]
  v_mfma_f32_32x32x16_bf16 v[160:175], v[228:231], v[188:191], v[160:175]
  s_waitcnt lgkmcnt(9)
  v_mfma_f32_32x32x16_bf16 v[16:31], v[192:195], v[176:179], v[16:31]
  ds_read_b128 v[184:187], v235 offset:53248
  ds_read_b64_tr_b16 v[212:213], v241 offset:3072
  ds_read_b64_tr_b16 v[214:215], v241 offset:3328
  s_waitcnt lgkmcnt(11)
  v_mfma_f32_32x32x16_bf16 v[32:47], v[192:195], v[180:183], v[32:47]
  ds_read_b128 v[188:191], v235 offset:57344
  ds_read_b64_tr_b16 v[216:217], v241 offset:7168
  s_waitcnt lgkmcnt(11)
  v_mfma_f32_32x32x16_bf16 v[48:63], v[196:199], v[176:179], v[48:63]
  ds_read_b64_tr_b16 v[218:219], v241 offset:7424
  ds_read_b64_tr_b16 v[220:221], v241 offset:11264
  v_mfma_f32_32x32x16_bf16 v[64:79], v[196:199], v[180:183], v[64:79]
  ds_read_b64_tr_b16 v[222:223], v241 offset:11520
  ds_read_b64_tr_b16 v[224:225], v241 offset:15360
  s_waitcnt lgkmcnt(13)
  v_mfma_f32_32x32x16_bf16 v[80:95], v[176:179], v[200:203], v[80:95]
  ds_read_b64_tr_b16 v[226:227], v241 offset:15616
  ds_read_b64_tr_b16 v[228:229], v241 offset:19456
  v_mfma_f32_32x32x16_bf16 v[96:111], v[180:183], v[200:203], v[96:111]
  ds_read_b64_tr_b16 v[230:231], v241 offset:19712
  s_waitcnt lgkmcnt(14)
  v_mfma_f32_32x32x16_bf16 v[112:127], v[176:179], v[204:207], v[112:127]
  v_mfma_f32_32x32x16_bf16 v[128:143], v[180:183], v[204:207], v[128:143]
  s_waitcnt lgkmcnt(12)
  v_mfma_f32_32x32x16_bf16 v[144:159], v[208:211], v[176:179], v[144:159]
  v_mfma_f32_32x32x16_bf16 v[160:175], v[208:211], v[180:183], v[160:175]
  s_waitcnt lgkmcnt(0)
  s_waitcnt vmcnt(0)
  s_barrier
  s_cmp_eq_u32 s28, 0
  s_cbranch_scc0 L_k1_sig_5
  s_lshl_b32 s47, s29, 2
  v_mov_b32 v2, 1
  v_cmp_eq_u32 vcc, 0, v1
  v_mov_b32 v3, 0x7ffffff0
  s_nop 0
  v_cndmask_b32 v3, v3, 0, vcc
  buffer_atomic_add v2, v3, s[4:7], s47 offen sc1
L_k1_sig_5:
  v_mfma_f32_32x32x16_bf16 v[16:31], v[212:215], v[184:187], v[16:31]
  ds_read_b128 v[176:179], v236 offset:0
  ds_read_b64_tr_b16 v[192:193], v242 offset:0
  ds_read_b64_tr_b16 v[194:195], v242 offset:256
  v_mfma_f32_32x32x16_bf16 v[32:47], v[212:215], v[188:191], v[32:47]
  ds_read_b128 v[180:183], v236 offset:4096
  ds_read_b64_tr_b16 v[196:197], v242 offset:4096
  v_mfma_f32_32x32x16_bf16 v[48:63], v[216:219], v[184:187], v[48:63]
  ds_read_b64_tr_b16 v[198:199], v242 offset:4352
  ds_read_b64_tr_b16 v[200:201], v242 offset:8192
  v_mfma_f32_32x32x16_bf16 v[64:79], v[216:219], v[188:191], v[64:79]
  ds_read_b64_tr_b16 v[202:203], v242 offset:8448
  ds_read_b64_tr_b16 v[204:205], v242 offset:12288
  v_mfma_f32_32x32x16_bf16 v[80:95], v[184:187], v[220:223], v[80:95]
  ds_read_b64_tr_b16 v[206:207], v242 offset:12544
  ds_read_b64_tr_b16 v[208:209], v242 offset:16384
  v_mfma_f32_32x32x16_bf16 v[96:111], v[188:191], v[220:223], v[96:111]
  ds_read_b64_tr_b16 v[210:211], v242 offset:16640
  v_mfma_f32_32x32x16_bf16 v[112:127], v[184:187], v[224:227], v[112:127]
  v_mfma_f32_32x32x16_bf16 v[128:143], v[188:191], v[224:227], v[128:143]
  v_mfma_f32_32x32x16_bf16 v[144:159], v[228:231], v[184:187], v[144:159]
  v_mfma_f32_32x32x16_bf16 v[160:175], v[228:231], v[188:191], v[160:175]
  s_waitcnt lgkmcnt(9)
  v_mfma_f32_32x32x16_bf16 v[16:31], v[192:195], v[176:179], v[16:31]
  ds_read_b128 v[184:187], v237 offset:0
  ds_read_b64_tr_b16 v[212:213], v242 offset:1024
  ds_read_b64_tr_b16 v[214:215], v242 offset:1280
  s_waitcnt lgkmcnt(11)
  v_mfma_f32_32x32x16_bf16 v[32:47], v[192:195], v[180:183], v[32:47]
  ds_read_b128 v[188:191], v237 offset:4096
  ds_read_b64_tr_b16 v[216:217], v242 offset:5120
  s_waitcnt lgkmcnt(11)
  v_mfma_f32_32x32x16_bf16 v[48:63], v[196:199], v[176:179], v[48:63]
  ds_read_b64_tr_b16 v[218:219], v242 offset:5376
  ds_read_b64_tr_b16 v[220:221], v242 offset:9216
  v_mfma_f32_32x32x16_bf16 v[64:79], v[196:199], v[180:183], v[64:79]
  ds_read_b64_tr_b16 v[222:223], v242 offset:9472
  ds_read_b64_tr_b16 v[224:225], v242 offset:13312
  s_waitcnt lgkmcnt(13)
  v_mfma_f32_32x32x16_bf16 v[80:95], v[176:179], v[200:203], v[80:95]
  ds_read_b64_tr_b16 v[226:227], v242 offset:13568
  ds_read_b64_tr_b16 v[228:229], v242 offset:17408
  v_mfma_f32_32x32x16_bf16 v[96:111], v[180:183], v[200:203], v[96:111]
  ds_read_b64_tr_b16 v[230:231], v242 offset:17664
  s_waitcnt lgkmcnt(14)
  v_mfma_f32_32x32x16_bf16 v[112:127], v[176:179], v[204:207], v[112:127]
  v_mfma_f32_32x32x16_bf16 v[128:143], v[180:183], v[204:207], v[128:143]
  s_waitcnt lgkmcnt(12)
  v_mfma_f32_32x32x16_bf16 v[144:159], v[208:211], v[176:179], v[144:159]
  v_mfma_f32_32x32x16_bf16 v[160:175], v[208:211], v[180:183], v[160:175]
  s_waitcnt lgkmcnt(9)
  v_mfma_f32_32x32x16_bf16 v[16:31], v[212:215], v[184:187], v[16:31]
  ds_read_b128 v[176:179], v238 offset:0
  ds_read_b64_tr_b16 v[192:193], v242 offset:2048
  ds_read_b64_tr_b16 v[194:195], v242 offset:2304
  s_waitcnt lgkmcnt(11)
  v_mfma_f32_32x32x16_bf16 v[32:47], v[212:215], v[188:191], v[32:47]
  ds_read_b128 v[180:183], v238 offset:4096
  ds_read_b64_tr_b16 v[196:197], v242 offset:6144
  s_waitcnt lgkmcnt(11)
  v_mfma_f32_32x32x16_bf16 v[48:63], v[216:219], v[184:187], v[48:63]
  ds_read_b64_tr_b16 v[198:199], v242 offset:6400
  ds_read_b64_tr_b16 v[200:201], v242 offset:10240
  v_mfma_f32_32x32x16_bf16 v[64:79], v[216:219], v[188:191], v[64:79]
  ds_read_b64_tr_b16 v[202:203], v242 offset:10496
  ds_read_b64_tr_b16 v[204:205], v242 offset:14336
  s_waitcnt lgkmcnt(13)
  v_mfma_f32_32x32x16_bf16 v[80:95], v[184:187], v[220:223], v[80:95]
  ds_read_b64_tr_b16 v[206:207], v242 offset:14592
  ds_read_b64_tr_b16 v[208:209], v242 offset:18432
  v_mfma_f32_32x32x16_bf16 v[96:111], v[188:191], v[220:223], v[96:111]
  ds_read_b64_tr_b16 v[210:211], v242 offset:18688
  s_waitcnt lgkmcnt(14)
  v_mfma_f32_32x32x16_bf16 v[112:127], v[184:187], v[224:227], v[112:127]
  v_mfma_f32_32x32x16_bf16 v[128:143], v[188:191], v[224:227], v[128:143]
  s_waitcnt lgkmcnt(12)
  v_mfma_f32_32x32x16_bf16 v[144:159], v[228:231], v[184:187], v[144:159]
  v_mfma_f32_32x32x16_bf16 v[160:175], v[228:231], v[188:191], v[160:175]
  s_waitcnt lgkmcnt(9)
  v_mfma_f32_32x32x16_bf16 v[16:31], v[192:195], v[176:179], v[16:31]
  ds_read_b128 v[184:187], v239 offset:0
  ds_read_b64_tr_b16 v[212:213], v242 offset:3072
  ds_read_b64_tr_b16 v[214:215], v242 offset:3328
  s_waitcnt lgkmcnt(11)
  v_mfma_f32_32x32x16_bf16 v[32:47], v[192:195], v[180:183], v[32:47]
  ds_read_b128 v[188:191], v239 offset:4096
  ds_read_b64_tr_b16 v[216:217], v242 offset:7168
  s_waitcnt lgkmcnt(11)
  v_mfma_f32_32x32x16_bf16 v[48:63], v[196:199], v[176:179], v[48:63]
  ds_read_b64_tr_b16 v[218:219], v242 offset:7424
  ds_read_b64_tr_b16 v[220:221], v242 offset:11264
  v_mfma_f32_32x32x16_bf16 v[64:79], v[196:199], v[180:183], v[64:79]
  ds_read_b64_tr_b16 v[222:223], v242 offset:11520
  ds_read_b64_tr_b16 v[224:225], v242 offset:15360
  s_waitcnt lgkmcnt(13)
  v_mfma_f32_32x32x16_bf16 v[80:95], v[176:179], v[200:203], v[80:95]
  ds_read_b64_tr_b16 v[226:227], v242 offset:15616
  ds_read_b64_tr_b16 v[228:229], v242 offset:19456
  v_mfma_f32_32x32x16_bf16 v[96:111], v[180:183], v[200:203], v[96:111]
  ds_read_b64_tr_b16 v[230:231], v242 offset:19712
  s_waitcnt lgkmcnt(14)
  v_mfma_f32_32x32x16_bf16 v[112:127], v[176:179], v[204:207], v[112:127]
  v_mfma_f32_32x32x16_bf16 v[128:143], v[180:183], v[204:207], v[128:143]
  s_waitcnt lgkmcnt(12)
  v_mfma_f32_32x32x16_bf16 v[144:159], v[208:211], v[176:179], v[144:159]
  v_mfma_f32_32x32x16_bf16 v[160:175], v[208:211], v[180:183], v[160:175]
  s_waitcnt lgkmcnt(0)
  s_barrier
  v_mfma_f32_32x32x16_bf16 v[16:31], v[212:215], v[184:187], v[16:31]
  ds_read_b128 v[176:179], v232 offset:0
  ds_read_b64_tr_b16 v[192:193], v240 offset:0
  ds_read_b64_tr_b16 v[194:195], v240 offset:256
  v_mfma_f32_32x32x16_bf16 v[32:47], v[212:215], v[188:191], v[32:47]
  ds_read_b128 v[180:183], v232 offset:4096
  ds_read_b64_tr_b16 v[196:197], v240 offset:4096
  v_mfma_f32_32x32x16_bf16 v[48:63], v[216:219], v[184:187], v[48:63]
  ds_read_b64_tr_b16 v[198:199], v240 offset:4352
  ds_read_b64_tr_b16 v[200:201], v240 offset:8192
  v_mfma_f32_32x32x16_bf16 v[64:79], v[216:219], v[188:191], v[64:79]
  ds_read_b64_tr_b16 v[202:203], v240 offset:8448
  ds_read_b64_tr_b16 v[204:205], v240 offset:12288
  v_mfma_f32_32x32x16_bf16 v[80:95], v[184:187], v[220:223], v[80:95]
  ds_read_b64_tr_b16 v[206:207], v240 offset:12544
  ds_read_b64_tr_b16 v[208:209], v240 offset:16384
  v_mfma_f32_32x32x16_bf16 v[96:111], v[188:191], v[220:223], v[96:111]
  ds_read_b64_tr_b16 v[210:211], v240 offset:16640
  v_mfma_f32_32x32x16_bf16 v[112:127], v[184:187], v[224:227], v[112:127]
  v_mfma_f32_32x32x16_bf16 v[128:143], v[188:191], v[224:227], v[128:143]
  v_mfma_f32_32x32x16_bf16 v[144:159], v[228:231], v[184:187], v[144:159]
  v_mfma_f32_32x32x16_bf16 v[160:175], v[228:231], v[188:191], v[160:175]
  s_waitcnt lgkmcnt(9)
  v_mfma_f32_32x32x16_bf16 v[16:31], v[192:195], v[176:179], v[16:31]
  ds_read_b128 v[184:187], v233 offset:0
  ds_read_b64_tr_b16 v[212:213], v240 offset:1024
  ds_read_b64_tr_b16 v[214:215], v240 offset:1280
  s_waitcnt lgkmcnt(11)
  v_mfma_f32_32x32x16_bf16 v[32:47], v[192:195], v[180:183], v[32:47]
  ds_read_b128 v[188:191], v233 offset:4096
  ds_read_b64_tr_b16 v[216:217], v240 offset:5120
  s_waitcnt lgkmcnt(11)
  v_mfma_f32_32x32x16_bf16 v[48:63], v[196:199], v[176:179], v[48:63]
  ds_read_b64_tr_b16 v[218:219], v240 offset:5376
  ds_read_b64_tr_b16 v[220:221], v240 offset:9216
  v_mfma_f32_32x32x16_bf16 v[64:79], v[196:199], v[180:183], v[64:79]
  ds_read_b64_tr_b16 v[222:223], v240 offset:9472
  ds_read_b64_tr_b16 v[224:225], v240 offset:13312
  s_waitcnt lgkmcnt(13)
  v_mfma_f32_32x32x16_bf16 v[80:95], v[176:179], v[200:203], v[80:95]
  ds_read_b64_tr_b16 v[226:227], v240 offset:13568
  ds_read_b64_tr_b16 v[228:229], v240 offset:17408
  v_mfma_f32_32x32x16_bf16 v[96:111], v[180:183], v[200:203], v[96:111]
  ds_read_b64_tr_b16 v[230:231], v240 offset:17664
  s_waitcnt lgkmcnt(14)
  v_mfma_f32_32x32x16_bf16 v[112:127], v[176:179], v[204:207], v[112:127]
  v_mfma_f32_32x32x16_bf16 v[128:143], v[180:183], v[204:207], v[128:143]
  s_waitcnt lgkmcnt(12)
  v_mfma_f32_32x32x16_bf16 v[144:159], v[208:211], v[176:179], v[144:159]
  v_mfma_f32_32x32x16_bf16 v[160:175], v[208:211], v[180:183], v[160:175]
  s_waitcnt lgkmcnt(9)
  v_mfma_f32_32x32x16_bf16 v[16:31], v[212:215], v[184:187], v[16:31]
  ds_read_b128 v[176:179], v234 offset:0
  ds_read_b64_tr_b16 v[192:193], v240 offset:2048
  ds_read_b64_tr_b16 v[194:195], v240 offset:2304
  s_waitcnt lgkmcnt(11)
  v_mfma_f32_32x32x16_bf16 v[32:47], v[212:215], v[188:191], v[32:47]
  ds_read_b128 v[180:183], v234 offset:4096
  ds_read_b64_tr_b16 v[196:197], v240 offset:6144
  s_waitcnt lgkmcnt(11)
  v_mfma_f32_32x32x16_bf16 v[48:63], v[216:219], v[184:187], v[48:63]
  ds_read_b64_tr_b16 v[198:199], v240 offset:6400
  ds_read_b64_tr_b16 v[200:201], v240 offset:10240
  v_mfma_f32_32x32x16_bf16 v[64:79], v[216:219], v[188:191], v[64:79]
  ds_read_b64_tr_b16 v[202:203], v240 offset:10496
  ds_read_b64_tr_b16 v[204:205], v240 offset:14336
  s_waitcnt lgkmcnt(13)
  v_mfma_f32_32x32x16_bf16 v[80:95], v[184:187], v[220:223], v[80:95]
  ds_read_b64_tr_b16 v[206:207], v240 offset:14592
  ds_read_b64_tr_b16 v[208:209], v240 offset:18432
  v_mfma_f32_32x32x16_bf16 v[96:111], v[188:191], v[220:223], v[96:111]
  ds_read_b64_tr_b16 v[210:211], v240 offset:18688
  s_waitcnt lgkmcnt(14)
  v_mfma_f32_32x32x16_bf16 v[112:127], v[184:187], v[224:227], v[112:127]
  v_mfma_f32_32x32x16_bf16 v[128:143], v[188:191], v[224:227], v[128:143]
  s_waitcnt lgkmcnt(12)
  v_mfma_f32_32x32x16_bf16 v[144:159], v[228:231], v[184:187], v[144:159]
  v_mfma_f32_32x32x16_bf16 v[160:175], v[228:231], v[188:191], v[160:175]
  s_waitcnt lgkmcnt(9)
  v_mfma_f32_32x32x16_bf16 v[16:31], v[192:195], v[176:179], v[16:31]
  ds_read_b128 v[184:187], v235 offset:0
  ds_read_b64_tr_b16 v[212:213], v240 offset:3072
  ds_read_b64_tr_b16 v[214:215], v240 offset:3328
  s_waitcnt lgkmcnt(11)
  v_mfma_f32_32x32x16_bf16 v[32:47], v[192:195], v[180:183], v[32:47]
  ds_read_b128 v[188:191], v235 offset:4096
  ds_read_b64_tr_b16 v[216:217], v240 offset:7168
  s_waitcnt lgkmcnt(11)
  v_mfma_f32_32x32x16_bf16 v[48:63], v[196:199], v[176:179], v[48:63]
  ds_read_b64_tr_b16 v[218:219], v240 offset:7424
  ds_read_b64_tr_b16 v[220:221], v240 offset:11264
  v_mfma_f32_32x32x16_bf16 v[64:79], v[196:199], v[180:183], v[64:79]
  ds_read_b64_tr_b16 v[222:223], v240 offset:11520
  ds_read_b64_tr_b16 v[224:225], v240 offset:15360
  s_waitcnt lgkmcnt(13)
  v_mfma_f32_32x32x16_bf16 v[80:95], v[176:179], v[200:203], v[80:95]
  ds_read_b64_tr_b16 v[226:227], v240 offset:15616
  ds_read_b64_tr_b16 v[228:229], v240 offset:19456
  v_mfma_f32_32x32x16_bf16 v[96:111], v[180:183], v[200:203], v[96:111]
  ds_read_b64_tr_b16 v[230:231], v240 offset:19712
  s_waitcnt lgkmcnt(14)
  v_mfma_f32_32x32x16_bf16 v[112:127], v[176:179], v[204:207], v[112:127]
  v_mfma_f32_32x32x16_bf16 v[128:143], v[180:183], v[204:207], v[128:143]
  s_waitcnt lgkmcnt(12)
  v_mfma_f32_32x32x16_bf16 v[144:159], v[208:211], v[176:179], v[144:159]
  v_mfma_f32_32x32x16_bf16 v[160:175], v[208:211], v[180:183], v[160:175]
  s_waitcnt lgkmcnt(0)
  s_barrier
  v_and_b32 v2, 7, v1
  v_lshlrev_b32 v249, 2, v2
  v_mov_b32 v250, 32
  v_mov_b32 v248, 0
  s_cmp_eq_u32 s28, 0
  s_cbranch_scc0 L_k1_pi_6
  buffer_load_dword v248, v249, s[4:7], 0 offen sc1
L_k1_pi_6:
  v_mfma_f32_32x32x16_bf16 v[16:31], v[212:215], v[184:187], v[16:31]
  ds_read_b128 v[176:179], v232 offset:53248
  ds_read_b64_tr_b16 v[192:193], v241 offset:0
  ds_read_b64_tr_b16 v[194:195], v241 offset:256
  v_mfma_f32_32x32x16_bf16 v[32:47], v[212:215], v[188:191], v[32:47]
  ds_read_b128 v[180:183], v232 offset:57344
  ds_read_b64_tr_b16 v[196:197], v241 offset:4096
  v_mfma_f32_32x32x16_bf16 v[48:63], v[216:219], v[184:187], v[48:63]
  ds_read_b64_tr_b16 v[198:199], v241 offset:4352
  ds_read_b64_tr_b16 v[200:201], v241 offset:8192
  v_mfma_f32_32x32x16_bf16 v[64:79], v[216:219], v[188:191], v[64:79]
  ds_read_b64_tr_b16 v[202:203], v241 offset:8448
  ds_read_b64_tr_b16 v[204:205], v241 offset:12288
  v_mfma_f32_32x32x16_bf16 v[80:95], v[184:187], v[220:223], v[80:95]
  ds_read_b64_tr_b16 v[206:207], v241 offset:12544
  ds_read_b64_tr_b16 v[208:209], v241 offset:16384
  v_mfma_f32_32x32x16_bf16 v[96:111], v[188:191], v[220:223], v[96:111]
  ds_read_b64_tr_b16 v[210:211], v241 offset:16640
  v_mfma_f32_32x32x16_bf16 v[112:127], v[184:187], v[224:227], v[112:127]
  v_mfma_f32_32x32x16_bf16 v[128:143], v[188:191], v[224:227], v[128:143]
  v_mfma_f32_32x32x16_bf16 v[144:159], v[228:231], v[184:187], v[144:159]
  v_mfma_f32_32x32x16_bf16 v[160:175], v[228:231], v[188:191], v[160:175]
  s_waitcnt lgkmcnt(9)
  v_mfma_f32_32x32x16_bf16 v[16:31], v[192:195], v[176:179], v[16:31]
  ds_read_b128 v[184:187], v233 offset:53248
  ds_read_b64_tr_b16 v[212:213], v241 offset:1024
  ds_read_b64_tr_b16 v[214:215], v241 offset:1280
  s_waitcnt lgkmcnt(11)
  v_mfma_f32_32x32x16_bf16 v[32:47], v[192:195], v[180:183], v[32:47]
  ds_read_b128 v[188:191], v233 offset:57344
  ds_read_b64_tr_b16 v[216:217], v241 offset:5120
  s_waitcnt lgkmcnt(11)
  v_mfma_f32_32x32x16_bf16 v[48:63], v[196:199], v[176:179], v[48:63]
  ds_read_b64_tr_b16 v[218:219], v241 offset:5376
  ds_read_b64_tr_b16 v[220:221], v241 offset:9216
  v_mfma_f32_32x32x16_bf16 v[64:79], v[196:199], v[180:183], v[64:79]
  ds_read_b64_tr_b16 v[222:223], v241 offset:9472
  ds_read_b64_tr_b16 v[224:225], v241 offset:13312
  s_waitcnt lgkmcnt(13)
  v_mfma_f32_32x32x16_bf16 v[80:95], v[176:179], v[200:203], v[80:95]
  ds_read_b64_tr_b16 v[226:227], v241 offset:13568
  ds_read_b64_tr_b16 v[228:229], v241 offset:17408
  v_mfma_f32_32x32x16_bf16 v[96:111], v[180:183], v[200:203], v[96:111]
  ds_read_b64_tr_b16 v[230:231], v241 offset:17664
  s_waitcnt lgkmcnt(14)
  v_mfma_f32_32x32x16_bf16 v[112:127], v[176:179], v[204:207], v[112:127]
  v_mfma_f32_32x32x16_bf16 v[128:143], v[180:183], v[204:207], v[128:143]
  s_waitcnt lgkmcnt(12)
  v_mfma_f32_32x32x16_bf16 v[144:159], v[208:211], v[176:179], v[144:159]
  v_mfma_f32_32x32x16_bf16 v[160:175], v[208:211], v[180:183], v[160:175]
  s_waitcnt lgkmcnt(9)
  v_mfma_f32_32x32x16_bf16 v[16:31], v[212:215], v[184:187], v[16:31]
  ds_read_b128 v[176:179], v234 offset:53248
  ds_read_b64_tr_b16 v[192:193], v241 offset:2048
  ds_read_b64_tr_b16 v[194:195], v241 offset:2304
  s_waitcnt lgkmcnt(11)
  v_mfma_f32_32x32x16_bf16 v[32:47], v[212:215], v[188:191], v[32:47]
  ds_read_b128 v[180:183], v234 offset:57344
  ds_read_b64_tr_b16 v[196:197], v241 offset:6144
  s_waitcnt lgkmcnt(11)
  v_mfma_f32_32x32x16_bf16 v[48:63], v[216:219], v[184:187], v[48:63]
  ds_read_b64_tr_b16 v[198:199], v241 offset:6400
  ds_read_b64_tr_b16 v[200:201], v241 offset:10240
  v_mfma_f32_32x32x16_bf16 v[64:79], v[216:219], v[188:191], v[64:79]
  ds_read_b64_tr_b16 v[202:203], v241 offset:10496
  ds_read_b64_tr_b16 v[204:205], v241 offset:14336
  s_waitcnt lgkmcnt(13)
  v_mfma_f32_32x32x16_bf16 v[80:95], v[184:187], v[220:223], v[80:95]
  ds_read_b64_tr_b16 v[206:207], v241 offset:14592
  ds_read_b64_tr_b16 v[208:209], v241 offset:18432
  v_mfma_f32_32x32x16_bf16 v[96:111], v[188:191], v[220:223], v[96:111]
  ds_read_b64_tr_b16 v[210:211], v241 offset:18688
  s_waitcnt lgkmcnt(14)
  v_mfma_f32_32x32x16_bf16 v[112:127], v[184:187], v[224:227], v[112:127]
  v_mfma_f32_32x32x16_bf16 v[128:143], v[188:191], v[224:227], v[128:143]
  s_waitcnt lgkmcnt(12)
  v_mfma_f32_32x32x16_bf16 v[144:159], v[228:231], v[184:187], v[144:159]
  v_mfma_f32_32x32x16_bf16 v[160:175], v[228:231], v[188:191], v[160:175]
  s_waitcnt lgkmcnt(9)
  v_mfma_f32_32x32x16_bf16 v[16:31], v[192:195], v[176:179], v[16:31]
  ds_read_b128 v[184:187], v235 offset:53248
  ds_read_b64_tr_b16 v[212:213], v241 offset:3072
  ds_read_b64_tr_b16 v[214:215], v241 offset:3328
  s_waitcnt lgkmcnt(11)
  v_mfma_f32_32x32x16_bf16 v[32:47], v[192:195], v[180:183], v[32:47]
  ds_read_b128 v[188:191], v235 offset:57344
  ds_read_b64_tr_b16 v[216:217], v241 offset:7168
  s_waitcnt lgkmcnt(11)
  v_mfma_f32_32x32x16_bf16 v[48:63], v[196:199], v[176:179], v[48:63]
  ds_read_b64_tr_b16 v[218:219], v241 offset:7424
  ds_read_b64_tr_b16 v[220:221], v241 offset:11264
  v_mfma_f32_32x32x16_bf16 v[64:79], v[196:199], v[180:183], v[64:79]
  ds_read_b64_tr_b16 v[222:223], v241 offset:11520
  ds_read_b64_tr_b16 v[224:225], v241 offset:15360
  s_waitcnt lgkmcnt(13)
  v_mfma_f32_32x32x16_bf16 v[80:95], v[176:179], v[200:203], v[80:95]
  ds_read_b64_tr_b16 v[226:227], v241 offset:15616
  ds_read_b64_tr_b16 v[228:229], v241 offset:19456
  v_mfma_f32_32x32x16_bf16 v[96:111], v[180:183], v[200:203], v[96:111]
  ds_read_b64_tr_b16 v[230:231], v241 offset:19712
  s_waitcnt lgkmcnt(14)
  v_mfma_f32_32x32x16_bf16 v[112:127], v[176:179], v[204:207], v[112:127]
  v_mfma_f32_32x32x16_bf16 v[128:143], v[180:183], v[204:207], v[128:143]
  s_waitcnt lgkmcnt(12)
  v_mfma_f32_32x32x16_bf16 v[144:159], v[208:211], v[176:179], v[144:159]
  v_mfma_f32_32x32x16_bf16 v[160:175], v[208:211], v[180:183], v[160:175]
  s_waitcnt lgkmcnt(0)
  s_waitcnt vmcnt(0)
  s_cmp_eq_u32 s28, 0
  s_cbranch_scc0 L_k1_rdy_7
  v_cmp_ge_u32 vcc, v248, v250
  s_nop 3
  s_cmp_eq_u64 vcc, exec
  s_cbranch_scc1 L_k1_rdy_7
  s_mov_b32 s46, 0
L_k1_spin_8:
  s_sleep 8
  buffer_load_dword v248, v249, s[4:7], 0 offen sc1
  s_waitcnt vmcnt(0)
  v_cmp_ge_u32 vcc, v248, v250
  s_nop 3
  s_cmp_eq_u64 vcc, exec
  s_cbranch_scc1 L_k1_rdy_7
  s_add_u32 s46, s46, 1
  s_cmp_lt_u32 s46, 262144
  s_cbranch_scc1 L_k1_spin_8
L_k1_rdy_7:
  s_barrier
  v_and_b32 v2, 31, v1
  v_lshrrev_b32 v3, 3, v2
  v_lshlrev_b32 v3, 7, v3
  v_and_b32 v2, 7, v2
  v_lshl_add_u32 v3, v2, 3, v3
  s_lshl_b32 s42, s29, 5
  s_lshl_b32 s43, s28, 3
  s_add_u32 s42, s42, s43
  s_lshl_b32 s42, s42, 7
  s_add_u32 s42, s42, 20971520
  buffer_load_dwordx2 v[244:245], v3, s[20:23], s42 offen offset:0 sc1
  buffer_load_dwordx2 v[246:247], v3, s[20:23], s42 offen offset:512 sc1
  v_mfma_f32_32x32x16_bf16 v[16:31], v[212:215], v[184:187], v[16:31]
  ds_read_b128 v[176:179], v236 offset:0
  ds_read_b64_tr_b16 v[192:193], v242 offset:0
  ds_read_b64_tr_b16 v[194:195], v242 offset:256
  v_mfma_f32_32x32x16_bf16 v[32:47], v[212:215], v[188:191], v[32:47]
  ds_read_b128 v[180:183], v236 offset:4096
  ds_read_b64_tr_b16 v[196:197], v242 offset:4096
  v_mfma_f32_32x32x16_bf16 v[48:63], v[216:219], v[184:187], v[48:63]
  ds_read_b64_tr_b16 v[198:199], v242 offset:4352
  ds_read_b64_tr_b16 v[200:201], v242 offset:8192
  v_mfma_f32_32x32x16_bf16 v[64:79], v[216:219], v[188:191], v[64:79]
  ds_read_b64_tr_b16 v[202:203], v242 offset:8448
  ds_read_b64_tr_b16 v[204:205], v242 offset:12288
  v_mfma_f32_32x32x16_bf16 v[80:95], v[184:187], v[220:223], v[80:95]
  ds_read_b64_tr_b16 v[206:207], v242 offset:12544
  ds_read_b64_tr_b16 v[208:209], v242 offset:16384
  v_mfma_f32_32x32x16_bf16 v[96:111], v[188:191], v[220:223], v[96:111]
  ds_read_b64_tr_b16 v[210:211], v242 offset:16640
  v_mfma_f32_32x32x16_bf16 v[112:127], v[184:187], v[224:227], v[112:127]
  v_mfma_f32_32x32x16_bf16 v[128:143], v[188:191], v[224:227], v[128:143]
  v_mfma_f32_32x32x16_bf16 v[144:159], v[228:231], v[184:187], v[144:159]
  v_mfma_f32_32x32x16_bf16 v[160:175], v[228:231], v[188:191], v[160:175]
  s_waitcnt lgkmcnt(9)
  v_mfma_f32_32x32x16_bf16 v[16:31], v[192:195], v[176:179], v[16:31]
  ds_read_b128 v[184:187], v237 offset:0
  ds_read_b64_tr_b16 v[212:213], v242 offset:1024
  ds_read_b64_tr_b16 v[214:215], v242 offset:1280
  s_waitcnt lgkmcnt(11)
  v_mfma_f32_32x32x16_bf16 v[32:47], v[192:195], v[180:183], v[32:47]
  ds_read_b128 v[188:191], v237 offset:4096
  ds_read_b64_tr_b16 v[216:217], v242 offset:5120
  s_waitcnt lgkmcnt(11)
  v_mfma_f32_32x32x16_bf16 v[48:63], v[196:199], v[176:179], v[48:63]
  ds_read_b64_tr_b16 v[218:219], v242 offset:5376
  ds_read_b64_tr_b16 v[220:221], v242 offset:9216
  v_mfma_f32_32x32x16_bf16 v[64:79], v[196:199], v[180:183], v[64:79]
  ds_read_b64_tr_b16 v[222:223], v242 offset:9472
  ds_read_b64_tr_b16 v[224:225], v242 offset:13312
  s_waitcnt lgkmcnt(13)
  v_mfma_f32_32x32x16_bf16 v[80:95], v[176:179], v[200:203], v[80:95]
  ds_read_b64_tr_b16 v[226:227], v242 offset:13568
  ds_read_b64_tr_b16 v[228:229], v242 offset:17408
  v_mfma_f32_32x32x16_bf16 v[96:111], v[180:183], v[200:203], v[96:111]
  ds_read_b64_tr_b16 v[230:231], v242 offset:17664
  s_waitcnt lgkmcnt(14)
  v_mfma_f32_32x32x16_bf16 v[112:127], v[176:179], v[204:207], v[112:127]
  v_mfma_f32_32x32x16_bf16 v[128:143], v[180:183], v[204:207], v[128:143]
  s_waitcnt lgkmcnt(12)
  v_mfma_f32_32x32x16_bf16 v[144:159], v[208:211], v[176:179], v[144:159]
  v_mfma_f32_32x32x16_bf16 v[160:175], v[208:211], v[180:183], v[160:175]
  s_waitcnt lgkmcnt(9)
  v_mfma_f32_32x32x16_bf16 v[16:31], v[212:215], v[184:187], v[16:31]
  ds_read_b128 v[176:179], v238 offset:0
  ds_read_b64_tr_b16 v[192:193], v242 offset:2048
  ds_read_b64_tr_b16 v[194:195], v242 offset:2304
  s_waitcnt lgkmcnt(11)
  v_mfma_f32_32x32x16_bf16 v[32:47], v[212:215], v[188:191], v[32:47]
  ds_read_b128 v[180:183], v238 offset:4096
  ds_read_b64_tr_b16 v[196:197], v242 offset:6144
  s_waitcnt lgkmcnt(11)
  v_mfma_f32_32x32x16_bf16 v[48:63], v[216:219], v[184:187], v[48:63]
  ds_read_b64_tr_b16 v[198:199], v242 offset:6400
  ds_read_b64_tr_b16 v[200:201], v242 offset:10240
  v_mfma_f32_32x32x16_bf16 v[64:79], v[216:219], v[188:191], v[64:79]
  ds_read_b64_tr_b16 v[202:203], v242 offset:10496
  ds_read_b64_tr_b16 v[204:205], v242 offset:14336
  s_waitcnt lgkmcnt(13)
  v_mfma_f32_32x32x16_bf16 v[80:95], v[184:187], v[220:223], v[80:95]
  ds_read_b64_tr_b16 v[206:207], v242 offset:14592
  ds_read_b64_tr_b16 v[208:209], v242 offset:18432
  v_mfma_f32_32x32x16_bf16 v[96:111], v[188:191], v[220:223], v[96:111]
  ds_read_b64_tr_b16 v[210:211], v242 offset:18688
  s_waitcnt lgkmcnt(14)
  v_mfma_f32_32x32x16_bf16 v[112:127], v[184:187], v[224:227], v[112:127]
  v_mfma_f32_32x32x16_bf16 v[128:143], v[188:191], v[224:227], v[128:143]
  s_waitcnt lgkmcnt(12)
  v_mfma_f32_32x32x16_bf16 v[144:159], v[228:231], v[184:187], v[144:159]
  v_mfma_f32_32x32x16_bf16 v[160:175], v[228:231], v[188:191], v[160:175]
  s_waitcnt lgkmcnt(9)
  v_mfma_f32_32x32x16_bf16 v[16:31], v[192:195], v[176:179], v[16:31]
  ds_read_b128 v[184:187], v239 offset:0
  ds_read_b64_tr_b16 v[212:213], v242 offset:3072
  ds_read_b64_tr_b16 v[214:215], v242 offset:3328
  s_waitcnt lgkmcnt(11)
  v_mfma_f32_32x32x16_bf16 v[32:47], v[192:195], v[180:183], v[32:47]
  ds_read_b128 v[188:191], v239 offset:4096
  ds_read_b64_tr_b16 v[216:217], v242 offset:7168
  s_waitcnt lgkmcnt(11)
  v_mfma_f32_32x32x16_bf16 v[48:63], v[196:199], v[176:179], v[48:63]
  ds_read_b64_tr_b16 v[218:219], v242 offset:7424
  ds_read_b64_tr_b16 v[220:221], v242 offset:11264
  v_mfma_f32_32x32x16_bf16 v[64:79], v[196:199], v[180:183], v[64:79]
  ds_read_b64_tr_b16 v[222:223], v242 offset:11520
  ds_read_b64_tr_b16 v[224:225], v242 offset:15360
  s_waitcnt lgkmcnt(13)
  v_mfma_f32_32x32x16_bf16 v[80:95], v[176:179], v[200:203], v[80:95]
  ds_read_b64_tr_b16 v[226:227], v242 offset:15616
  ds_read_b64_tr_b16 v[228:229], v242 offset:19456
  v_mfma_f32_32x32x16_bf16 v[96:111], v[180:183], v[200:203], v[96:111]
  ds_read_b64_tr_b16 v[230:231], v242 offset:19712
  s_waitcnt lgkmcnt(14)
  v_mfma_f32_32x32x16_bf16 v[112:127], v[176:179], v[204:207], v[112:127]
  v_mfma_f32_32x32x16_bf16 v[128:143], v[180:183], v[204:207], v[128:143]
  s_waitcnt lgkmcnt(12)
  v_mfma_f32_32x32x16_bf16 v[144:159], v[208:211], v[176:179], v[144:159]
  v_mfma_f32_32x32x16_bf16 v[160:175], v[208:211], v[180:183], v[160:175]
  s_waitcnt lgkmcnt(0)
  s_barrier
  v_mfma_f32_32x32x16_bf16 v[16:31], v[212:215], v[184:187], v[16:31]
  ds_read_b128 v[176:179], v232 offset:0
  ds_read_b64_tr_b16 v[192:193], v240 offset:0
  ds_read_b64_tr_b16 v[194:195], v240 offset:256
  v_mfma_f32_32x32x16_bf16 v[32:47], v[212:215], v[188:191], v[32:47]
  ds_read_b128 v[180:183], v232 offset:4096
  ds_read_b64_tr_b16 v[196:197], v240 offset:4096
  v_mfma_f32_32x32x16_bf16 v[48:63], v[216:219], v[184:187], v[48:63]
  ds_read_b64_tr_b16 v[198:199], v240 offset:4352
  ds_read_b64_tr_b16 v[200:201], v240 offset:8192
  v_mfma_f32_32x32x16_bf16 v[64:79], v[216:219], v[188:191], v[64:79]
  ds_read_b64_tr_b16 v[202:203], v240 offset:8448
  ds_read_b64_tr_b16 v[204:205], v240 offset:12288
  v_mfma_f32_32x32x16_bf16 v[80:95], v[184:187], v[220:223], v[80:95]
  ds_read_b64_tr_b16 v[206:207], v240 offset:12544
  ds_read_b64_tr_b16 v[208:209], v240 offset:16384
  v_mfma_f32_32x32x16_bf16 v[96:111], v[188:191], v[220:223], v[96:111]
  ds_read_b64_tr_b16 v[210:211], v240 offset:16640
  v_mfma_f32_32x32x16_bf16 v[112:127], v[184:187], v[224:227], v[112:127]
  v_mfma_f32_32x32x16_bf16 v[128:143], v[188:191], v[224:227], v[128:143]
  v_mfma_f32_32x32x16_bf16 v[144:159], v[228:231], v[184:187], v[144:159]
  v_mfma_f32_32x32x16_bf16 v[160:175], v[228:231], v[188:191], v[160:175]
  s_waitcnt lgkmcnt(9)
  v_mfma_f32_32x32x16_bf16 v[16:31], v[192:195], v[176:179], v[16:31]
  ds_read_b128 v[184:187], v233 offset:0
  ds_read_b64_tr_b16 v[212:213], v240 offset:1024
  ds_read_b64_tr_b16 v[214:215], v240 offset:1280
  s_waitcnt lgkmcnt(11)
  v_mfma_f32_32x32x16_bf16 v[32:47], v[192:195], v[180:183], v[32:47]
  ds_read_b128 v[188:191], v233 offset:4096
  ds_read_b64_tr_b16 v[216:217], v240 offset:5120
  s_waitcnt lgkmcnt(11)
  v_mfma_f32_32x32x16_bf16 v[48:63], v[196:199], v[176:179], v[48:63]
  ds_read_b64_tr_b16 v[218:219], v240 offset:5376
  ds_read_b64_tr_b16 v[220:221], v240 offset:9216
  v_mfma_f32_32x32x16_bf16 v[64:79], v[196:199], v[180:183], v[64:79]
  ds_read_b64_tr_b16 v[222:223], v240 offset:9472
  ds_read_b64_tr_b16 v[224:225], v240 offset:13312
  s_waitcnt lgkmcnt(13)
  v_mfma_f32_32x32x16_bf16 v[80:95], v[176:179], v[200:203], v[80:95]
  ds_read_b64_tr_b16 v[226:227], v240 offset:13568
  ds_read_b64_tr_b16 v[228:229], v240 offset:17408
  v_mfma_f32_32x32x16_bf16 v[96:111], v[180:183], v[200:203], v[96:111]
  ds_read_b64_tr_b16 v[230:231], v240 offset:17664
  s_waitcnt vmcnt(0)
  v_cmp_gt_u32 vcc, 32, v1
  s_waitcnt lgkmcnt(14)
  v_mfma_f32_32x32x16_bf16 v[112:127], v[176:179], v[204:207], v[112:127]
  v_sub_f32 v15, 0, v244
  v_cndmask_b32 v15, 0, v15, vcc
  v_mfma_f32_32x32x16_bf16 v[128:143], v[180:183], v[204:207], v[128:143]
  v_cvt_pk_bf16_f32 v2, v15, v15
  v_mov_b32 v4, 0
  s_waitcnt lgkmcnt(12)
  v_mfma_f32_32x32x16_bf16 v[144:159], v[208:211], v[176:179], v[144:159]
  v_and_b32 v5, 0xffff0000, v2
  v_sub_f32 v15, v15, v5
  v_mfma_f32_32x32x16_bf16 v[160:175], v[208:211], v[180:183], v[160:175]
  v_cvt_pk_bf16_f32 v3, v15, v15
  v_mov_b32 v5, 0
  s_waitcnt lgkmcnt(9)
  v_mfma_f32_32x32x16_bf16 v[16:31], v[212:215], v[184:187], v[16:31]
  ds_read_b128 v[176:179], v234 offset:0
  ds_read_b64_tr_b16 v[192:193], v240 offset:2048
  ds_read_b64_tr_b16 v[194:195], v240 offset:2304
  s_waitcnt lgkmcnt(11)
  v_mfma_f32_32x32x16_bf16 v[32:47], v[212:215], v[188:191], v[32:47]
  ds_read_b128 v[180:183], v234 offset:4096
  ds_read_b64_tr_b16 v[196:197], v240 offset:6144
  s_waitcnt lgkmcnt(11)
  v_mfma_f32_32x32x16_bf16 v[48:63], v[216:219], v[184:187], v[48:63]
  ds_read_b64_tr_b16 v[198:199], v240 offset:6400
  ds_read_b64_tr_b16 v[200:201], v240 offset:10240
  v_mfma_f32_32x32x16_bf16 v[64:79], v[216:219], v[188:191], v[64:79]
  ds_read_b64_tr_b16 v[202:203], v240 offset:10496
  ds_read_b64_tr_b16 v[204:205], v240 offset:14336
  s_waitcnt lgkmcnt(13)
  v_mfma_f32_32x32x16_bf16 v[80:95], v[184:187], v[220:223], v[80:95]
  ds_read_b64_tr_b16 v[206:207], v240 offset:14592
  ds_read_b64_tr_b16 v[208:209], v240 offset:18432
  v_mfma_f32_32x32x16_bf16 v[96:111], v[188:191], v[220:223], v[96:111]
  ds_read_b64_tr_b16 v[210:211], v240 offset:18688
  v_mov_b32 v10, v245
  v_rsq_f32 v12, v245
  s_waitcnt lgkmcnt(14)
  v_mfma_f32_32x32x16_bf16 v[112:127], v[184:187], v[224:227], v[112:127]
  v_sub_f32 v15, 0, v246
  v_cndmask_b32 v15, 0, v15, vcc
  v_mfma_f32_32x32x16_bf16 v[128:143], v[188:191], v[224:227], v[128:143]
  v_cvt_pk_bf16_f32 v6, v15, v15
  v_mov_b32 v8, 0
  s_waitcnt lgkmcnt(12)
  v_mfma_f32_32x32x16_bf16 v[144:159], v[228:231], v[184:187], v[144:159]
  v_and_b32 v9, 0xffff0000, v6
  v_sub_f32 v15, v15, v9
  v_mfma_f32_32x32x16_bf16 v[160:175], v[228:231], v[188:191], v[160:175]
  v_cvt_pk_bf16_f32 v7, v15, v15
  v_mov_b32 v9, 0
  s_waitcnt lgkmcnt(9)
  v_mfma_f32_32x32x16_bf16 v[16:31], v[192:195], v[176:179], v[16:31]
  ds_read_b128 v[184:187], v235 offset:0
  ds_read_b64_tr_b16 v[212:213], v240 offset:3072
  ds_read_b64_tr_b16 v[214:215], v240 offset:3328
  s_waitcnt lgkmcnt(11)
  v_mfma_f32_32x32x16_bf16 v[32:47], v[192:195], v[180:183], v[32:47]
  ds_read_b128 v[188:191], v235 offset:4096
  ds_read_b64_tr_b16 v[216:217], v240 offset:7168
  s_waitcnt lgkmcnt(11)
  v_mfma_f32_32x32x16_bf16 v[48:63], v[196:199], v[176:179], v[48:63]
  ds_read_b64_tr_b16 v[218:219], v240 offset:7424
  ds_read_b64_tr_b16 v[220:221], v240 offset:11264
  v_mfma_f32_32x32x16_bf16 v[64:79], v[196:199], v[180:183], v[64:79]
  ds_read_b64_tr_b16 v[222:223], v240 offset:11520
  ds_read_b64_tr_b16 v[224:225], v240 offset:15360
  s_waitcnt lgkmcnt(13)
  v_mfma_f32_32x32x16_bf16 v[80:95], v[176:179], v[200:203], v[80:95]
  ds_read_b64_tr_b16 v[226:227], v240 offset:15616
  ds_read_b64_tr_b16 v[228:229], v240 offset:19456
  v_mfma_f32_32x32x16_bf16 v[96:111], v[180:183], v[200:203], v[96:111]
  ds_read_b64_tr_b16 v[230:231], v240 offset:19712
  v_mov_b32 v11, v247
  v_rsq_f32 v13, v247
  s_waitcnt lgkmcnt(14)
  v_mfma_f32_32x32x16_bf16 v[112:127], v[176:179], v[204:207], v[112:127]
  s_lshl_b32 s42, s28, 8
  s_add_u32 s42, s42, 126976
  v_mfma_f32_32x32x16_bf16 v[128:143], v[180:183], v[204:207], v[128:143]
  v_and_b32 v15, 31, v1
  v_lshl_add_u32 v15, v15, 2, s42
  s_waitcnt lgkmcnt(12)
  v_mfma_f32_32x32x16_bf16 v[144:159], v[208:211], v[176:179], v[144:159]
  ds_write_b32 v15, v12 offset:0
  ds_write_b32 v15, v13 offset:128
  v_mfma_f32_32x32x16_bf16 v[160:175], v[208:211], v[180:183], v[160:175]
  s_waitcnt lgkmcnt(0)
  s_barrier
  v_mfma_f32_32x32x16_bf16 v[16:31], v[212:215], v[184:187], v[16:31]
  ds_read_b128 v[176:179], v232 offset:53248
  ds_read_b128 v[180:183], v232 offset:57344
  ds_read_b64_tr_b16 v[192:193], v241 offset:8192
  v_mfma_f32_32x32x16_bf16 v[32:47], v[212:215], v[188:191], v[32:47]
  ds_read_b64_tr_b16 v[194:195], v241 offset:8448
  ds_read_b64_tr_b16 v[196:197], v241 offset:12288
  v_mfma_f32_32x32x16_bf16 v[48:63], v[216:219], v[184:187], v[48:63]
  ds_read_b64_tr_b16 v[198:199], v241 offset:12544
  v_mfma_f32_32x32x16_bf16 v[64:79], v[216:219], v[188:191], v[64:79]
  v_mfma_f32_32x32x16_bf16 v[80:95], v[184:187], v[220:223], v[80:95]
  v_mfma_f32_32x32x16_bf16 v[96:111], v[188:191], v[220:223], v[96:111]
  v_mfma_f32_32x32x16_bf16 v[112:127], v[184:187], v[224:227], v[112:127]
  v_mfma_f32_32x32x16_bf16 v[128:143], v[188:191], v[224:227], v[128:143]
  v_mfma_f32_32x32x16_bf16 v[144:159], v[228:231], v[184:187], v[144:159]
  v_mfma_f32_32x32x16_bf16 v[160:175], v[228:231], v[188:191], v[160:175]
  v_and_b32 v15, 0x33, v1
  v_bfe_u32 v246, v1, 2, 1
  v_lshl_or_b32 v15, v246, 3, v15
  v_bfe_u32 v246, v1, 3, 1
  v_lshl_or_b32 v15, v246, 2, v15
  v_lshlrev_b32 v15, 4, v15
  s_cmp_lt_u32 s30, 16
  s_cselect_b64 vcc, -1, 0
  v_cndmask_b32 v246, v15, v14, vcc
  v_and_b32 v15, 31, v1
  v_lshlrev_b32 v15, 4, v15
  v_add_u32 v242, 159744, v15
  v_bfe_u32 v15, v1, 4, 1
  v_lshlrev_b32 v15, 16, v15
  v_and_b32 v244, 15, v1
  v_lshl_add_u32 v15, v244, 4, v15
  v_lshrrev_b32 v244, 5, v1
  v_lshl_add_u32 v244, v244, 8, v15
  s_lshl_b32 s42, s28, 8
  s_add_u32 s42, s42, 126976
  v_lshrrev_b32 v15, 5, v1
  v_lshl_add_u32 v245, v15, 4, s42
  s_waitcnt lgkmcnt(2)
  v_mfma_f32_32x32x16_bf16 v[80:95], v[176:179], v[192:195], v[80:95]
  ds_read_b128 v[184:187], v233 offset:53248
  ds_read_b128 v[188:191], v233 offset:57344
  v_mfma_f32_32x32x16_bf16 v[96:111], v[180:183], v[192:195], v[96:111]
  ds_read_b64_tr_b16 v[200:201], v241 offset:9216
  ds_read_b64_tr_b16 v[202:203], v241 offset:9472
  s_waitcnt lgkmcnt(4)
  v_mfma_f32_32x32x16_bf16 v[112:127], v[176:179], v[196:199], v[112:127]
  ds_read_b64_tr_b16 v[204:205], v241 offset:13312
  ds_read_b64_tr_b16 v[206:207], v241 offset:13568
  v_mfma_f32_32x32x16_bf16 v[128:143], v[180:183], v[196:199], v[128:143]
  s_waitcnt lgkmcnt(2)
  v_mfma_f32_32x32x16_bf16 v[80:95], v[184:187], v[200:203], v[80:95]
  ds_read_b128 v[176:179], v234 offset:53248
  ds_read_b128 v[180:183], v234 offset:57344
  v_mfma_f32_32x32x16_bf16 v[96:111], v[188:191], v[200:203], v[96:111]
  ds_read_b64_tr_b16 v[192:193], v241 offset:10240
  ds_read_b64_tr_b16 v[194:195], v241 offset:10496
  s_waitcnt lgkmcnt(4)
  v_mfma_f32_32x32x16_bf16 v[112:127], v[184:187], v[204:207], v[112:127]
  ds_read_b64_tr_b16 v[196:197], v241 offset:14336
  ds_read_b64_tr_b16 v[198:199], v241 offset:14592
  v_mfma_f32_32x32x16_bf16 v[128:143], v[188:191], v[204:207], v[128:143]
  s_waitcnt lgkmcnt(2)
  v_mfma_f32_32x32x16_bf16 v[80:95], v[176:179], v[192:195], v[80:95]
  ds_read_b128 v[184:187], v235 offset:53248
  ds_read_b128 v[188:191], v235 offset:57344
  v_mfma_f32_32x32x16_bf16 v[96:111], v[180:183], v[192:195], v[96:111]
  ds_read_b64_tr_b16 v[200:201], v241 offset:11264
  ds_read_b64_tr_b16 v[202:203], v241 offset:11520
  s_waitcnt lgkmcnt(4)
  v_mfma_f32_32x32x16_bf16 v[112:127], v[176:179], v[196:199], v[112:127]
  ds_read_b64_tr_b16 v[204:205], v241 offset:15360
  ds_read_b64_tr_b16 v[206:207], v241 offset:15616
  v_mfma_f32_32x32x16_bf16 v[128:143], v[180:183], v[196:199], v[128:143]
  s_barrier
  s_waitcnt lgkmcnt(2)
  v_mfma_f32_32x32x16_bf16 v[80:95], v[184:187], v[200:203], v[80:95]
  ds_read_b128 v[192:195], v242 offset:1024
  v_mfma_f32_32x32x16_bf16 v[96:111], v[188:191], v[200:203], v[96:111]
  ds_read_b128 v[196:199], v242 offset:1536
  s_waitcnt lgkmcnt(2)
  v_mfma_f32_32x32x16_bf16 v[112:127], v[184:187], v[204:207], v[112:127]
  v_mfma_f32_32x32x16_bf16 v[128:143], v[188:191], v[204:207], v[128:143]
  s_waitcnt lgkmcnt(1)
  v_mfma_f32_32x32x16_bf16 v[80:95], v[2:5], v[192:195], v[80:95]
  ds_read_b128 v[184:187], v232 offset:53248
  v_mfma_f32_32x32x16_bf16 v[96:111], v[6:9], v[192:195], v[96:111]
  ds_read_b128 v[188:191], v232 offset:57344
  s_waitcnt lgkmcnt(2)
  v_mfma_f32_32x32x16_bf16 v[112:127], v[2:5], v[196:199], v[112:127]
  ds_read_b64_tr_b16 v[200:201], v241 offset:16384
  v_mfma_f32_32x32x16_bf16 v[128:143], v[6:9], v[196:199], v[128:143]
  ds_read_b64_tr_b16 v[202:203], v241 offset:16640
  s_waitcnt lgkmcnt(0)
  v_mfma_f32_32x32x16_bf16 v[144:159], v[200:203], v[184:187], v[144:159]
  ds_read_b128 v[176:179], v233 offset:53248
  ds_read_b128 v[180:183], v233 offset:57344
  v_mfma_f32_32x32x16_bf16 v[160:175], v[200:203], v[188:191], v[160:175]
  ds_read_b64_tr_b16 v[192:193], v241 offset:17408
  ds_read_b64_tr_b16 v[194:195], v241 offset:17664
  s_waitcnt lgkmcnt(0)
  v_mfma_f32_32x32x16_bf16 v[144:159], v[192:195], v[176:179], v[144:159]
  ds_read_b128 v[184:187], v234 offset:53248
  ds_read_b128 v[188:191], v234 offset:57344
  ds_read_b128 v[208:211], v245 offset:0
  ds_read_b128 v[212:215], v245 offset:32
  ds_read_b128 v[216:219], v245 offset:64
  ds_read_b128 v[220:223], v245 offset:96
  s_sub_u32 s42, s30, 24
  s_lshl_b32 s42, s42, 1
  s_add_u32 s42, s42, 0
  s_lshl_b32 s42, s42, 17
  s_add_u32 s43, s33, 0
  s_lshl_b32 s43, s43, 10
  s_add_u32 s42, s42, s43
  s_add_u32 s42, s42, 4194304
  s_waitcnt lgkmcnt(0)
  v_mul_f32 v80, v80, v208
  v_mul_f32 v81, v81, v209
  v_mul_f32 v82, v82, v210
  v_mul_f32 v83, v83, v211
  v_mul_f32 v84, v84, v212
  v_mfma_f32_32x32x16_bf16 v[160:175], v[192:195], v[180:183], v[160:175]
  ds_read_b64_tr_b16 v[200:201], v241 offset:18432
  ds_read_b64_tr_b16 v[202:203], v241 offset:18688
  v_mul_f32 v85, v85, v213
  v_mul_f32 v86, v86, v214
  v_mul_f32 v87, v87, v215
  v_mul_f32 v88, v88, v216
  v_mul_f32 v89, v89, v217
  v_mul_f32 v90, v90, v218
  v_mul_f32 v91, v91, v219
  v_mul_f32 v92, v92, v220
  v_mul_f32 v93, v93, v221
  v_mul_f32 v94, v94, v222
  v_mul_f32 v95, v95, v223
  v_cvt_pk_bf16_f32 v224, v80, v81
  v_cvt_pk_bf16_f32 v225, v82, v83
  v_cvt_pk_bf16_f32 v226, v84, v85
  v_cvt_pk_bf16_f32 v227, v86, v87
  buffer_store_dwordx4 v[224:227], v244, s[20:23], s42 offen offset:0 sc1
  v_cvt_pk_bf16_f32 v228, v88, v89
  v_cvt_pk_bf16_f32 v229, v90, v91
  s_waitcnt lgkmcnt(0)
  v_mfma_f32_32x32x16_bf16 v[144:159], v[200:203], v[184:187], v[144:159]
  ds_read_b128 v[176:179], v235 offset:53248
  ds_read_b128 v[180:183], v235 offset:57344
  v_cvt_pk_bf16_f32 v230, v92, v93
  v_cvt_pk_bf16_f32 v231, v94, v95
  buffer_store_dwordx4 v[228:231], v244, s[20:23], s42 offen offset:512 sc1
  s_sub_u32 s42, s30, 24
  s_lshl_b32 s42, s42, 1
  s_add_u32 s42, s42, 1
  s_lshl_b32 s42, s42, 17
  s_add_u32 s43, s33, 0
  s_lshl_b32 s43, s43, 10
  s_add_u32 s42, s42, s43
  s_add_u32 s42, s42, 4194304
  v_mul_f32 v112, v112, v208
  v_mul_f32 v113, v113, v209
  v_mul_f32 v114, v114, v210
  v_mul_f32 v115, v115, v211
  v_mul_f32 v116, v116, v212
  v_mul_f32 v117, v117, v213
  v_mul_f32 v118, v118, v214
  v_mfma_f32_32x32x16_bf16 v[160:175], v[200:203], v[188:191], v[160:175]
  ds_read_b64_tr_b16 v[192:193], v241 offset:19456
  ds_read_b64_tr_b16 v[194:195], v241 offset:19712
  v_mul_f32 v119, v119, v215
  v_mul_f32 v120, v120, v216
  v_mul_f32 v121, v121, v217
  v_mul_f32 v122, v122, v218
  v_mul_f32 v123, v123, v219
  v_mul_f32 v124, v124, v220
  v_mul_f32 v125, v125, v221
  v_mul_f32 v126, v126, v222
  v_mul_f32 v127, v127, v223
  ds_read_b128 v[208:211], v245 offset:128
  ds_read_b128 v[212:215], v245 offset:160
  ds_read_b128 v[216:219], v245 offset:192
  ds_read_b128 v[220:223], v245 offset:224
  v_cvt_pk_bf16_f32 v224, v112, v113
  v_cvt_pk_bf16_f32 v225, v114, v115
  v_cvt_pk_bf16_f32 v226, v116, v117
  v_cvt_pk_bf16_f32 v227, v118, v119
  buffer_store_dwordx4 v[224:227], v244, s[20:23], s42 offen offset:0 sc1
  v_cvt_pk_bf16_f32 v228, v120, v121
  s_waitcnt lgkmcnt(4)
  v_mfma_f32_32x32x16_bf16 v[144:159], v[192:195], v[176:179], v[144:159]
  ds_read_b128 v[200:203], v242 offset:2048
  v_cvt_pk_bf16_f32 v229, v122, v123
  v_cvt_pk_bf16_f32 v230, v124, v125
  v_cvt_pk_bf16_f32 v231, v126, v127
  buffer_store_dwordx4 v[228:231], v244, s[20:23], s42 offen offset:512 sc1
  s_sub_u32 s42, s30, 24
  s_lshl_b32 s42, s42, 1
  s_add_u32 s42, s42, 0
  s_lshl_b32 s42, s42, 17
  s_add_u32 s43, s33, 1
  s_lshl_b32 s43, s43, 10
  s_add_u32 s42, s42, s43
  s_add_u32 s42, s42, 4194304
  s_waitcnt lgkmcnt(1)
  v_mul_f32 v96, v96, v208
  v_mul_f32 v97, v97, v209
  v_mul_f32 v98, v98, v210
  v_mul_f32 v99, v99, v211
  v_mul_f32 v100, v100, v212
  v_mfma_f32_32x32x16_bf16 v[160:175], v[192:195], v[180:183], v[160:175]
  v_mul_f32 v101, v101, v213
  v_mul_f32 v102, v102, v214
  v_mul_f32 v103, v103, v215
  v_mul_f32 v104, v104, v216
  v_mul_f32 v105, v105, v217
  v_mul_f32 v106, v106, v218
  v_mul_f32 v107, v107, v219
  v_mul_f32 v108, v108, v220
  v_mul_f32 v109, v109, v221
  v_mul_f32 v110, v110, v222
  v_mul_f32 v111, v111, v223
  v_cvt_pk_bf16_f32 v224, v96, v97
  v_cvt_pk_bf16_f32 v225, v98, v99
  v_cvt_pk_bf16_f32 v226, v100, v101
  v_cvt_pk_bf16_f32 v227, v102, v103
  buffer_store_dwordx4 v[224:227], v244, s[20:23], s42 offen offset:0 sc1
  v_cvt_pk_bf16_f32 v228, v104, v105
  v_cvt_pk_bf16_f32 v229, v106, v107
  s_waitcnt lgkmcnt(0)
  v_mfma_f32_32x32x16_bf16 v[144:159], v[200:203], v[2:5], v[144:159]
  ds_read_b128 v[176:179], v232 offset:53248
  ds_read_b128 v[180:183], v232 offset:57344
  ds_read_b64_tr_b16 v[192:193], v241 offset:0
  v_cvt_pk_bf16_f32 v230, v108, v109
  v_cvt_pk_bf16_f32 v231, v110, v111
  buffer_store_dwordx4 v[228:231], v244, s[20:23], s42 offen offset:512 sc1
  s_sub_u32 s42, s30, 24
  s_lshl_b32 s42, s42, 1
  s_add_u32 s42, s42, 1
  s_lshl_b32 s42, s42, 17
  s_add_u32 s43, s33, 1
  s_lshl_b32 s43, s43, 10
  s_add_u32 s42, s42, s43
  s_add_u32 s42, s42, 4194304
  v_mul_f32 v128, v128, v208
  v_mul_f32 v129, v129, v209
  v_mul_f32 v130, v130, v210
  v_mul_f32 v131, v131, v211
  v_mul_f32 v132, v132, v212
  v_mul_f32 v133, v133, v213
  v_mul_f32 v134, v134, v214
  v_mfma_f32_32x32x16_bf16 v[160:175], v[200:203], v[6:9], v[160:175]
  ds_read_b64_tr_b16 v[194:195], v241 offset:256
  ds_read_b64_tr_b16 v[196:197], v241 offset:4096
  ds_read_b64_tr_b16 v[198:199], v241 offset:4352
  v_mul_f32 v135, v135, v215
  v_mul_f32 v136, v136, v216
  v_mul_f32 v137, v137, v217
  v_mul_f32 v138, v138, v218
  v_mul_f32 v139, v139, v219
  v_mul_f32 v140, v140, v220
  v_mul_f32 v141, v141, v221
  v_mul_f32 v142, v142, v222
  v_mul_f32 v143, v143, v223
  v_cvt_pk_bf16_f32 v224, v128, v129
  v_cvt_pk_bf16_f32 v225, v130, v131
  v_cvt_pk_bf16_f32 v226, v132, v133
  v_cvt_pk_bf16_f32 v227, v134, v135
  buffer_store_dwordx4 v[224:227], v244, s[20:23], s42 offen offset:0 sc1
  v_cvt_pk_bf16_f32 v228, v136, v137
  v_cvt_pk_bf16_f32 v229, v138, v139
  v_cvt_pk_bf16_f32 v230, v140, v141
  v_cvt_pk_bf16_f32 v231, v142, v143
  buffer_store_dwordx4 v[228:231], v244, s[20:23], s42 offen offset:512 sc1
  s_waitcnt lgkmcnt(2)
  v_mfma_f32_32x32x16_bf16 v[16:31], v[192:195], v[176:179], v[16:31]
  ds_read_b128 v[184:187], v233 offset:53248
  ds_read_b128 v[188:191], v233 offset:57344
  v_mfma_f32_32x32x16_bf16 v[32:47], v[192:195], v[180:183], v[32:47]
  ds_read_b64_tr_b16 v[200:201], v241 offset:1024
  ds_read_b64_tr_b16 v[202:203], v241 offset:1280
  s_waitcnt lgkmcnt(4)
  v_mfma_f32_32x32x16_bf16 v[48:63], v[196:199], v[176:179], v[48:63]
  ds_read_b64_tr_b16 v[204:205], v241 offset:5120
  ds_read_b64_tr_b16 v[206:207], v241 offset:5376
  s_cmp_lt_u32 s30, 16
  s_cselect_b32 s42, 0x3eb8aa3b, 0x3f800000
  s_lshl_b32 s43, s30, 17
  s_lshl_b32 s44, s33, 10
  s_add_u32 s43, s43, s44
  s_add_u32 s43, s43, 0
  s_add_u32 s44, s43, 65536
  v_mfma_f32_32x32x16_bf16 v[64:79], v[196:199], v[180:183], v[64:79]
  v_mul_f32 v15, s42, v12
  v_mul_f32 v144, v144, v15
  v_mul_f32 v145, v145, v15
  v_mul_f32 v146, v146, v15
  v_mul_f32 v147, v147, v15
  v_mul_f32 v148, v148, v15
  v_mul_f32 v149, v149, v15
  s_waitcnt lgkmcnt(2)
  v_mfma_f32_32x32x16_bf16 v[16:31], v[200:203], v[184:187], v[16:31]
  ds_read_b128 v[176:179], v234 offset:53248
  ds_read_b128 v[180:183], v234 offset:57344
  v_mul_f32 v150, v150, v15
  v_mul_f32 v151, v151, v15
  v_mul_f32 v152, v152, v15
  v_mul_f32 v153, v153, v15
  v_mul_f32 v154, v154, v15
  v_mul_f32 v155, v155, v15
  v_mul_f32 v156, v156, v15
  v_mfma_f32_32x32x16_bf16 v[32:47], v[200:203], v[188:191], v[32:47]
  ds_read_b64_tr_b16 v[192:193], v241 offset:2048
  ds_read_b64_tr_b16 v[194:195], v241 offset:2304
  v_mul_f32 v157, v157, v15
  v_mul_f32 v158, v158, v15
  v_mul_f32 v159, v159, v15
  v_cvt_pk_bf16_f32 v224, v144, v145
  v_cvt_pk_bf16_f32 v225, v146, v147
  v_cvt_pk_bf16_f32 v226, v148, v149
  v_cvt_pk_bf16_f32 v227, v150, v151
  s_waitcnt lgkmcnt(4)
  v_mfma_f32_32x32x16_bf16 v[48:63], v[204:207], v[184:187], v[48:63]
  ds_read_b64_tr_b16 v[196:197], v241 offset:6144
  ds_read_b64_tr_b16 v[198:199], v241 offset:6400
  buffer_store_dwordx4 v[224:227], v246, s[20:23], s43 offen offset:0 sc1
  v_cvt_pk_bf16_f32 v228, v152, v153
  v_cvt_pk_bf16_f32 v229, v154, v155
  v_cvt_pk_bf16_f32 v230, v156, v157
  v_cvt_pk_bf16_f32 v231, v158, v159
  buffer_store_dwordx4 v[228:231], v246, s[20:23], s44 offen offset:0 sc1
  v_mul_f32 v15, s42, v13
  v_mfma_f32_32x32x16_bf16 v[64:79], v[204:207], v[188:191], v[64:79]
  v_mul_f32 v160, v160, v15
  v_mul_f32 v161, v161, v15
  v_mul_f32 v162, v162, v15
  v_mul_f32 v163, v163, v15
  v_mul_f32 v164, v164, v15
  v_mul_f32 v165, v165, v15
  v_mul_f32 v166, v166, v15
  s_waitcnt lgkmcnt(2)
  v_mfma_f32_32x32x16_bf16 v[16:31], v[192:195], v[176:179], v[16:31]
  ds_read_b128 v[184:187], v235 offset:53248
  ds_read_b128 v[188:191], v235 offset:57344
  v_mul_f32 v167, v167, v15
  v_mul_f32 v168, v168, v15
  v_mul_f32 v169, v169, v15
  v_mul_f32 v170, v170, v15
  v_mul_f32 v171, v171, v15
  v_mul_f32 v172, v172, v15
  v_mul_f32 v173, v173, v15
  v_mfma_f32_32x32x16_bf16 v[32:47], v[192:195], v[180:183], v[32:47]
  ds_read_b64_tr_b16 v[200:201], v241 offset:3072
  ds_read_b64_tr_b16 v[202:203], v241 offset:3328
  v_mul_f32 v174, v174, v15
  v_mul_f32 v175, v175, v15
  v_cvt_pk_bf16_f32 v224, v160, v161
  v_cvt_pk_bf16_f32 v225, v162, v163
  v_cvt_pk_bf16_f32 v226, v164, v165
  v_cvt_pk_bf16_f32 v227, v166, v167
  buffer_store_dwordx4 v[224:227], v246, s[20:23], s43 offen offset:1024 sc1
  s_waitcnt lgkmcnt(4)
  v_mfma_f32_32x32x16_bf16 v[48:63], v[196:199], v[176:179], v[48:63]
  ds_read_b64_tr_b16 v[204:205], v241 offset:7168
  ds_read_b64_tr_b16 v[206:207], v241 offset:7424
  v_cvt_pk_bf16_f32 v228, v168, v169
  v_cvt_pk_bf16_f32 v229, v170, v171
  v_cvt_pk_bf16_f32 v230, v172, v173
  v_cvt_pk_bf16_f32 v231, v174, v175
  buffer_store_dwordx4 v[228:231], v246, s[20:23], s44 offen offset:1024 sc1
  v_mfma_f32_32x32x16_bf16 v[64:79], v[196:199], v[180:183], v[64:79]
  s_waitcnt lgkmcnt(2)
  v_mfma_f32_32x32x16_bf16 v[16:31], v[200:203], v[184:187], v[16:31]
  ds_read_b128 v[192:195], v242 offset:0
  v_mfma_f32_32x32x16_bf16 v[32:47], v[200:203], v[188:191], v[32:47]
  ds_read_b128 v[196:199], v242 offset:512
  s_waitcnt lgkmcnt(2)
  v_mfma_f32_32x32x16_bf16 v[48:63], v[204:207], v[184:187], v[48:63]
  v_mfma_f32_32x32x16_bf16 v[64:79], v[204:207], v[188:191], v[64:79]
  s_waitcnt lgkmcnt(1)
  v_mfma_f32_32x32x16_bf16 v[16:31], v[192:195], v[2:5], v[16:31]
  v_mfma_f32_32x32x16_bf16 v[32:47], v[192:195], v[6:9], v[32:47]
  s_waitcnt lgkmcnt(0)
  v_mfma_f32_32x32x16_bf16 v[48:63], v[196:199], v[2:5], v[48:63]
  v_mfma_f32_32x32x16_bf16 v[64:79], v[196:199], v[6:9], v[64:79]
  s_waitcnt vmcnt(0)
  s_barrier
  v_mul_f32 v15, 0xbfb8aa3b, v12
  s_add_u32 s42, s33, 0
  s_mul_i32 s42, s42, 112
  s_lshl_b32 s43, s30, 1
  s_add_u32 s42, s42, s43
  s_add_u32 s42, s42, 48
  s_lshl_b32 s42, s42, 10
  s_add_u32 s42, s42, 6291456
  v_mul_f32 v208, v16, v15
  v_mul_f32 v209, v17, v15
  v_mul_f32 v210, v18, v15
  v_mul_f32 v211, v19, v15
  v_mul_f32 v212, v20, v15
  v_mul_f32 v213, v21, v15
  v_mul_f32 v214, v22, v15
  v_mul_f32 v215, v23, v15
  v_mul_f32 v216, v24, v15
  v_mul_f32 v217, v25, v15
  v_mul_f32 v218, v26, v15
  v_mul_f32 v219, v27, v15
  v_mul_f32 v220, v28, v15
  v_mul_f32 v221, v29, v15
  v_mul_f32 v222, v30, v15
  v_mul_f32 v223, v31, v15
  v_exp_f32 v208, v208
  v_exp_f32 v209, v209
  v_exp_f32 v210, v210
  v_exp_f32 v211, v211
  v_exp_f32 v212, v212
  v_exp_f32 v213, v213
  v_exp_f32 v214, v214
  v_exp_f32 v215, v215
  v_exp_f32 v216, v216
  v_exp_f32 v217, v217
  v_exp_f32 v218, v218
  v_exp_f32 v219, v219
  v_exp_f32 v220, v220
  v_exp_f32 v221, v221
  v_exp_f32 v222, v222
  v_exp_f32 v223, v223
  v_mul_f32 v16, v16, v48
  v_mul_f32 v17, v17, v49
  v_mul_f32 v18, v18, v50
  v_mul_f32 v19, v19, v51
  v_mul_f32 v20, v20, v52
  v_mul_f32 v21, v21, v53
  v_mul_f32 v22, v22, v54
  v_mul_f32 v23, v23, v55
  v_mul_f32 v24, v24, v56
  v_mul_f32 v25, v25, v57
  v_mul_f32 v26, v26, v58
  v_mul_f32 v27, v27, v59
  v_mul_f32 v28, v28, v60
  v_mul_f32 v29, v29, v61
  v_mul_f32 v30, v30, v62
  v_mul_f32 v31, v31, v63
  v_fma_f32 v208, v208, v10, v10
  v_fma_f32 v209, v209, v10, v10
  v_fma_f32 v210, v210, v10, v10
  v_fma_f32 v211, v211, v10, v10
  v_fma_f32 v212, v212, v10, v10
  v_fma_f32 v213, v213, v10, v10
  v_fma_f32 v214, v214, v10, v10
  v_fma_f32 v215, v215, v10, v10
  v_fma_f32 v216, v216, v10, v10
  v_fma_f32 v217, v217, v10, v10
  v_fma_f32 v218, v218, v10, v10
  v_fma_f32 v219, v219, v10, v10
  v_fma_f32 v220, v220, v10, v10
  v_fma_f32 v221, v221, v10, v10
  v_fma_f32 v222, v222, v10, v10
  v_fma_f32 v223, v223, v10, v10
  v_rcp_f32 v208, v208
  v_rcp_f32 v209, v209
  v_rcp_f32 v210, v210
  v_rcp_f32 v211, v211
  v_rcp_f32 v212, v212
  v_rcp_f32 v213, v213
  v_rcp_f32 v214, v214
  v_rcp_f32 v215, v215
  v_rcp_f32 v216, v216
  v_rcp_f32 v217, v217
  v_rcp_f32 v218, v218
  v_rcp_f32 v219, v219
  v_rcp_f32 v220, v220
  v_rcp_f32 v221, v221
  v_rcp_f32 v222, v222
  v_rcp_f32 v223, v223
  v_mul_f32 v16, v16, v208
  v_mul_f32 v17, v17, v209
  v_mul_f32 v18, v18, v210
  v_mul_f32 v19, v19, v211
  v_mul_f32 v20, v20, v212
  v_mul_f32 v21, v21, v213
  v_mul_f32 v22, v22, v214
  v_mul_f32 v23, v23, v215
  v_mul_f32 v24, v24, v216
  v_mul_f32 v25, v25, v217
  v_mul_f32 v26, v26, v218
  v_mul_f32 v27, v27, v219
  v_mul_f32 v28, v28, v220
  v_mul_f32 v29, v29, v221
  v_mul_f32 v30, v30, v222
  v_mul_f32 v31, v31, v223
  v_cvt_pk_bf16_f32 v224, v16, v17
  v_cvt_pk_bf16_f32 v225, v18, v19
  v_cvt_pk_bf16_f32 v226, v20, v21
  v_cvt_pk_bf16_f32 v227, v22, v23
  buffer_store_dwordx4 v[224:227], v14, s[20:23], s42 offen offset:0 sc1
  v_cvt_pk_bf16_f32 v228, v24, v25
  v_cvt_pk_bf16_f32 v229, v26, v27
  v_cvt_pk_bf16_f32 v230, v28, v29
  v_cvt_pk_bf16_f32 v231, v30, v31
  buffer_store_dwordx4 v[228:231], v14, s[20:23], s42 offen offset:1024 sc1
  v_mul_f32 v15, 0xbfb8aa3b, v13
  s_add_u32 s42, s33, 1
  s_mul_i32 s42, s42, 112
  s_lshl_b32 s43, s30, 1
  s_add_u32 s42, s42, s43
  s_add_u32 s42, s42, 48
  s_lshl_b32 s42, s42, 10
  s_add_u32 s42, s42, 6291456
  v_mul_f32 v208, v32, v15
  v_mul_f32 v209, v33, v15
  v_mul_f32 v210, v34, v15
  v_mul_f32 v211, v35, v15
  v_mul_f32 v212, v36, v15
  v_mul_f32 v213, v37, v15
  v_mul_f32 v214, v38, v15
  v_mul_f32 v215, v39, v15
  v_mul_f32 v216, v40, v15
  v_mul_f32 v217, v41, v15
  v_mul_f32 v218, v42, v15
  v_mul_f32 v219, v43, v15
  v_mul_f32 v220, v44, v15
  v_mul_f32 v221, v45, v15
  v_mul_f32 v222, v46, v15
  v_mul_f32 v223, v47, v15
  v_exp_f32 v208, v208
  v_exp_f32 v209, v209
  v_exp_f32 v210, v210
  v_exp_f32 v211, v211
  v_exp_f32 v212, v212
  v_exp_f32 v213, v213
  v_exp_f32 v214, v214
  v_exp_f32 v215, v215
  v_exp_f32 v216, v216
  v_exp_f32 v217, v217
  v_exp_f32 v218, v218
  v_exp_f32 v219, v219
  v_exp_f32 v220, v220
  v_exp_f32 v221, v221
  v_exp_f32 v222, v222
  v_exp_f32 v223, v223
  v_mul_f32 v32, v32, v64
  v_mul_f32 v33, v33, v65
  v_mul_f32 v34, v34, v66
  v_mul_f32 v35, v35, v67
  v_mul_f32 v36, v36, v68
  v_mul_f32 v37, v37, v69
  v_mul_f32 v38, v38, v70
  v_mul_f32 v39, v39, v71
  v_mul_f32 v40, v40, v72
  v_mul_f32 v41, v41, v73
  v_mul_f32 v42, v42, v74
  v_mul_f32 v43, v43, v75
  v_mul_f32 v44, v44, v76
  v_mul_f32 v45, v45, v77
  v_mul_f32 v46, v46, v78
  v_mul_f32 v47, v47, v79
  v_fma_f32 v208, v208, v11, v11
  v_fma_f32 v209, v209, v11, v11
  v_fma_f32 v210, v210, v11, v11
  v_fma_f32 v211, v211, v11, v11
  v_fma_f32 v212, v212, v11, v11
  v_fma_f32 v213, v213, v11, v11
  v_fma_f32 v214, v214, v11, v11
  v_fma_f32 v215, v215, v11, v11
  v_fma_f32 v216, v216, v11, v11
  v_fma_f32 v217, v217, v11, v11
  v_fma_f32 v218, v218, v11, v11
  v_fma_f32 v219, v219, v11, v11
  v_fma_f32 v220, v220, v11, v11
  v_fma_f32 v221, v221, v11, v11
  v_fma_f32 v222, v222, v11, v11
  v_fma_f32 v223, v223, v11, v11
  v_rcp_f32 v208, v208
  v_rcp_f32 v209, v209
  v_rcp_f32 v210, v210
  v_rcp_f32 v211, v211
  v_rcp_f32 v212, v212
  v_rcp_f32 v213, v213
  v_rcp_f32 v214, v214
  v_rcp_f32 v215, v215
  v_rcp_f32 v216, v216
  v_rcp_f32 v217, v217
  v_rcp_f32 v218, v218
  v_rcp_f32 v219, v219
  v_rcp_f32 v220, v220
  v_rcp_f32 v221, v221
  v_rcp_f32 v222, v222
  v_rcp_f32 v223, v223
  v_mul_f32 v32, v32, v208
  v_mul_f32 v33, v33, v209
  v_mul_f32 v34, v34, v210
  v_mul_f32 v35, v35, v211
  v_mul_f32 v36, v36, v212
  v_mul_f32 v37, v37, v213
  v_mul_f32 v38, v38, v214
  v_mul_f32 v39, v39, v215
  v_mul_f32 v40, v40, v216
  v_mul_f32 v41, v41, v217
  v_mul_f32 v42, v42, v218
  v_mul_f32 v43, v43, v219
  v_mul_f32 v44, v44, v220
  v_mul_f32 v45, v45, v221
  v_mul_f32 v46, v46, v222
  v_mul_f32 v47, v47, v223
  v_cvt_pk_bf16_f32 v224, v32, v33
  v_cvt_pk_bf16_f32 v225, v34, v35
  v_cvt_pk_bf16_f32 v226, v36, v37
  v_cvt_pk_bf16_f32 v227, v38, v39
  buffer_store_dwordx4 v[224:227], v14, s[20:23], s42 offen offset:0 sc1
  v_cvt_pk_bf16_f32 v228, v40, v41
  v_cvt_pk_bf16_f32 v229, v42, v43
  v_cvt_pk_bf16_f32 v230, v44, v45
  v_cvt_pk_bf16_f32 v231, v46, v47
  buffer_store_dwordx4 v[228:231], v14, s[20:23], s42 offen offset:1024 sc1
  s_waitcnt vmcnt(0) lgkmcnt(0)
  s_barrier
  s_branch L_p2
L_p2:
  s_load_dwordx2 s[58:59], s[0:1], 56
  v_and_b32 v1, 63, v0
  v_lshlrev_b32 v2, 4, v1
  s_and_b32 s29, s2, 31
  s_lshr_b32 s40, s2, 5
  s_lshl_b32 s40, s40, 3
  s_add_u32 s30, s40, s28
  s_lshl_b32 s31, s29, 16
  s_and_b32 s40, s2, 7
  s_lshr_b32 s41, s2, 3
  s_lshl_b32 s42, s40, 2
  s_lshr_b32 s43, s41, 3
  s_add_u32 s42, s42, s43
  s_and_b32 s43, s41, 7
  s_and_b32 s44, s28, 1
  s_lshr_b32 s45, s28, 1
  s_lshl_b32 s46, s43, 1
  s_add_u32 s46, s46, s44
  s_mul_i32 s46, s46, 112
  s_mul_i32 s47, s45, 28
  s_add_u32 s46, s46, s47
  s_lshl_b32 s46, s46, 10
  s_add_u32 s32, s46, 13631488
  s_mul_i32 s46, s42, 224
  s_add_u32 s46, s46, s47
  s_lshl_b32 s46, s46, 10
  s_add_u32 s33, s46, 6291456
  s_add_u32 s34, s33, 114688
  s_lshl_b32 s46, s42, 3
  s_add_u32 s46, s46, s43
  s_lshl_b32 s46, s46, 3
  s_lshl_b32 s47, s44, 2
  s_add_u32 s46, s46, s47
  s_add_u32 s46, s46, s45
  s_lshl_b32 s46, s46, 10
  s_add_u32 s35, s46, 18874368
  s_lshl_b32 s46, s43, 1
  s_add_u32 s46, s46, s44
  s_lshl_b32 s46, s46, 5
  s_and_b32 s47, s45, 1
  s_lshl_b32 s47, s47, 4
  s_add_u32 s46, s46, s47
  s_lshl_b32 s46, s46, 10
  s_add_u32 s37, s46, 15466496
  s_lshl_b32 s46, s42, 1
  s_lshr_b32 s47, s45, 1
  s_add_u32 s46, s46, s47
  s_lshl_b32 s46, s46, 15
  s_lshl_b32 s47, s43, 1
  s_add_u32 s47, s47, s44
  s_lshl_b32 s47, s47, 6
  s_add_u32 s46, s46, s47
  s_and_b32 s47, s45, 1
  s_lshl_b32 s47, s47, 5
  s_add_u32 s38, s46, s47
  s_lshl_b32 s46, s42, 16
  s_add_u32 s39, s46, 16777216
  s_lshl_b32 s46, s30, 5
  s_add_u32 s46, s46, s29
  s_lshl_b32 s46, s46, 10
  s_add_u32 s36, s46, 16777216
  s_waitcnt lgkmcnt(0)
  s_mov_b32 s8, s70
  s_mov_b32 s9, s71
  s_mov_b32 s10, 21495808
  s_mov_b32 s11, 0x20000
  s_mov_b32 s12, s56
  s_mov_b32 s13, s57
  s_mov_b32 s14, 2097152
  s_mov_b32 s15, 0x20000
  s_mov_b32 s16, s58
  s_mov_b32 s17, s59
  s_mov_b32 s18, 2097152
  s_mov_b32 s19, 0x20000
  s_mov_b32 s6, 256
  s_mov_b32 s7, 0x20000
  s_lshl_b32 s51, s28, 10
  s_add_u32 s52, s51, s31
  s_add_u32 s53, s52, 4194304
  s_add_u32 s52, s52, 2097152
  s_mul_i32 s54, s28, 1040
  s_add_u32 s54, s54, 65536
  v_and_b32 v5, 31, v1
  v_lshrrev_b32 v6, 5, v1
  v_lshlrev_b32 v7, 8, v6
  v_lshl_add_u32 v152, v5, 4, v7
  v_cmp_gt_u32 vcc, 16, v5
  s_nop 1
  v_cndmask_b32 v153, v7, v152, vcc
  v_subrev_u32 v154, 20, v5
  v_cmp_gt_u32 s[46:47], 8, v154
  s_nop 3
  s_or_b64 s[46:47], s[46:47], vcc
  v_mov_b32 v155, 1024
  v_add_u32 v156, 512, v153
  v_cndmask_b32 v3, v155, v153, s[46:47]
  v_cndmask_b32 v4, v155, v156, s[46:47]
  v_add_u32 v3, 65536, v3
  v_add_u32 v4, 65536, v4
  s_lshl_b32 s40, s28, 13
  s_add_u32 s40, s40, 65536
  v_add_u32 v150, s40, v2
  s_and_b32 s40, s28, 1
  s_lshl_b32 s40, s40, 13
  s_lshr_b32 s41, s28, 1
  s_lshl_b32 s41, s41, 11
  s_add_u32 s40, s40, s41
  s_add_u32 s40, s40, 65536
  v_add_u32 v148, s40, v2
  s_waitcnt lgkmcnt(0)
  s_cmp_eq_u32 s28, 5
  s_cbranch_scc0 L_p2_qkv
  s_lshr_b32 s43, s29, 1
  s_add_u32 s44, s43, 16
  s_lshr_b32 s45, s29, 2
  s_add_u32 s45, s45, 24
  s_lshr_b32 s47, s2, 5
  s_lshl_b32 s47, s47, 5
  s_add_u32 s47, s47, s43
  v_and_b32 v152, 7, v1
  v_lshlrev_b32 v152, 5, v152
  v_add_u32 v153, s44, v152
  v_add_u32 v154, s45, v152
  v_mov_b32 v155, s47
  v_cmp_gt_u32 vcc, 16, v1
  s_nop 1
  v_cndmask_b32 v155, v155, v154, vcc
  v_cmp_gt_u32 vcc, 8, v1
  s_nop 1
  v_cndmask_b32 v155, v155, v153, vcc
  v_lshlrev_b32 v155, 7, v155
  v_mov_b32 v156, 1
  s_mov_b32 s42, 21102592
  s_mov_b32 s46, 0
L_p2_qspin:
  buffer_load_dword v157, v155, s[8:11], s42 offen sc1
  s_waitcnt vmcnt(0)
  v_cmp_eq_u32 vcc, v157, v156
  s_nop 3
  s_cmp_eq_u64 vcc, exec
  s_cbranch_scc1 L_p2_qkv
  s_sleep 6
  s_add_u32 s46, s46, 1
  s_cmp_lt_u32 s46, 262144
  s_cbranch_scc1 L_p2_qspin
L_p2_qkv:
  s_barrier
  s_lshl_b32 s40, s30, 10
  s_add_u32 s40, s40, s31
  s_add_u32 s40, s40, 0
  buffer_load_dwordx4 v[8:11], v2, s[8:11], s40 offen sc1
  s_add_u32 m0, s51, 0
  s_add_u32 s55, s52, 0
  buffer_load_dwordx4 v2, s[8:11], s55 offen sc1 lds
  s_add_u32 m0, s54, 0
  s_add_u32 s55, s53, 0
  buffer_load_dwordx4 v2, s[8:11], s55 offen sc1 lds
  s_waitcnt vmcnt(0)
  s_barrier
  s_mov_b32 s48, 0xffff
  s_mov_b32 s49, 0xffff
  v_and_b32 v5, 31, v1
  v_cmp_eq_u32 vcc, 16, v5
  v_mov_b32 v6, 0x3f803f80
  s_nop 0
  v_cndmask_b32 v16, 0, v6, vcc
  v_cndmask_b32 v17, 0, v6, vcc
  v_cndmask_b32 v18, 0, v6, vcc
  v_cndmask_b32 v19, 0, v6, vcc
  v_cndmask_b32 v20, 0, v6, vcc
  v_cndmask_b32 v21, 0, v6, vcc
  v_cndmask_b32 v22, 0, v6, vcc
  v_cndmask_b32 v23, 0, v6, vcc
  ds_read_b128 v[12:15], v2 offset:0
  s_mov_b64 exec, s[48:49]
  ds_read_b128 v[16:19], v3 offset:0
  s_mov_b64 exec, -1
  v_mov_b32 v24, 0xdddd
  v_mov_b32 v64, 0
  v_mov_b32 v65, 0
  v_mov_b32 v66, 0
  v_mov_b32 v67, 0
  v_mov_b32 v68, 0
  v_mov_b32 v69, 0
  v_mov_b32 v70, 0
  v_mov_b32 v71, 0
  v_mov_b32 v72, 0
  v_mov_b32 v73, 0
  v_mov_b32 v74, 0
  v_mov_b32 v75, 0
  v_mov_b32 v76, 0
  v_mov_b32 v77, 0
  v_mov_b32 v78, 0
  v_mov_b32 v79, 0
  s_waitcnt lgkmcnt(1)
  v_mfma_f32_32x32x16_bf16 v[32:47], v[12:15], v[8:11], 0
  ds_read_b128 v[12:15], v2 offset:1024
  s_setprio 0
  s_nop 9
  v_exp_f32 v32, v32
  v_exp_f32 v33, v33
  s_mov_b64 exec, s[48:49]
  ds_read_b128 v[20:23], v4 offset:0
  s_mov_b64 exec, -1
  s_add_u32 m0, s51, 8192
  s_add_u32 s55, s52, 8192
  buffer_load_dwordx4 v2, s[8:11], s55 offen sc1 lds
  v_exp_f32 v34, v34
  v_exp_f32 v35, v35
  v_exp_f32 v36, v36
  v_exp_f32 v37, v37
  s_waitcnt lgkmcnt(1)
  v_mfma_f32_32x32x16_bf16 v[48:63], v[12:15], v[8:11], 0
  ds_read_b128 v[12:15], v2 offset:2048
  v_exp_f32 v38, v38
  v_exp_f32 v39, v39
  v_exp_f32 v40, v40
  v_exp_f32 v41, v41
  v_exp_f32 v42, v42
  v_exp_f32 v43, v43
  v_exp_f32 v44, v44
  v_exp_f32 v45, v45
  v_smfmac_f32_32x32x32_bf16 v[64:79], v[16:19], v[32:39], v24
  s_mov_b64 exec, s[48:49]
  ds_read_b128 v[16:19], v3 offset:1040
  s_mov_b64 exec, -1
  v_exp_f32 v46, v46
  v_exp_f32 v47, v47
  s_setprio 3
  v_exp_f32 v48, v48
  v_exp_f32 v49, v49
  s_waitcnt lgkmcnt(1)
  v_smfmac_f32_32x32x32_bf16 v[64:79], v[20:23], v[40:47], v24
  s_mov_b64 exec, s[48:49]
  ds_read_b128 v[20:23], v4 offset:1040
  s_mov_b64 exec, -1
  v_and_b32 v26, 7, v1
  v_lshlrev_b32 v26, 7, v26
  v_mov_b32 v27, 0
  v_mov_b32 v28, 32
  s_mov_b32 s42, 21135360
  s_cmp_eq_u32 s28, 0
  s_cbranch_scc0 L_p2_np
  buffer_load_dword v27, v26, s[8:11], s42 offen sc1
L_p2_np:
  v_exp_f32 v50, v50
  v_exp_f32 v51, v51
  v_exp_f32 v52, v52
  v_exp_f32 v53, v53
  v_mfma_f32_32x32x16_bf16 v[32:47], v[12:15], v[8:11], 0
  ds_read_b128 v[12:15], v2 offset:3072
  v_exp_f32 v54, v54
  v_exp_f32 v55, v55
  v_exp_f32 v56, v56
  v_exp_f32 v57, v57
  v_exp_f32 v58, v58
  v_exp_f32 v59, v59
  v_exp_f32 v60, v60
  v_exp_f32 v61, v61
  s_waitcnt lgkmcnt(2)
  v_smfmac_f32_32x32x32_bf16 v[64:79], v[16:19], v[48:55], v24
  s_mov_b64 exec, s[48:49]
  ds_read_b128 v[16:19], v3 offset:2080
  s_mov_b64 exec, -1
  v_exp_f32 v62, v62
  v_exp_f32 v63, v63
  s_setprio 2
  v_exp_f32 v32, v32
  v_exp_f32 v33, v33
  s_waitcnt lgkmcnt(1)
  v_smfmac_f32_32x32x32_bf16 v[64:79], v[20:23], v[56:63], v24
  s_mov_b64 exec, s[48:49]
  ds_read_b128 v[20:23], v4 offset:2080
  s_mov_b64 exec, -1
  s_add_u32 m0, s54, 8320
  s_add_u32 s55, s53, 8192
  buffer_load_dwordx4 v2, s[8:11], s55 offen sc1 lds
  v_exp_f32 v34, v34
  v_exp_f32 v35, v35
  v_exp_f32 v36, v36
  v_exp_f32 v37, v37
  v_mfma_f32_32x32x16_bf16 v[48:63], v[12:15], v[8:11], 0
  ds_read_b128 v[12:15], v2 offset:4096
  v_exp_f32 v38, v38
  v_exp_f32 v39, v39
  v_exp_f32 v40, v40
  v_exp_f32 v41, v41
  v_exp_f32 v42, v42
  v_exp_f32 v43, v43
  v_exp_f32 v44, v44
  v_exp_f32 v45, v45
  s_waitcnt lgkmcnt(2)
  v_smfmac_f32_32x32x32_bf16 v[64:79], v[16:19], v[32:39], v24
  s_mov_b64 exec, s[48:49]
  ds_read_b128 v[16:19], v3 offset:3120
  s_mov_b64 exec, -1
  v_exp_f32 v46, v46
  v_exp_f32 v47, v47
  s_setprio 1
  v_exp_f32 v48, v48
  v_exp_f32 v49, v49
  s_waitcnt lgkmcnt(1)
  v_smfmac_f32_32x32x32_bf16 v[64:79], v[20:23], v[40:47], v24
  s_mov_b64 exec, s[48:49]
  ds_read_b128 v[20:23], v4 offset:3120
  s_mov_b64 exec, -1
  v_exp_f32 v50, v50
  v_exp_f32 v51, v51
  v_exp_f32 v52, v52
  v_exp_f32 v53, v53
  v_mfma_f32_32x32x16_bf16 v[32:47], v[12:15], v[8:11], 0
  ds_read_b128 v[12:15], v2 offset:5120
  v_exp_f32 v54, v54
  v_exp_f32 v55, v55
  v_exp_f32 v56, v56
  v_exp_f32 v57, v57
  v_exp_f32 v58, v58
  v_exp_f32 v59, v59
  v_exp_f32 v60, v60
  v_exp_f32 v61, v61
  s_waitcnt lgkmcnt(2)
  v_smfmac_f32_32x32x32_bf16 v[64:79], v[16:19], v[48:55], v24
  s_mov_b64 exec, s[48:49]
  ds_read_b128 v[16:19], v3 offset:4160
  s_mov_b64 exec, -1
  v_exp_f32 v62, v62
  v_exp_f32 v63, v63
  s_setprio 0
  v_exp_f32 v32, v32
  v_exp_f32 v33, v33
  s_waitcnt lgkmcnt(1)
  v_smfmac_f32_32x32x32_bf16 v[64:79], v[20:23], v[56:63], v24
  s_mov_b64 exec, s[48:49]
  ds_read_b128 v[20:23], v4 offset:4160
  s_mov_b64 exec, -1
  s_add_u32 m0, s51, 16384
  s_add_u32 s55, s52, 16384
  buffer_load_dwordx4 v2, s[8:11], s55 offen sc1 lds
  v_exp_f32 v34, v34
  v_exp_f32 v35, v35
  v_exp_f32 v36, v36
  v_exp_f32 v37, v37
  v_mfma_f32_32x32x16_bf16 v[48:63], v[12:15], v[8:11], 0
  ds_read_b128 v[12:15], v2 offset:6144
  v_exp_f32 v38, v38
  v_exp_f32 v39, v39
  v_exp_f32 v40, v40
  v_exp_f32 v41, v41
  v_exp_f32 v42, v42
  v_exp_f32 v43, v43
  v_exp_f32 v44, v44
  v_exp_f32 v45, v45
  s_waitcnt lgkmcnt(2)
  v_smfmac_f32_32x32x32_bf16 v[64:79], v[16:19], v[32:39], v24
  s_mov_b64 exec, s[48:49]
  ds_read_b128 v[16:19], v3 offset:5200
  s_mov_b64 exec, -1
  v_exp_f32 v46, v46
  v_exp_f32 v47, v47
  s_setprio 3
  v_exp_f32 v48, v48
  v_exp_f32 v49, v49
  s_waitcnt lgkmcnt(1)
  v_smfmac_f32_32x32x32_bf16 v[64:79], v[20:23], v[40:47], v24
  s_mov_b64 exec, s[48:49]
  ds_read_b128 v[20:23], v4 offset:5200
  s_mov_b64 exec, -1
  v_exp_f32 v50, v50
  v_exp_f32 v51, v51
  v_exp_f32 v52, v52
  v_exp_f32 v53, v53
  v_mfma_f32_32x32x16_bf16 v[32:47], v[12:15], v[8:11], 0
  ds_read_b128 v[12:15], v2 offset:7168
  s_waitcnt vmcnt(1)
  s_cmp_eq_u32 s28, 0
  s_cbranch_scc0 L_p2_rdy
  v_cmp_ge_u32 vcc, v27, v28
  s_nop 3
  s_cmp_eq_u64 vcc, exec
  s_cbranch_scc1 L_p2_rdy
  s_mov_b32 s46, 0
  s_mov_b32 s42, 21135360
L_p2_spin:
  s_sleep 2
  buffer_load_dword v27, v26, s[8:11], s42 offen sc1
  s_waitcnt vmcnt(0)
  v_cmp_ge_u32 vcc, v27, v28
  s_nop 3
  s_cmp_eq_u64 vcc, exec
  s_cbranch_scc1 L_p2_rdy
  s_add_u32 s46, s46, 1
  s_cmp_lt_u32 s46, 262144
  s_cbranch_scc1 L_p2_spin
L_p2_rdy:
  s_barrier
  v_exp_f32 v54, v54
  v_exp_f32 v55, v55
  v_exp_f32 v56, v56
  v_exp_f32 v57, v57
  v_exp_f32 v58, v58
  v_exp_f32 v59, v59
  v_exp_f32 v60, v60
  v_exp_f32 v61, v61
  s_waitcnt lgkmcnt(2)
  v_smfmac_f32_32x32x32_bf16 v[64:79], v[16:19], v[48:55], v24
  s_mov_b64 exec, s[48:49]
  ds_read_b128 v[16:19], v3 offset:6240
  s_mov_b64 exec, -1
  v_exp_f32 v62, v62
  v_exp_f32 v63, v63
  s_setprio 2
  v_exp_f32 v32, v32
  v_exp_f32 v33, v33
  s_waitcnt lgkmcnt(1)
  v_smfmac_f32_32x32x32_bf16 v[64:79], v[20:23], v[56:63], v24
  s_mov_b64 exec, s[48:49]
  ds_read_b128 v[20:23], v4 offset:6240
  s_mov_b64 exec, -1
  s_add_u32 m0, s54, 16640
  s_add_u32 s55, s53, 16384
  buffer_load_dwordx4 v2, s[8:11], s55 offen sc1 lds
  buffer_load_dwordx4 v[112:115], v2, s[8:11], s32 offen offset:0 sc1
  buffer_load_dwordx4 v[116:119], v2, s[8:11], s33 offen offset:0 sc1
  buffer_load_dwordx4 v[120:123], v2, s[8:11], s34 offen offset:0 sc1
  v_exp_f32 v34, v34
  v_exp_f32 v35, v35
  v_exp_f32 v36, v36
  v_exp_f32 v37, v37
  v_mfma_f32_32x32x16_bf16 v[48:63], v[12:15], v[8:11], 0
  ds_read_b128 v[12:15], v2 offset:8192
  v_exp_f32 v38, v38
  v_exp_f32 v39, v39
  v_exp_f32 v40, v40
  v_exp_f32 v41, v41
  v_exp_f32 v42, v42
  v_exp_f32 v43, v43
  v_exp_f32 v44, v44
  v_exp_f32 v45, v45
  s_waitcnt lgkmcnt(2)
  v_smfmac_f32_32x32x32_bf16 v[64:79], v[16:19], v[32:39], v24
  s_mov_b64 exec, s[48:49]
  ds_read_b128 v[16:19], v3 offset:7280
  s_mov_b64 exec, -1
  v_exp_f32 v46, v46
  v_exp_f32 v47, v47
  s_setprio 1
  v_exp_f32 v48, v48
  v_exp_f32 v49, v49
  s_waitcnt lgkmcnt(1)
  v_smfmac_f32_32x32x32_bf16 v[64:79], v[20:23], v[40:47], v24
  s_mov_b64 exec, s[48:49]
  ds_read_b128 v[20:23], v4 offset:7280
  s_mov_b64 exec, -1
  buffer_load_dwordx4 v[124:127], v2, s[8:11], s32 offen offset:1024 sc1
  buffer_load_dwordx4 v[128:131], v2, s[8:11], s33 offen offset:1024 sc1
  buffer_load_dwordx4 v[132:135], v2, s[8:11], s34 offen offset:1024 sc1
  v_exp_f32 v50, v50
  v_exp_f32 v51, v51
  v_exp_f32 v52, v52
  v_exp_f32 v53, v53
  v_mfma_f32_32x32x16_bf16 v[32:47], v[12:15], v[8:11], 0
  ds_read_b128 v[12:15], v2 offset:9216
  v_exp_f32 v54, v54
  v_exp_f32 v55, v55
  v_exp_f32 v56, v56
  v_exp_f32 v57, v57
  v_exp_f32 v58, v58
  v_exp_f32 v59, v59
  v_exp_f32 v60, v60
  v_exp_f32 v61, v61
  s_waitcnt lgkmcnt(2)
  v_smfmac_f32_32x32x32_bf16 v[64:79], v[16:19], v[48:55], v24
  s_mov_b64 exec, s[48:49]
  ds_read_b128 v[16:19], v3 offset:8320
  s_mov_b64 exec, -1
  v_exp_f32 v62, v62
  v_exp_f32 v63, v63
  s_setprio 0
  v_exp_f32 v32, v32
  v_exp_f32 v33, v33
  s_waitcnt lgkmcnt(1)
  v_smfmac_f32_32x32x32_bf16 v[64:79], v[20:23], v[56:63], v24
  s_mov_b64 exec, s[48:49]
  ds_read_b128 v[20:23], v4 offset:8320
  s_mov_b64 exec, -1
  s_add_u32 m0, s51, 24576
  s_add_u32 s55, s52, 24576
  buffer_load_dwordx4 v2, s[8:11], s55 offen sc1 lds
  buffer_load_dwordx4 v[136:139], v2, s[8:11], s32 offen offset:2048 sc1
  buffer_load_dwordx4 v[140:143], v2, s[8:11], s33 offen offset:2048 sc1
  buffer_load_dwordx4 v[144:147], v2, s[8:11], s34 offen offset:2048 sc1
  v_exp_f32 v34, v34
  v_exp_f32 v35, v35
  v_exp_f32 v36, v36
  v_exp_f32 v37, v37
  v_mfma_f32_32x32x16_bf16 v[48:63], v[12:15], v[8:11], 0
  ds_read_b128 v[12:15], v2 offset:10240
  v_exp_f32 v38, v38
  v_exp_f32 v39, v39
  v_exp_f32 v40, v40
  v_exp_f32 v41, v41
  v_exp_f32 v42, v42
  v_exp_f32 v43, v43
  v_exp_f32 v44, v44
  v_exp_f32 v45, v45
  s_waitcnt lgkmcnt(2)
  v_smfmac_f32_32x32x32_bf16 v[64:79], v[16:19], v[32:39], v24
  s_mov_b64 exec, s[48:49]
  ds_read_b128 v[16:19], v3 offset:9360
  s_mov_b64 exec, -1
  v_exp_f32 v46, v46
  v_exp_f32 v47, v47
  s_setprio 3
  v_exp_f32 v48, v48
  v_exp_f32 v49, v49
  s_waitcnt lgkmcnt(1)
  v_smfmac_f32_32x32x32_bf16 v[64:79], v[20:23], v[40:47], v24
  s_mov_b64 exec, s[48:49]
  ds_read_b128 v[20:23], v4 offset:9360
  s_mov_b64 exec, -1
  v_exp_f32 v50, v50
  v_exp_f32 v51, v51
  v_exp_f32 v52, v52
  v_exp_f32 v53, v53
  v_mfma_f32_32x32x16_bf16 v[32:47], v[12:15], v[8:11], 0
  ds_read_b128 v[12:15], v2 offset:11264
  v_exp_f32 v54, v54
  v_exp_f32 v55, v55
  v_exp_f32 v56, v56
  v_exp_f32 v57, v57
  s_waitcnt vmcnt(7)
  v_mfma_f32_32x32x16_bf16 v[80:95], v[112:115], v[116:119], 0
  v_exp_f32 v58, v58
  v_exp_f32 v59, v59
  v_exp_f32 v60, v60
  v_exp_f32 v61, v61
  s_waitcnt lgkmcnt(2)
  v_smfmac_f32_32x32x32_bf16 v[64:79], v[16:19], v[48:55], v24
  s_mov_b64 exec, s[48:49]
  ds_read_b128 v[16:19], v3 offset:10400
  s_mov_b64 exec, -1
  v_exp_f32 v62, v62
  v_exp_f32 v63, v63
  s_setprio 2
  v_exp_f32 v32, v32
  v_exp_f32 v33, v33
  s_waitcnt lgkmcnt(1)
  v_smfmac_f32_32x32x32_bf16 v[64:79], v[20:23], v[56:63], v24
  s_mov_b64 exec, s[48:49]
  ds_read_b128 v[20:23], v4 offset:10400
  s_mov_b64 exec, -1
  s_add_u32 m0, s54, 24960
  s_add_u32 s55, s53, 24576
  buffer_load_dwordx4 v2, s[8:11], s55 offen sc1 lds
  v_exp_f32 v34, v34
  v_exp_f32 v35, v35
  v_exp_f32 v36, v36
  v_exp_f32 v37, v37
  v_mfma_f32_32x32x16_bf16 v[48:63], v[12:15], v[8:11], 0
  ds_read_b128 v[12:15], v2 offset:12288
  v_exp_f32 v38, v38
  v_exp_f32 v39, v39
  v_exp_f32 v40, v40
  v_exp_f32 v41, v41
  v_mfma_f32_32x32x16_bf16 v[96:111], v[112:115], v[120:123], 0
  buffer_load_dwordx4 v[112:115], v2, s[8:11], s32 offen offset:3072 sc1
  buffer_load_dwordx4 v[116:119], v2, s[8:11], s33 offen offset:3072 sc1
  buffer_load_dwordx4 v[120:123], v2, s[8:11], s34 offen offset:3072 sc1
  s_add_u32 s32, s32, 4096
  s_add_u32 s33, s33, 4096
  s_add_u32 s34, s34, 4096
  v_exp_f32 v42, v42
  v_exp_f32 v43, v43
  v_exp_f32 v44, v44
  v_exp_f32 v45, v45
  s_waitcnt lgkmcnt(2)
  v_smfmac_f32_32x32x32_bf16 v[64:79], v[16:19], v[32:39], v24
  s_mov_b64 exec, s[48:49]
  ds_read_b128 v[16:19], v3 offset:11440
  s_mov_b64 exec, -1
  v_exp_f32 v46, v46
  v_exp_f32 v47, v47
  s_setprio 1
  v_exp_f32 v48, v48
  v_exp_f32 v49, v49
  s_waitcnt lgkmcnt(1)
  v_smfmac_f32_32x32x32_bf16 v[64:79], v[20:23], v[40:47], v24
  s_mov_b64 exec, s[48:49]
  ds_read_b128 v[20:23], v4 offset:11440
  s_mov_b64 exec, -1
  v_exp_f32 v50, v50
  v_exp_f32 v51, v51
  v_exp_f32 v52, v52
  v_exp_f32 v53, v53
  v_mfma_f32_32x32x16_bf16 v[32:47], v[12:15], v[8:11], 0
  ds_read_b128 v[12:15], v2 offset:13312
  v_exp_f32 v54, v54
  v_exp_f32 v55, v55
  v_exp_f32 v56, v56
  v_exp_f32 v57, v57
  s_waitcnt vmcnt(8)
  v_mfma_f32_32x32x16_bf16 v[80:95], v[124:127], v[128:131], v[80:95]
  v_exp_f32 v58, v58
  v_exp_f32 v59, v59
  v_mfma_f32_32x32x16_bf16 v[96:111], v[124:127], v[132:135], v[96:111]
  buffer_load_dwordx4 v[124:127], v2, s[8:11], s32 offen offset:0 sc1
  buffer_load_dwordx4 v[128:131], v2, s[8:11], s33 offen offset:0 sc1
  buffer_load_dwordx4 v[132:135], v2, s[8:11], s34 offen offset:0 sc1
  v_exp_f32 v60, v60
  v_exp_f32 v61, v61
  s_waitcnt lgkmcnt(2)
  v_smfmac_f32_32x32x32_bf16 v[64:79], v[16:19], v[48:55], v24
  s_mov_b64 exec, s[48:49]
  ds_read_b128 v[16:19], v3 offset:12480
  s_mov_b64 exec, -1
  v_exp_f32 v62, v62
  v_exp_f32 v63, v63
  s_setprio 0
  v_exp_f32 v32, v32
  v_exp_f32 v33, v33
  s_waitcnt lgkmcnt(1)
  v_smfmac_f32_32x32x32_bf16 v[64:79], v[20:23], v[56:63], v24
  s_mov_b64 exec, s[48:49]
  ds_read_b128 v[20:23], v4 offset:12480
  s_mov_b64 exec, -1
  s_add_u32 m0, s51, 32768
  s_add_u32 s55, s52, 32768
  buffer_load_dwordx4 v2, s[8:11], s55 offen sc1 lds
  v_exp_f32 v34, v34
  v_exp_f32 v35, v35
  v_exp_f32 v36, v36
  v_exp_f32 v37, v37
  v_mfma_f32_32x32x16_bf16 v[48:63], v[12:15], v[8:11], 0
  ds_read_b128 v[12:15], v2 offset:14336
  v_exp_f32 v38, v38
  v_exp_f32 v39, v39
  v_exp_f32 v40, v40
  v_exp_f32 v41, v41
  s_waitcnt vmcnt(8)
  v_mfma_f32_32x32x16_bf16 v[80:95], v[136:139], v[140:143], v[80:95]
  v_exp_f32 v42, v42
  v_exp_f32 v43, v43
  v_exp_f32 v44, v44
  v_exp_f32 v45, v45
  s_waitcnt lgkmcnt(2)
  v_smfmac_f32_32x32x32_bf16 v[64:79], v[16:19], v[32:39], v24
  s_mov_b64 exec, s[48:49]
  ds_read_b128 v[16:19], v3 offset:13520
  s_mov_b64 exec, -1
  v_exp_f32 v46, v46
  v_exp_f32 v47, v47
  s_setprio 3
  v_exp_f32 v48, v48
  v_exp_f32 v49, v49
  s_waitcnt lgkmcnt(1)
  v_smfmac_f32_32x32x32_bf16 v[64:79], v[20:23], v[40:47], v24
  s_mov_b64 exec, s[48:49]
  ds_read_b128 v[20:23], v4 offset:13520
  s_mov_b64 exec, -1
  v_exp_f32 v50, v50
  v_exp_f32 v51, v51
  v_exp_f32 v52, v52
  v_exp_f32 v53, v53
  v_mfma_f32_32x32x16_bf16 v[32:47], v[12:15], v[8:11], 0
  ds_read_b128 v[12:15], v2 offset:15360
  s_barrier
  v_exp_f32 v54, v54
  v_exp_f32 v55, v55
  v_exp_f32 v56, v56
  v_exp_f32 v57, v57
  v_mfma_f32_32x32x16_bf16 v[96:111], v[136:139], v[144:147], v[96:111]
  buffer_load_dwordx4 v[136:139], v2, s[8:11], s32 offen offset:1024 sc1
  buffer_load_dwordx4 v[140:143], v2, s[8:11], s33 offen offset:1024 sc1
  buffer_load_dwordx4 v[144:147], v2, s[8:11], s34 offen offset:1024 sc1
  v_exp_f32 v58, v58
  v_exp_f32 v59, v59
  v_exp_f32 v60, v60
  v_exp_f32 v61, v61
  s_waitcnt lgkmcnt(2)
  v_smfmac_f32_32x32x32_bf16 v[64:79], v[16:19], v[48:55], v24
  s_mov_b64 exec, s[48:49]
  ds_read_b128 v[16:19], v3 offset:14560
  s_mov_b64 exec, -1
  v_exp_f32 v62, v62
  v_exp_f32 v63, v63
  s_setprio 2
  v_exp_f32 v32, v32
  v_exp_f32 v33, v33
  s_waitcnt lgkmcnt(1)
  v_smfmac_f32_32x32x32_bf16 v[64:79], v[20:23], v[56:63], v24
  s_mov_b64 exec, s[48:49]
  ds_read_b128 v[20:23], v4 offset:14560
  s_mov_b64 exec, -1
  s_add_u32 m0, s54, 33280
  s_add_u32 s55, s53, 32768
  buffer_load_dwordx4 v2, s[8:11], s55 offen sc1 lds
  v_exp_f32 v34, v34
  v_exp_f32 v35, v35
  v_exp_f32 v36, v36
  v_exp_f32 v37, v37
  v_mfma_f32_32x32x16_bf16 v[48:63], v[12:15], v[8:11], 0
  ds_read_b128 v[12:15], v2 offset:16384
  v_exp_f32 v38, v38
  v_exp_f32 v39, v39
  v_exp_f32 v40, v40
  v_exp_f32 v41, v41
  s_waitcnt vmcnt(8)
  v_mfma_f32_32x32x16_bf16 v[80:95], v[112:115], v[116:119], v[80:95]
  v_exp_f32 v42, v42
  v_exp_f32 v43, v43
  v_exp_f32 v44, v44
  v_exp_f32 v45, v45
  s_waitcnt lgkmcnt(2)
  v_smfmac_f32_32x32x32_bf16 v[64:79], v[16:19], v[32:39], v24
  s_mov_b64 exec, s[48:49]
  ds_read_b128 v[16:19], v3 offset:15600
  s_mov_b64 exec, -1
  v_exp_f32 v46, v46
  v_exp_f32 v47, v47
  s_setprio 1
  v_exp_f32 v48, v48
  v_exp_f32 v49, v49
  s_waitcnt lgkmcnt(1)
  v_smfmac_f32_32x32x32_bf16 v[64:79], v[20:23], v[40:47], v24
  s_mov_b64 exec, s[48:49]
  ds_read_b128 v[20:23], v4 offset:15600
  s_mov_b64 exec, -1
  v_exp_f32 v50, v50
  v_exp_f32 v51, v51
  v_exp_f32 v52, v52
  v_exp_f32 v53, v53
  v_mfma_f32_32x32x16_bf16 v[32:47], v[12:15], v[8:11], 0
  ds_read_b128 v[12:15], v2 offset:17408
  v_exp_f32 v54, v54
  v_exp_f32 v55, v55
  v_exp_f32 v56, v56
  v_exp_f32 v57, v57
  v_mfma_f32_32x32x16_bf16 v[96:111], v[112:115], v[120:123], v[96:111]
  buffer_load_dwordx4 v[112:115], v2, s[8:11], s32 offen offset:2048 sc1
  buffer_load_dwordx4 v[116:119], v2, s[8:11], s33 offen offset:2048 sc1
  buffer_load_dwordx4 v[120:123], v2, s[8:11], s34 offen offset:2048 sc1
  v_exp_f32 v58, v58
  v_exp_f32 v59, v59
  v_exp_f32 v60, v60
  v_exp_f32 v61, v61
  s_waitcnt lgkmcnt(2)
  v_smfmac_f32_32x32x32_bf16 v[64:79], v[16:19], v[48:55], v24
  s_mov_b64 exec, s[48:49]
  ds_read_b128 v[16:19], v3 offset:16640
  s_mov_b64 exec, -1
  v_exp_f32 v62, v62
  v_exp_f32 v63, v63
  s_setprio 0
  v_exp_f32 v32, v32
  v_exp_f32 v33, v33
  s_waitcnt lgkmcnt(1)
  v_smfmac_f32_32x32x32_bf16 v[64:79], v[20:23], v[56:63], v24
  s_mov_b64 exec, s[48:49]
  ds_read_b128 v[20:23], v4 offset:16640
  s_mov_b64 exec, -1
  s_add_u32 m0, s51, 40960
  s_add_u32 s55, s52, 40960
  buffer_load_dwordx4 v2, s[8:11], s55 offen sc1 lds
  v_exp_f32 v34, v34
  v_exp_f32 v35, v35
  v_exp_f32 v36, v36
  v_exp_f32 v37, v37
  v_mfma_f32_32x32x16_bf16 v[48:63], v[12:15], v[8:11], 0
  ds_read_b128 v[12:15], v2 offset:18432
  v_exp_f32 v38, v38
  v_exp_f32 v39, v39
  v_exp_f32 v40, v40
  v_exp_f32 v41, v41
  s_waitcnt vmcnt(9)
  v_mfma_f32_32x32x16_bf16 v[80:95], v[124:127], v[128:131], v[80:95]
  v_exp_f32 v42, v42
  v_exp_f32 v43, v43
  v_exp_f32 v44, v44
  v_exp_f32 v45, v45
  s_waitcnt lgkmcnt(2)
  v_smfmac_f32_32x32x32_bf16 v[64:79], v[16:19], v[32:39], v24
  s_mov_b64 exec, s[48:49]
  ds_read_b128 v[16:19], v3 offset:17680
  s_mov_b64 exec, -1
  v_exp_f32 v46, v46
  v_exp_f32 v47, v47
  s_setprio 3
  v_exp_f32 v48, v48
  v_exp_f32 v49, v49
  s_waitcnt lgkmcnt(1)
  v_smfmac_f32_32x32x32_bf16 v[64:79], v[20:23], v[40:47], v24
  s_mov_b64 exec, s[48:49]
  ds_read_b128 v[20:23], v4 offset:17680
  s_mov_b64 exec, -1
  v_exp_f32 v50, v50
  v_exp_f32 v51, v51
  v_exp_f32 v52, v52
  v_exp_f32 v53, v53
  v_mfma_f32_32x32x16_bf16 v[32:47], v[12:15], v[8:11], 0
  ds_read_b128 v[12:15], v2 offset:19456
  v_exp_f32 v54, v54
  v_exp_f32 v55, v55
  v_exp_f32 v56, v56
  v_exp_f32 v57, v57
  v_mfma_f32_32x32x16_bf16 v[96:111], v[124:127], v[132:135], v[96:111]
  buffer_load_dwordx4 v[124:127], v2, s[8:11], s32 offen offset:3072 sc1
  buffer_load_dwordx4 v[128:131], v2, s[8:11], s33 offen offset:3072 sc1
  buffer_load_dwordx4 v[132:135], v2, s[8:11], s34 offen offset:3072 sc1
  s_add_u32 s32, s32, 4096
  s_add_u32 s33, s33, 4096
  s_add_u32 s34, s34, 4096
  v_exp_f32 v58, v58
  v_exp_f32 v59, v59
  v_exp_f32 v60, v60
  v_exp_f32 v61, v61
  s_waitcnt lgkmcnt(2)
  v_smfmac_f32_32x32x32_bf16 v[64:79], v[16:19], v[48:55], v24
  s_mov_b64 exec, s[48:49]
  ds_read_b128 v[16:19], v3 offset:18720
  s_mov_b64 exec, -1
  v_exp_f32 v62, v62
  v_exp_f32 v63, v63
  s_setprio 2
  v_exp_f32 v32, v32
  v_exp_f32 v33, v33
  s_waitcnt lgkmcnt(1)
  v_smfmac_f32_32x32x32_bf16 v[64:79], v[20:23], v[56:63], v24
  s_mov_b64 exec, s[48:49]
  ds_read_b128 v[20:23], v4 offset:18720
  s_mov_b64 exec, -1
  s_add_u32 m0, s54, 41600
  s_add_u32 s55, s53, 40960
  buffer_load_dwordx4 v2, s[8:11], s55 offen sc1 lds
  v_exp_f32 v34, v34
  v_exp_f32 v35, v35
  v_exp_f32 v36, v36
  v_exp_f32 v37, v37
  v_mfma_f32_32x32x16_bf16 v[48:63], v[12:15], v[8:11], 0
  ds_read_b128 v[12:15], v2 offset:20480
  v_exp_f32 v38, v38
  v_exp_f32 v39, v39
  v_exp_f32 v40, v40
  v_exp_f32 v41, v41
  s_waitcnt vmcnt(9)
  v_mfma_f32_32x32x16_bf16 v[80:95], v[136:139], v[140:143], v[80:95]
  v_exp_f32 v42, v42
  v_exp_f32 v43, v43
  v_exp_f32 v44, v44
  v_exp_f32 v45, v45
  s_waitcnt lgkmcnt(2)
  v_smfmac_f32_32x32x32_bf16 v[64:79], v[16:19], v[32:39], v24
  s_mov_b64 exec, s[48:49]
  ds_read_b128 v[16:19], v3 offset:19760
  s_mov_b64 exec, -1
  v_exp_f32 v46, v46
  v_exp_f32 v47, v47
  s_setprio 1
  v_exp_f32 v48, v48
  v_exp_f32 v49, v49
  s_waitcnt lgkmcnt(1)
  v_smfmac_f32_32x32x32_bf16 v[64:79], v[20:23], v[40:47], v24
  s_mov_b64 exec, s[48:49]
  ds_read_b128 v[20:23], v4 offset:19760
  s_mov_b64 exec, -1
  v_exp_f32 v50, v50
  v_exp_f32 v51, v51
  v_exp_f32 v52, v52
  v_exp_f32 v53, v53
  v_mfma_f32_32x32x16_bf16 v[32:47], v[12:15], v[8:11], 0
  ds_read_b128 v[12:15], v2 offset:21504
  v_exp_f32 v54, v54
  v_exp_f32 v55, v55
  v_exp_f32 v56, v56
  v_exp_f32 v57, v57
  v_mfma_f32_32x32x16_bf16 v[96:111], v[136:139], v[144:147], v[96:111]
  buffer_load_dwordx4 v[136:139], v2, s[8:11], s32 offen offset:0 sc1
  buffer_load_dwordx4 v[140:143], v2, s[8:11], s33 offen offset:0 sc1
  buffer_load_dwordx4 v[144:147], v2, s[8:11], s34 offen offset:0 sc1
  v_exp_f32 v58, v58
  v_exp_f32 v59, v59
  v_exp_f32 v60, v60
  v_exp_f32 v61, v61
  s_waitcnt lgkmcnt(2)
  v_smfmac_f32_32x32x32_bf16 v[64:79], v[16:19], v[48:55], v24
  s_mov_b64 exec, s[48:49]
  ds_read_b128 v[16:19], v3 offset:20800
  s_mov_b64 exec, -1
  v_exp_f32 v62, v62
  v_exp_f32 v63, v63
  s_setprio 0
  v_exp_f32 v32, v32
  v_exp_f32 v33, v33
  s_waitcnt lgkmcnt(1)
  v_smfmac_f32_32x32x32_bf16 v[64:79], v[20:23], v[56:63], v24
  s_mov_b64 exec, s[48:49]
  ds_read_b128 v[20:23], v4 offset:20800
  s_mov_b64 exec, -1
  s_add_u32 m0, s51, 49152
  s_add_u32 s55, s52, 49152
  buffer_load_dwordx4 v2, s[8:11], s55 offen sc1 lds
  v_exp_f32 v34, v34
  v_exp_f32 v35, v35
  v_exp_f32 v36, v36
  v_exp_f32 v37, v37
  v_mfma_f32_32x32x16_bf16 v[48:63], v[12:15], v[8:11], 0
  ds_read_b128 v[12:15], v2 offset:22528
  v_exp_f32 v38, v38
  v_exp_f32 v39, v39
  v_exp_f32 v40, v40
  v_exp_f32 v41, v41
  s_waitcnt vmcnt(9)
  v_mfma_f32_32x32x16_bf16 v[80:95], v[112:115], v[116:119], v[80:95]
  v_exp_f32 v42, v42
  v_exp_f32 v43, v43
  v_exp_f32 v44, v44
  v_exp_f32 v45, v45
  s_waitcnt lgkmcnt(2)
  v_smfmac_f32_32x32x32_bf16 v[64:79], v[16:19], v[32:39], v24
  s_mov_b64 exec, s[48:49]
  ds_read_b128 v[16:19], v3 offset:21840
  s_mov_b64 exec, -1
  v_exp_f32 v46, v46
  v_exp_f32 v47, v47
  s_setprio 3
  v_exp_f32 v48, v48
  v_exp_f32 v49, v49
  s_waitcnt lgkmcnt(1)
  v_smfmac_f32_32x32x32_bf16 v[64:79], v[20:23], v[40:47], v24
  s_mov_b64 exec, s[48:49]
  ds_read_b128 v[20:23], v4 offset:21840
  s_mov_b64 exec, -1
  v_exp_f32 v50, v50
  v_exp_f32 v51, v51
  v_exp_f32 v52, v52
  v_exp_f32 v53, v53
  v_mfma_f32_32x32x16_bf16 v[32:47], v[12:15], v[8:11], 0
  ds_read_b128 v[12:15], v2 offset:23552
  v_exp_f32 v54, v54
  v_exp_f32 v55, v55
  v_exp_f32 v56, v56
  v_exp_f32 v57, v57
  v_mfma_f32_32x32x16_bf16 v[96:111], v[112:115], v[120:123], v[96:111]
  buffer_load_dwordx4 v[112:115], v2, s[8:11], s32 offen offset:1024 sc1
  buffer_load_dwordx4 v[116:119], v2, s[8:11], s33 offen offset:1024 sc1
  buffer_load_dwordx4 v[120:123], v2, s[8:11], s34 offen offset:1024 sc1
  v_exp_f32 v58, v58
  v_exp_f32 v59, v59
  v_exp_f32 v60, v60
  v_exp_f32 v61, v61
  s_waitcnt lgkmcnt(2)
  v_smfmac_f32_32x32x32_bf16 v[64:79], v[16:19], v[48:55], v24
  s_mov_b64 exec, s[48:49]
  ds_read_b128 v[16:19], v3 offset:22880
  s_mov_b64 exec, -1
  v_exp_f32 v62, v62
  v_exp_f32 v63, v63
  s_setprio 2
  v_exp_f32 v32, v32
  v_exp_f32 v33, v33
  s_waitcnt lgkmcnt(1)
  v_smfmac_f32_32x32x32_bf16 v[64:79], v[20:23], v[56:63], v24
  s_mov_b64 exec, s[48:49]
  ds_read_b128 v[20:23], v4 offset:22880
  s_mov_b64 exec, -1
  s_add_u32 m0, s54, 49920
  s_add_u32 s55, s53, 49152
  buffer_load_dwordx4 v2, s[8:11], s55 offen sc1 lds
  v_exp_f32 v34, v34
  v_exp_f32 v35, v35
  v_exp_f32 v36, v36
  v_exp_f32 v37, v37
  v_mfma_f32_32x32x16_bf16 v[48:63], v[12:15], v[8:11], 0
  s_barrier
  ds_read_b128 v[12:15], v2 offset:24576
  v_exp_f32 v38, v38
  v_exp_f32 v39, v39
  v_exp_f32 v40, v40
  v_exp_f32 v41, v41
  s_waitcnt vmcnt(9)
  v_mfma_f32_32x32x16_bf16 v[80:95], v[124:127], v[128:131], v[80:95]
  v_exp_f32 v42, v42
  v_exp_f32 v43, v43
  v_exp_f32 v44, v44
  v_exp_f32 v45, v45
  s_waitcnt lgkmcnt(2)
  v_smfmac_f32_32x32x32_bf16 v[64:79], v[16:19], v[32:39], v24
  s_mov_b64 exec, s[48:49]
  ds_read_b128 v[16:19], v3 offset:23920
  s_mov_b64 exec, -1
  v_exp_f32 v46, v46
  v_exp_f32 v47, v47
  s_setprio 1
  v_exp_f32 v48, v48
  v_exp_f32 v49, v49
  s_waitcnt lgkmcnt(1)
  v_smfmac_f32_32x32x32_bf16 v[64:79], v[20:23], v[40:47], v24
  s_mov_b64 exec, s[48:49]
  ds_read_b128 v[20:23], v4 offset:23920
  s_mov_b64 exec, -1
  v_exp_f32 v50, v50
  v_exp_f32 v51, v51
  v_exp_f32 v52, v52
  v_exp_f32 v53, v53
  v_mfma_f32_32x32x16_bf16 v[32:47], v[12:15], v[8:11], 0
  ds_read_b128 v[12:15], v2 offset:25600
  v_exp_f32 v54, v54
  v_exp_f32 v55, v55
  v_exp_f32 v56, v56
  v_exp_f32 v57, v57
  v_mfma_f32_32x32x16_bf16 v[96:111], v[124:127], v[132:135], v[96:111]
  buffer_load_dwordx4 v[124:127], v2, s[8:11], s32 offen offset:2048 sc1
  buffer_load_dwordx4 v[128:131], v2, s[8:11], s33 offen offset:2048 sc1
  buffer_load_dwordx4 v[132:135], v2, s[8:11], s34 offen offset:2048 sc1
  v_exp_f32 v58, v58
  v_exp_f32 v59, v59
  v_exp_f32 v60, v60
  v_exp_f32 v61, v61
  s_waitcnt lgkmcnt(2)
  v_smfmac_f32_32x32x32_bf16 v[64:79], v[16:19], v[48:55], v24
  s_mov_b64 exec, s[48:49]
  ds_read_b128 v[16:19], v3 offset:24960
  s_mov_b64 exec, -1
  v_exp_f32 v62, v62
  v_exp_f32 v63, v63
  s_setprio 0
  v_exp_f32 v32, v32
  v_exp_f32 v33, v33
  s_waitcnt lgkmcnt(1)
  v_smfmac_f32_32x32x32_bf16 v[64:79], v[20:23], v[56:63], v24
  s_mov_b64 exec, s[48:49]
  ds_read_b128 v[20:23], v4 offset:24960
  s_mov_b64 exec, -1
  s_add_u32 m0, s51, 57344
  s_add_u32 s55, s52, 57344
  buffer_load_dwordx4 v2, s[8:11], s55 offen sc1 lds
  v_exp_f32 v34, v34
  v_exp_f32 v35, v35
  v_exp_f32 v36, v36
  v_exp_f32 v37, v37
  v_mfma_f32_32x32x16_bf16 v[48:63], v[12:15], v[8:11], 0
  ds_read_b128 v[12:15], v2 offset:26624
  v_exp_f32 v38, v38
  v_exp_f32 v39, v39
  v_exp_f32 v40, v40
  v_exp_f32 v41, v41
  s_waitcnt vmcnt(9)
  v_mfma_f32_32x32x16_bf16 v[80:95], v[136:139], v[140:143], v[80:95]
  v_exp_f32 v42, v42
  v_exp_f32 v43, v43
  v_exp_f32 v44, v44
  v_exp_f32 v45, v45
  s_waitcnt lgkmcnt(2)
  v_smfmac_f32_32x32x32_bf16 v[64:79], v[16:19], v[32:39], v24
  s_mov_b64 exec, s[48:49]
  ds_read_b128 v[16:19], v3 offset:26000
  s_mov_b64 exec, -1
  v_exp_f32 v46, v46
  v_exp_f32 v47, v47
  s_setprio 3
  v_exp_f32 v48, v48
  v_exp_f32 v49, v49
  s_waitcnt lgkmcnt(1)
  v_smfmac_f32_32x32x32_bf16 v[64:79], v[20:23], v[40:47], v24
  s_mov_b64 exec, s[48:49]
  ds_read_b128 v[20:23], v4 offset:26000
  s_mov_b64 exec, -1
  v_exp_f32 v50, v50
  v_exp_f32 v51, v51
  v_exp_f32 v52, v52
  v_exp_f32 v53, v53
  v_mfma_f32_32x32x16_bf16 v[32:47], v[12:15], v[8:11], 0
  ds_read_b128 v[12:15], v2 offset:27648
  v_exp_f32 v54, v54
  v_exp_f32 v55, v55
  v_exp_f32 v56, v56
  v_exp_f32 v57, v57
  v_mfma_f32_32x32x16_bf16 v[96:111], v[136:139], v[144:147], v[96:111]
  buffer_load_dwordx4 v[136:139], v2, s[8:11], s32 offen offset:3072 sc1
  buffer_load_dwordx4 v[140:143], v2, s[8:11], s33 offen offset:3072 sc1
  buffer_load_dwordx4 v[144:147], v2, s[8:11], s34 offen offset:3072 sc1
  s_add_u32 s32, s32, 4096
  s_add_u32 s33, s33, 4096
  s_add_u32 s34, s34, 4096
  v_exp_f32 v58, v58
  v_exp_f32 v59, v59
  v_exp_f32 v60, v60
  v_exp_f32 v61, v61
  s_waitcnt lgkmcnt(2)
  v_smfmac_f32_32x32x32_bf16 v[64:79], v[16:19], v[48:55], v24
  s_mov_b64 exec, s[48:49]
  ds_read_b128 v[16:19], v3 offset:27040
  s_mov_b64 exec, -1
  v_exp_f32 v62, v62
  v_exp_f32 v63, v63
  s_setprio 2
  v_exp_f32 v32, v32
  v_exp_f32 v33, v33
  s_waitcnt lgkmcnt(1)
  v_smfmac_f32_32x32x32_bf16 v[64:79], v[20:23], v[56:63], v24
  s_mov_b64 exec, s[48:49]
  ds_read_b128 v[20:23], v4 offset:27040
  s_mov_b64 exec, -1
  s_add_u32 m0, s54, 58240
  s_add_u32 s55, s53, 57344
  buffer_load_dwordx4 v2, s[8:11], s55 offen sc1 lds
  v_exp_f32 v34, v34
  v_exp_f32 v35, v35
  v_exp_f32 v36, v36
  v_exp_f32 v37, v37
  v_mfma_f32_32x32x16_bf16 v[48:63], v[12:15], v[8:11], 0
  ds_read_b128 v[12:15], v2 offset:28672
  v_exp_f32 v38, v38
  v_exp_f32 v39, v39
  v_exp_f32 v40, v40
  v_exp_f32 v41, v41
  s_waitcnt vmcnt(9)
  v_mfma_f32_32x32x16_bf16 v[80:95], v[112:115], v[116:119], v[80:95]
  v_exp_f32 v42, v42
  v_exp_f32 v43, v43
  v_exp_f32 v44, v44
  v_exp_f32 v45, v45
  s_waitcnt lgkmcnt(2)
  v_smfmac_f32_32x32x32_bf16 v[64:79], v[16:19], v[32:39], v24
  s_mov_b64 exec, s[48:49]
  ds_read_b128 v[16:19], v3 offset:28080
  s_mov_b64 exec, -1
  v_exp_f32 v46, v46
  v_exp_f32 v47, v47
  s_setprio 1
  v_exp_f32 v48, v48
  v_exp_f32 v49, v49
  s_waitcnt lgkmcnt(1)
  v_smfmac_f32_32x32x32_bf16 v[64:79], v[20:23], v[40:47], v24
  s_mov_b64 exec, s[48:49]
  ds_read_b128 v[20:23], v4 offset:28080
  s_mov_b64 exec, -1
  v_exp_f32 v50, v50
  v_exp_f32 v51, v51
  v_exp_f32 v52, v52
  v_exp_f32 v53, v53
  v_mfma_f32_32x32x16_bf16 v[32:47], v[12:15], v[8:11], 0
  ds_read_b128 v[12:15], v2 offset:29696
  v_exp_f32 v54, v54
  v_exp_f32 v55, v55
  v_exp_f32 v56, v56
  v_exp_f32 v57, v57
  v_mfma_f32_32x32x16_bf16 v[96:111], v[112:115], v[120:123], v[96:111]
  buffer_load_dwordx4 v[112:115], v2, s[8:11], s32 offen offset:0 sc1
  buffer_load_dwordx4 v[116:119], v2, s[8:11], s33 offen offset:0 sc1
  buffer_load_dwordx4 v[120:123], v2, s[8:11], s34 offen offset:0 sc1
  v_exp_f32 v58, v58
  v_exp_f32 v59, v59
  v_exp_f32 v60, v60
  v_exp_f32 v61, v61
  s_waitcnt lgkmcnt(2)
  v_smfmac_f32_32x32x32_bf16 v[64:79], v[16:19], v[48:55], v24
  s_mov_b64 exec, s[48:49]
  ds_read_b128 v[16:19], v3 offset:29120
  s_mov_b64 exec, -1
  v_exp_f32 v62, v62
  v_exp_f32 v63, v63
  s_setprio 0
  v_exp_f32 v32, v32
  v_exp_f32 v33, v33
  s_waitcnt lgkmcnt(1)
  v_smfmac_f32_32x32x32_bf16 v[64:79], v[20:23], v[56:63], v24
  s_mov_b64 exec, s[48:49]
  ds_read_b128 v[20:23], v4 offset:29120
  s_mov_b64 exec, -1
  v_exp_f32 v34, v34
  v_exp_f32 v35, v35
  v_exp_f32 v36, v36
  v_exp_f32 v37, v37
  v_mfma_f32_32x32x16_bf16 v[48:63], v[12:15], v[8:11], 0
  ds_read_b128 v[12:15], v2 offset:30720
  v_exp_f32 v38, v38
  v_exp_f32 v39, v39
  v_exp_f32 v40, v40
  v_exp_f32 v41, v41
  s_waitcnt vmcnt(8)
  v_mfma_f32_32x32x16_bf16 v[80:95], v[124:127], v[128:131], v[80:95]
  v_exp_f32 v42, v42
  v_exp_f32 v43, v43
  v_exp_f32 v44, v44
  v_exp_f32 v45, v45
  s_waitcnt lgkmcnt(2)
  v_smfmac_f32_32x32x32_bf16 v[64:79], v[16:19], v[32:39], v24
  s_mov_b64 exec, s[48:49]
  ds_read_b128 v[16:19], v3 offset:30160
  s_mov_b64 exec, -1
  v_exp_f32 v46, v46
  v_exp_f32 v47, v47
  s_setprio 3
  v_exp_f32 v48, v48
  v_exp_f32 v49, v49
  s_waitcnt lgkmcnt(1)
  v_smfmac_f32_32x32x32_bf16 v[64:79], v[20:23], v[40:47], v24
  s_mov_b64 exec, s[48:49]
  ds_read_b128 v[20:23], v4 offset:30160
  s_mov_b64 exec, -1
  v_exp_f32 v50, v50
  v_exp_f32 v51, v51
  v_exp_f32 v52, v52
  v_exp_f32 v53, v53
  v_mfma_f32_32x32x16_bf16 v[32:47], v[12:15], v[8:11], 0
  ds_read_b128 v[12:15], v2 offset:31744
  v_exp_f32 v54, v54
  v_exp_f32 v55, v55
  v_exp_f32 v56, v56
  v_exp_f32 v57, v57
  v_mfma_f32_32x32x16_bf16 v[96:111], v[124:127], v[132:135], v[96:111]
  buffer_load_dwordx4 v[124:127], v2, s[8:11], s32 offen offset:1024 sc1
  buffer_load_dwordx4 v[128:131], v2, s[8:11], s33 offen offset:1024 sc1
  buffer_load_dwordx4 v[132:135], v2, s[8:11], s34 offen offset:1024 sc1
  v_exp_f32 v58, v58
  v_exp_f32 v59, v59
  v_exp_f32 v60, v60
  v_exp_f32 v61, v61
  s_waitcnt lgkmcnt(2)
  v_smfmac_f32_32x32x32_bf16 v[64:79], v[16:19], v[48:55], v24
  s_mov_b64 exec, s[48:49]
  ds_read_b128 v[16:19], v3 offset:31200
  s_mov_b64 exec, -1
  v_exp_f32 v62, v62
  v_exp_f32 v63, v63
  s_setprio 2
  v_exp_f32 v32, v32
  v_exp_f32 v33, v33
  s_waitcnt lgkmcnt(1)
  v_smfmac_f32_32x32x32_bf16 v[64:79], v[20:23], v[56:63], v24
  s_mov_b64 exec, s[48:49]
  ds_read_b128 v[20:23], v4 offset:31200
  s_mov_b64 exec, -1
  buffer_load_dwordx4 v[184:187], v2, s[8:11], s37 offen offset:0 sc1
  v_exp_f32 v34, v34
  v_exp_f32 v35, v35
  v_exp_f32 v36, v36
  v_exp_f32 v37, v37
  v_mfma_f32_32x32x16_bf16 v[48:63], v[12:15], v[8:11], 0
  ds_read_b128 v[12:15], v2 offset:32768
  v_exp_f32 v38, v38
  v_exp_f32 v39, v39
  v_exp_f32 v40, v40
  v_exp_f32 v41, v41
  s_waitcnt vmcnt(8)
  v_mfma_f32_32x32x16_bf16 v[80:95], v[136:139], v[140:143], v[80:95]
  v_exp_f32 v42, v42
  v_exp_f32 v43, v43
  v_exp_f32 v44, v44
  v_exp_f32 v45, v45
  s_waitcnt lgkmcnt(2)
  v_smfmac_f32_32x32x32_bf16 v[64:79], v[16:19], v[32:39], v24
  s_mov_b64 exec, s[48:49]
  ds_read_b128 v[16:19], v3 offset:32240
  s_mov_b64 exec, -1
  v_exp_f32 v46, v46
  v_exp_f32 v47, v47
  s_setprio 1
  v_exp_f32 v48, v48
  v_exp_f32 v49, v49
  s_waitcnt lgkmcnt(1)
  v_smfmac_f32_32x32x32_bf16 v[64:79], v[20:23], v[40:47], v24
  s_mov_b64 exec, s[48:49]
  ds_read_b128 v[20:23], v4 offset:32240
  s_mov_b64 exec, -1
  v_exp_f32 v50, v50
  v_exp_f32 v51, v51
  v_exp_f32 v52, v52
  v_exp_f32 v53, v53
  v_mfma_f32_32x32x16_bf16 v[32:47], v[12:15], v[8:11], 0
  ds_read_b128 v[12:15], v2 offset:33792
  v_exp_f32 v54, v54
  v_exp_f32 v55, v55
  v_exp_f32 v56, v56
  v_exp_f32 v57, v57
  v_mfma_f32_32x32x16_bf16 v[96:111], v[136:139], v[144:147], v[96:111]
  buffer_load_dwordx4 v[136:139], v2, s[8:11], s32 offen offset:2048 sc1
  buffer_load_dwordx4 v[140:143], v2, s[8:11], s33 offen offset:2048 sc1
  buffer_load_dwordx4 v[144:147], v2, s[8:11], s34 offen offset:2048 sc1
  v_exp_f32 v58, v58
  v_exp_f32 v59, v59
  v_exp_f32 v60, v60
  v_exp_f32 v61, v61
  s_waitcnt lgkmcnt(2)
  v_smfmac_f32_32x32x32_bf16 v[64:79], v[16:19], v[48:55], v24
  s_mov_b64 exec, s[48:49]
  ds_read_b128 v[16:19], v3 offset:33280
  s_mov_b64 exec, -1
  v_exp_f32 v62, v62
  v_exp_f32 v63, v63
  s_setprio 0
  v_exp_f32 v32, v32
  v_exp_f32 v33, v33
  s_waitcnt lgkmcnt(1)
  v_smfmac_f32_32x32x32_bf16 v[64:79], v[20:23], v[56:63], v24
  s_mov_b64 exec, s[48:49]
  ds_read_b128 v[20:23], v4 offset:33280
  s_mov_b64 exec, -1
  buffer_load_dwordx4 v[188:191], v2, s[8:11], s37 offen offset:1024 sc1
  v_exp_f32 v34, v34
  v_exp_f32 v35, v35
  v_exp_f32 v36, v36
  v_exp_f32 v37, v37
  v_mfma_f32_32x32x16_bf16 v[48:63], v[12:15], v[8:11], 0
  ds_read_b128 v[12:15], v2 offset:34816
  v_exp_f32 v38, v38
  v_exp_f32 v39, v39
  v_exp_f32 v40, v40
  v_exp_f32 v41, v41
  s_waitcnt vmcnt(8)
  v_mfma_f32_32x32x16_bf16 v[80:95], v[112:115], v[116:119], v[80:95]
  v_exp_f32 v42, v42
  v_exp_f32 v43, v43
  v_exp_f32 v44, v44
  v_exp_f32 v45, v45
  s_waitcnt lgkmcnt(2)
  v_smfmac_f32_32x32x32_bf16 v[64:79], v[16:19], v[32:39], v24
  s_mov_b64 exec, s[48:49]
  ds_read_b128 v[16:19], v3 offset:34320
  s_mov_b64 exec, -1
  v_exp_f32 v46, v46
  v_exp_f32 v47, v47
  s_setprio 3
  v_exp_f32 v48, v48
  v_exp_f32 v49, v49
  s_waitcnt lgkmcnt(1)
  v_smfmac_f32_32x32x32_bf16 v[64:79], v[20:23], v[40:47], v24
  s_mov_b64 exec, s[48:49]
  ds_read_b128 v[20:23], v4 offset:34320
  s_mov_b64 exec, -1
  v_exp_f32 v50, v50
  v_exp_f32 v51, v51
  v_exp_f32 v52, v52
  v_exp_f32 v53, v53
  v_mfma_f32_32x32x16_bf16 v[32:47], v[12:15], v[8:11], 0
  ds_read_b128 v[12:15], v2 offset:35840
  v_exp_f32 v54, v54
  v_exp_f32 v55, v55
  v_exp_f32 v56, v56
  v_exp_f32 v57, v57
  v_mfma_f32_32x32x16_bf16 v[96:111], v[112:115], v[120:123], v[96:111]
  buffer_load_dwordx4 v[112:115], v2, s[8:11], s32 offen offset:3072 sc1
  buffer_load_dwordx4 v[116:119], v2, s[8:11], s33 offen offset:3072 sc1
  buffer_load_dwordx4 v[120:123], v2, s[8:11], s34 offen offset:3072 sc1
  s_add_u32 s32, s32, 4096
  s_add_u32 s33, s33, 4096
  s_add_u32 s34, s34, 4096
  v_exp_f32 v58, v58
  v_exp_f32 v59, v59
  v_exp_f32 v60, v60
  v_exp_f32 v61, v61
  s_waitcnt lgkmcnt(2)
  v_smfmac_f32_32x32x32_bf16 v[64:79], v[16:19], v[48:55], v24
  s_mov_b64 exec, s[48:49]
  ds_read_b128 v[16:19], v3 offset:35360
  s_mov_b64 exec, -1
  v_exp_f32 v62, v62
  v_exp_f32 v63, v63
  s_setprio 2
  v_exp_f32 v32, v32
  v_exp_f32 v33, v33
  s_waitcnt lgkmcnt(1)
  v_smfmac_f32_32x32x32_bf16 v[64:79], v[20:23], v[56:63], v24
  s_mov_b64 exec, s[48:49]
  ds_read_b128 v[20:23], v4 offset:35360
  s_mov_b64 exec, -1
  buffer_load_dwordx4 v[192:195], v2, s[8:11], s37 offen offset:2048 sc1
  v_exp_f32 v34, v34
  v_exp_f32 v35, v35
  v_exp_f32 v36, v36
  v_exp_f32 v37, v37
  v_mfma_f32_32x32x16_bf16 v[48:63], v[12:15], v[8:11], 0
  ds_read_b128 v[12:15], v2 offset:36864
  v_exp_f32 v38, v38
  v_exp_f32 v39, v39
  v_exp_f32 v40, v40
  v_exp_f32 v41, v41
  s_waitcnt vmcnt(9)
  v_mfma_f32_32x32x16_bf16 v[80:95], v[124:127], v[128:131], v[80:95]
  v_exp_f32 v42, v42
  v_exp_f32 v43, v43
  v_exp_f32 v44, v44
  v_exp_f32 v45, v45
  s_waitcnt lgkmcnt(2)
  v_smfmac_f32_32x32x32_bf16 v[64:79], v[16:19], v[32:39], v24
  s_mov_b64 exec, s[48:49]
  ds_read_b128 v[16:19], v3 offset:36400
  s_mov_b64 exec, -1
  v_exp_f32 v46, v46
  v_exp_f32 v47, v47
  s_setprio 1
  v_exp_f32 v48, v48
  v_exp_f32 v49, v49
  s_waitcnt lgkmcnt(1)
  v_smfmac_f32_32x32x32_bf16 v[64:79], v[20:23], v[40:47], v24
  s_mov_b64 exec, s[48:49]
  ds_read_b128 v[20:23], v4 offset:36400
  s_mov_b64 exec, -1
  v_exp_f32 v50, v50
  v_exp_f32 v51, v51
  v_exp_f32 v52, v52
  v_exp_f32 v53, v53
  v_mfma_f32_32x32x16_bf16 v[32:47], v[12:15], v[8:11], 0
  ds_read_b128 v[12:15], v2 offset:37888
  v_exp_f32 v54, v54
  v_exp_f32 v55, v55
  v_exp_f32 v56, v56
  v_exp_f32 v57, v57
  v_mfma_f32_32x32x16_bf16 v[96:111], v[124:127], v[132:135], v[96:111]
  buffer_load_dwordx4 v[124:127], v2, s[8:11], s32 offen offset:0 sc1
  buffer_load_dwordx4 v[128:131], v2, s[8:11], s33 offen offset:0 sc1
  buffer_load_dwordx4 v[132:135], v2, s[8:11], s34 offen offset:0 sc1
  v_exp_f32 v58, v58
  v_exp_f32 v59, v59
  v_exp_f32 v60, v60
  v_exp_f32 v61, v61
  s_waitcnt lgkmcnt(2)
  v_smfmac_f32_32x32x32_bf16 v[64:79], v[16:19], v[48:55], v24
  s_mov_b64 exec, s[48:49]
  ds_read_b128 v[16:19], v3 offset:37440
  s_mov_b64 exec, -1
  v_exp_f32 v62, v62
  v_exp_f32 v63, v63
  s_setprio 0
  v_exp_f32 v32, v32
  v_exp_f32 v33, v33
  s_waitcnt lgkmcnt(1)
  v_smfmac_f32_32x32x32_bf16 v[64:79], v[20:23], v[56:63], v24
  s_mov_b64 exec, s[48:49]
  ds_read_b128 v[20:23], v4 offset:37440
  s_mov_b64 exec, -1
  buffer_load_dwordx4 v[196:199], v2, s[8:11], s37 offen offset:3072 sc1
  s_add_u32 s37, s37, 4096
  v_exp_f32 v34, v34
  v_exp_f32 v35, v35
  v_exp_f32 v36, v36
  v_exp_f32 v37, v37
  v_mfma_f32_32x32x16_bf16 v[48:63], v[12:15], v[8:11], 0
  ds_read_b128 v[12:15], v2 offset:38912
  v_exp_f32 v38, v38
  v_exp_f32 v39, v39
  v_exp_f32 v40, v40
  v_exp_f32 v41, v41
  s_waitcnt vmcnt(9)
  v_mfma_f32_32x32x16_bf16 v[80:95], v[136:139], v[140:143], v[80:95]
  v_exp_f32 v42, v42
  v_exp_f32 v43, v43
  v_exp_f32 v44, v44
  v_exp_f32 v45, v45
  s_waitcnt lgkmcnt(2)
  v_smfmac_f32_32x32x32_bf16 v[64:79], v[16:19], v[32:39], v24
  s_mov_b64 exec, s[48:49]
  ds_read_b128 v[16:19], v3 offset:38480
  s_mov_b64 exec, -1
  v_exp_f32 v46, v46
  v_exp_f32 v47, v47
  s_setprio 3
  v_exp_f32 v48, v48
  v_exp_f32 v49, v49
  s_waitcnt lgkmcnt(1)
  v_smfmac_f32_32x32x32_bf16 v[64:79], v[20:23], v[40:47], v24
  s_mov_b64 exec, s[48:49]
  ds_read_b128 v[20:23], v4 offset:38480
  s_mov_b64 exec, -1
  v_exp_f32 v50, v50
  v_exp_f32 v51, v51
  v_exp_f32 v52, v52
  v_exp_f32 v53, v53
  v_mfma_f32_32x32x16_bf16 v[32:47], v[12:15], v[8:11], 0
  ds_read_b128 v[12:15], v2 offset:39936
  v_exp_f32 v54, v54
  v_exp_f32 v55, v55
  v_exp_f32 v56, v56
  v_exp_f32 v57, v57
  v_mfma_f32_32x32x16_bf16 v[96:111], v[136:139], v[144:147], v[96:111]
  buffer_load_dwordx4 v[136:139], v2, s[8:11], s32 offen offset:1024 sc1
  buffer_load_dwordx4 v[140:143], v2, s[8:11], s33 offen offset:1024 sc1
  buffer_load_dwordx4 v[144:147], v2, s[8:11], s34 offen offset:1024 sc1
  v_exp_f32 v58, v58
  v_exp_f32 v59, v59
  v_exp_f32 v60, v60
  v_exp_f32 v61, v61
  s_waitcnt lgkmcnt(2)
  v_smfmac_f32_32x32x32_bf16 v[64:79], v[16:19], v[48:55], v24
  s_mov_b64 exec, s[48:49]
  ds_read_b128 v[16:19], v3 offset:39520
  s_mov_b64 exec, -1
  v_exp_f32 v62, v62
  v_exp_f32 v63, v63
  s_setprio 2
  v_exp_f32 v32, v32
  v_exp_f32 v33, v33
  s_waitcnt lgkmcnt(1)
  v_smfmac_f32_32x32x32_bf16 v[64:79], v[20:23], v[56:63], v24
  s_mov_b64 exec, s[48:49]
  ds_read_b128 v[20:23], v4 offset:39520
  s_mov_b64 exec, -1
  buffer_load_dwordx4 v[200:203], v2, s[8:11], s37 offen offset:0 sc1
  v_exp_f32 v34, v34
  v_exp_f32 v35, v35
  v_exp_f32 v36, v36
  v_exp_f32 v37, v37
  v_mfma_f32_32x32x16_bf16 v[48:63], v[12:15], v[8:11], 0
  s_barrier
  ds_read_b128 v[12:15], v2 offset:40960
  v_exp_f32 v38, v38
  v_exp_f32 v39, v39
  v_exp_f32 v40, v40
  v_exp_f32 v41, v41
  s_waitcnt vmcnt(9)
  v_mfma_f32_32x32x16_bf16 v[80:95], v[112:115], v[116:119], v[80:95]
  v_exp_f32 v42, v42
  v_exp_f32 v43, v43
  v_exp_f32 v44, v44
  v_exp_f32 v45, v45
  s_waitcnt lgkmcnt(2)
  v_smfmac_f32_32x32x32_bf16 v[64:79], v[16:19], v[32:39], v24
  s_mov_b64 exec, s[48:49]
  ds_read_b128 v[16:19], v3 offset:40560
  s_mov_b64 exec, -1
  v_exp_f32 v46, v46
  v_exp_f32 v47, v47
  s_setprio 1
  v_exp_f32 v48, v48
  v_exp_f32 v49, v49
  s_waitcnt lgkmcnt(1)
  v_smfmac_f32_32x32x32_bf16 v[64:79], v[20:23], v[40:47], v24
  s_mov_b64 exec, s[48:49]
  ds_read_b128 v[20:23], v4 offset:40560
  s_mov_b64 exec, -1
  v_exp_f32 v50, v50
  v_exp_f32 v51, v51
  v_exp_f32 v52, v52
  v_exp_f32 v53, v53
  v_mfma_f32_32x32x16_bf16 v[32:47], v[12:15], v[8:11], 0
  ds_read_b128 v[12:15], v2 offset:41984
  v_exp_f32 v54, v54
  v_exp_f32 v55, v55
  v_exp_f32 v56, v56
  v_exp_f32 v57, v57
  v_mfma_f32_32x32x16_bf16 v[96:111], v[112:115], v[120:123], v[96:111]
  buffer_load_dwordx4 v[112:115], v2, s[8:11], s32 offen offset:2048 sc1
  buffer_load_dwordx4 v[116:119], v2, s[8:11], s33 offen offset:2048 sc1
  buffer_load_dwordx4 v[120:123], v2, s[8:11], s34 offen offset:2048 sc1
  v_exp_f32 v58, v58
  v_exp_f32 v59, v59
  v_exp_f32 v60, v60
  v_exp_f32 v61, v61
  s_waitcnt lgkmcnt(2)
  v_smfmac_f32_32x32x32_bf16 v[64:79], v[16:19], v[48:55], v24
  s_mov_b64 exec, s[48:49]
  ds_read_b128 v[16:19], v3 offset:41600
  s_mov_b64 exec, -1
  v_exp_f32 v62, v62
  v_exp_f32 v63, v63
  s_setprio 0
  v_exp_f32 v32, v32
  v_exp_f32 v33, v33
  s_waitcnt lgkmcnt(1)
  v_smfmac_f32_32x32x32_bf16 v[64:79], v[20:23], v[56:63], v24
  s_mov_b64 exec, s[48:49]
  ds_read_b128 v[20:23], v4 offset:41600
  s_mov_b64 exec, -1
  buffer_load_dwordx4 v[204:207], v2, s[8:11], s37 offen offset:1024 sc1
  v_exp_f32 v34, v34
  v_exp_f32 v35, v35
  v_exp_f32 v36, v36
  v_exp_f32 v37, v37
  v_mfma_f32_32x32x16_bf16 v[48:63], v[12:15], v[8:11], 0
  ds_read_b128 v[12:15], v2 offset:43008
  v_exp_f32 v38, v38
  v_exp_f32 v39, v39
  v_exp_f32 v40, v40
  v_exp_f32 v41, v41
  s_waitcnt vmcnt(9)
  v_mfma_f32_32x32x16_bf16 v[80:95], v[124:127], v[128:131], v[80:95]
  v_exp_f32 v42, v42
  v_exp_f32 v43, v43
  v_exp_f32 v44, v44
  v_exp_f32 v45, v45
  s_waitcnt lgkmcnt(2)
  v_smfmac_f32_32x32x32_bf16 v[64:79], v[16:19], v[32:39], v24
  s_mov_b64 exec, s[48:49]
  ds_read_b128 v[16:19], v3 offset:42640
  s_mov_b64 exec, -1
  v_exp_f32 v46, v46
  v_exp_f32 v47, v47
  s_setprio 3
  v_exp_f32 v48, v48
  v_exp_f32 v49, v49
  s_waitcnt lgkmcnt(1)
  v_smfmac_f32_32x32x32_bf16 v[64:79], v[20:23], v[40:47], v24
  s_mov_b64 exec, s[48:49]
  ds_read_b128 v[20:23], v4 offset:42640
  s_mov_b64 exec, -1
  v_exp_f32 v50, v50
  v_exp_f32 v51, v51
  v_exp_f32 v52, v52
  v_exp_f32 v53, v53
  v_mfma_f32_32x32x16_bf16 v[32:47], v[12:15], v[8:11], 0
  ds_read_b128 v[12:15], v2 offset:44032
  v_exp_f32 v54, v54
  v_exp_f32 v55, v55
  v_exp_f32 v56, v56
  v_exp_f32 v57, v57
  v_mfma_f32_32x32x16_bf16 v[96:111], v[124:127], v[132:135], v[96:111]
  buffer_load_dwordx4 v[124:127], v2, s[8:11], s32 offen offset:3072 sc1
  buffer_load_dwordx4 v[128:131], v2, s[8:11], s33 offen offset:3072 sc1
  buffer_load_dwordx4 v[132:135], v2, s[8:11], s34 offen offset:3072 sc1
  s_add_u32 s32, s32, 4096
  s_add_u32 s33, s33, 4096
  s_add_u32 s34, s34, 4096
  v_exp_f32 v58, v58
  v_exp_f32 v59, v59
  v_exp_f32 v60, v60
  v_exp_f32 v61, v61
  s_waitcnt lgkmcnt(2)
  v_smfmac_f32_32x32x32_bf16 v[64:79], v[16:19], v[48:55], v24
  s_mov_b64 exec, s[48:49]
  ds_read_b128 v[16:19], v3 offset:43680
  s_mov_b64 exec, -1
  v_exp_f32 v62, v62
  v_exp_f32 v63, v63
  s_setprio 2
  v_exp_f32 v32, v32
  v_exp_f32 v33, v33
  s_waitcnt lgkmcnt(1)
  v_smfmac_f32_32x32x32_bf16 v[64:79], v[20:23], v[56:63], v24
  s_mov_b64 exec, s[48:49]
  ds_read_b128 v[20:23], v4 offset:43680
  s_mov_b64 exec, -1
  buffer_load_dwordx4 v[208:211], v2, s[8:11], s37 offen offset:2048 sc1
  v_exp_f32 v34, v34
  v_exp_f32 v35, v35
  v_exp_f32 v36, v36
  v_exp_f32 v37, v37
  v_mfma_f32_32x32x16_bf16 v[48:63], v[12:15], v[8:11], 0
  ds_read_b128 v[12:15], v2 offset:45056
  v_exp_f32 v38, v38
  v_exp_f32 v39, v39
  v_exp_f32 v40, v40
  v_exp_f32 v41, v41
  s_waitcnt vmcnt(9)
  v_mfma_f32_32x32x16_bf16 v[80:95], v[136:139], v[140:143], v[80:95]
  v_exp_f32 v42, v42
  v_exp_f32 v43, v43
  v_exp_f32 v44, v44
  v_exp_f32 v45, v45
  s_waitcnt lgkmcnt(2)
  v_smfmac_f32_32x32x32_bf16 v[64:79], v[16:19], v[32:39], v24
  s_mov_b64 exec, s[48:49]
  ds_read_b128 v[16:19], v3 offset:44720
  s_mov_b64 exec, -1
  v_exp_f32 v46, v46
  v_exp_f32 v47, v47
  s_setprio 1
  v_exp_f32 v48, v48
  v_exp_f32 v49, v49
  s_waitcnt lgkmcnt(1)
  v_smfmac_f32_32x32x32_bf16 v[64:79], v[20:23], v[40:47], v24
  s_mov_b64 exec, s[48:49]
  ds_read_b128 v[20:23], v4 offset:44720
  s_mov_b64 exec, -1
  v_exp_f32 v50, v50
  v_exp_f32 v51, v51
  v_exp_f32 v52, v52
  v_exp_f32 v53, v53
  v_mfma_f32_32x32x16_bf16 v[32:47], v[12:15], v[8:11], 0
  ds_read_b128 v[12:15], v2 offset:46080
  v_exp_f32 v54, v54
  v_exp_f32 v55, v55
  v_exp_f32 v56, v56
  v_exp_f32 v57, v57
  v_mfma_f32_32x32x16_bf16 v[96:111], v[136:139], v[144:147], v[96:111]
  buffer_load_dwordx4 v[136:139], v2, s[8:11], s32 offen offset:0 sc1
  buffer_load_dwordx4 v[140:143], v2, s[8:11], s33 offen offset:0 sc1
  buffer_load_dwordx4 v[144:147], v2, s[8:11], s34 offen offset:0 sc1
  v_exp_f32 v58, v58
  v_exp_f32 v59, v59
  v_exp_f32 v60, v60
  v_exp_f32 v61, v61
  s_waitcnt lgkmcnt(2)
  v_smfmac_f32_32x32x32_bf16 v[64:79], v[16:19], v[48:55], v24
  s_mov_b64 exec, s[48:49]
  ds_read_b128 v[16:19], v3 offset:45760
  s_mov_b64 exec, -1
  v_exp_f32 v62, v62
  v_exp_f32 v63, v63
  s_setprio 0
  v_exp_f32 v32, v32
  v_exp_f32 v33, v33
  s_waitcnt lgkmcnt(1)
  v_smfmac_f32_32x32x32_bf16 v[64:79], v[20:23], v[56:63], v24
  s_mov_b64 exec, s[48:49]
  ds_read_b128 v[20:23], v4 offset:45760
  s_mov_b64 exec, -1
  buffer_load_dwordx4 v[212:215], v2, s[8:11], s37 offen offset:3072 sc1
  s_add_u32 s37, s37, 4096
  v_exp_f32 v34, v34
  v_exp_f32 v35, v35
  v_exp_f32 v36, v36
  v_exp_f32 v37, v37
  v_mfma_f32_32x32x16_bf16 v[48:63], v[12:15], v[8:11], 0
  ds_read_b128 v[12:15], v2 offset:47104
  v_exp_f32 v38, v38
  v_exp_f32 v39, v39
  v_exp_f32 v40, v40
  v_exp_f32 v41, v41
  s_waitcnt vmcnt(9)
  v_mfma_f32_32x32x16_bf16 v[80:95], v[112:115], v[116:119], v[80:95]
  v_exp_f32 v42, v42
  v_exp_f32 v43, v43
  v_exp_f32 v44, v44
  v_exp_f32 v45, v45
  s_waitcnt lgkmcnt(2)
  v_smfmac_f32_32x32x32_bf16 v[64:79], v[16:19], v[32:39], v24
  s_mov_b64 exec, s[48:49]
  ds_read_b128 v[16:19], v3 offset:46800
  s_mov_b64 exec, -1
  v_exp_f32 v46, v46
  v_exp_f32 v47, v47
  s_setprio 3
  v_exp_f32 v48, v48
  v_exp_f32 v49, v49
  s_waitcnt lgkmcnt(1)
  v_smfmac_f32_32x32x32_bf16 v[64:79], v[20:23], v[40:47], v24
  s_mov_b64 exec, s[48:49]
  ds_read_b128 v[20:23], v4 offset:46800
  s_mov_b64 exec, -1
  v_exp_f32 v50, v50
  v_exp_f32 v51, v51
  v_exp_f32 v52, v52
  v_exp_f32 v53, v53
  v_mfma_f32_32x32x16_bf16 v[32:47], v[12:15], v[8:11], 0
  ds_read_b128 v[12:15], v2 offset:48128
  v_exp_f32 v54, v54
  v_exp_f32 v55, v55
  v_exp_f32 v56, v56
  v_exp_f32 v57, v57
  v_mfma_f32_32x32x16_bf16 v[96:111], v[112:115], v[120:123], v[96:111]
  buffer_load_dwordx4 v[112:115], v2, s[8:11], s32 offen offset:1024 sc1
  buffer_load_dwordx4 v[116:119], v2, s[8:11], s33 offen offset:1024 sc1
  buffer_load_dwordx4 v[120:123], v2, s[8:11], s34 offen offset:1024 sc1
  v_exp_f32 v58, v58
  v_exp_f32 v59, v59
  v_exp_f32 v60, v60
  v_exp_f32 v61, v61
  s_waitcnt lgkmcnt(2)
  v_smfmac_f32_32x32x32_bf16 v[64:79], v[16:19], v[48:55], v24
  s_mov_b64 exec, s[48:49]
  ds_read_b128 v[16:19], v3 offset:47840
  s_mov_b64 exec, -1
  v_exp_f32 v62, v62
  v_exp_f32 v63, v63
  s_setprio 2
  v_exp_f32 v32, v32
  v_exp_f32 v33, v33
  s_waitcnt lgkmcnt(1)
  v_smfmac_f32_32x32x32_bf16 v[64:79], v[20:23], v[56:63], v24
  s_mov_b64 exec, s[48:49]
  ds_read_b128 v[20:23], v4 offset:47840
  s_mov_b64 exec, -1
  buffer_load_dwordx4 v[216:219], v2, s[8:11], s37 offen offset:0 sc1
  v_exp_f32 v34, v34
  v_exp_f32 v35, v35
  v_exp_f32 v36, v36
  v_exp_f32 v37, v37
  v_mfma_f32_32x32x16_bf16 v[48:63], v[12:15], v[8:11], 0
  ds_read_b128 v[12:15], v2 offset:49152
  v_exp_f32 v38, v38
  v_exp_f32 v39, v39
  v_exp_f32 v40, v40
  v_exp_f32 v41, v41
  s_waitcnt vmcnt(9)
  v_mfma_f32_32x32x16_bf16 v[80:95], v[124:127], v[128:131], v[80:95]
  v_exp_f32 v42, v42
  v_exp_f32 v43, v43
  v_exp_f32 v44, v44
  v_exp_f32 v45, v45
  s_waitcnt lgkmcnt(2)
  v_smfmac_f32_32x32x32_bf16 v[64:79], v[16:19], v[32:39], v24
  s_mov_b64 exec, s[48:49]
  ds_read_b128 v[16:19], v3 offset:48880
  s_mov_b64 exec, -1
  v_exp_f32 v46, v46
  v_exp_f32 v47, v47
  s_setprio 1
  v_exp_f32 v48, v48
  v_exp_f32 v49, v49
  s_waitcnt lgkmcnt(1)
  v_smfmac_f32_32x32x32_bf16 v[64:79], v[20:23], v[40:47], v24
  s_mov_b64 exec, s[48:49]
  ds_read_b128 v[20:23], v4 offset:48880
  s_mov_b64 exec, -1
  v_exp_f32 v50, v50
  v_exp_f32 v51, v51
  v_exp_f32 v52, v52
  v_exp_f32 v53, v53
  v_mfma_f32_32x32x16_bf16 v[32:47], v[12:15], v[8:11], 0
  ds_read_b128 v[12:15], v2 offset:50176
  v_exp_f32 v54, v54
  v_exp_f32 v55, v55
  v_exp_f32 v56, v56
  v_exp_f32 v57, v57
  v_mfma_f32_32x32x16_bf16 v[96:111], v[124:127], v[132:135], v[96:111]
  buffer_load_dwordx4 v[124:127], v2, s[8:11], s32 offen offset:2048 sc1
  buffer_load_dwordx4 v[128:131], v2, s[8:11], s33 offen offset:2048 sc1
  buffer_load_dwordx4 v[132:135], v2, s[8:11], s34 offen offset:2048 sc1
  v_exp_f32 v58, v58
  v_exp_f32 v59, v59
  v_exp_f32 v60, v60
  v_exp_f32 v61, v61
  s_waitcnt lgkmcnt(2)
  v_smfmac_f32_32x32x32_bf16 v[64:79], v[16:19], v[48:55], v24
  s_mov_b64 exec, s[48:49]
  ds_read_b128 v[16:19], v3 offset:49920
  s_mov_b64 exec, -1
  v_exp_f32 v62, v62
  v_exp_f32 v63, v63
  s_setprio 0
  v_exp_f32 v32, v32
  v_exp_f32 v33, v33
  s_waitcnt lgkmcnt(1)
  v_smfmac_f32_32x32x32_bf16 v[64:79], v[20:23], v[56:63], v24
  s_mov_b64 exec, s[48:49]
  ds_read_b128 v[20:23], v4 offset:49920
  s_mov_b64 exec, -1
  buffer_load_dwordx4 v[220:223], v2, s[8:11], s37 offen offset:1024 sc1
  v_exp_f32 v34, v34
  v_exp_f32 v35, v35
  v_exp_f32 v36, v36
  v_exp_f32 v37, v37
  v_mfma_f32_32x32x16_bf16 v[48:63], v[12:15], v[8:11], 0
  ds_read_b128 v[12:15], v2 offset:51200
  v_exp_f32 v38, v38
  v_exp_f32 v39, v39
  v_exp_f32 v40, v40
  v_exp_f32 v41, v41
  s_waitcnt vmcnt(9)
  v_mfma_f32_32x32x16_bf16 v[80:95], v[136:139], v[140:143], v[80:95]
  v_exp_f32 v42, v42
  v_exp_f32 v43, v43
  v_exp_f32 v44, v44
  v_exp_f32 v45, v45
  s_waitcnt lgkmcnt(2)
  v_smfmac_f32_32x32x32_bf16 v[64:79], v[16:19], v[32:39], v24
  s_mov_b64 exec, s[48:49]
  ds_read_b128 v[16:19], v3 offset:50960
  s_mov_b64 exec, -1
  v_exp_f32 v46, v46
  v_exp_f32 v47, v47
  s_setprio 3
  v_exp_f32 v48, v48
  v_exp_f32 v49, v49
  s_waitcnt lgkmcnt(1)
  v_smfmac_f32_32x32x32_bf16 v[64:79], v[20:23], v[40:47], v24
  s_mov_b64 exec, s[48:49]
  ds_read_b128 v[20:23], v4 offset:50960
  s_mov_b64 exec, -1
  v_exp_f32 v50, v50
  v_exp_f32 v51, v51
  v_exp_f32 v52, v52
  v_exp_f32 v53, v53
  v_mfma_f32_32x32x16_bf16 v[32:47], v[12:15], v[8:11], 0
  ds_read_b128 v[12:15], v2 offset:52224
  v_exp_f32 v54, v54
  v_exp_f32 v55, v55
  v_exp_f32 v56, v56
  v_exp_f32 v57, v57
  v_mfma_f32_32x32x16_bf16 v[96:111], v[136:139], v[144:147], v[96:111]
  buffer_load_dwordx4 v[136:139], v2, s[8:11], s32 offen offset:3072 sc1
  buffer_load_dwordx4 v[140:143], v2, s[8:11], s33 offen offset:3072 sc1
  buffer_load_dwordx4 v[144:147], v2, s[8:11], s34 offen offset:3072 sc1
  s_add_u32 s32, s32, 4096
  s_add_u32 s33, s33, 4096
  s_add_u32 s34, s34, 4096
  v_exp_f32 v58, v58
  v_exp_f32 v59, v59
  v_exp_f32 v60, v60
  v_exp_f32 v61, v61
  s_waitcnt lgkmcnt(2)
  v_smfmac_f32_32x32x32_bf16 v[64:79], v[16:19], v[48:55], v24
  s_mov_b64 exec, s[48:49]
  ds_read_b128 v[16:19], v3 offset:52000
  s_mov_b64 exec, -1
  v_exp_f32 v62, v62
  v_exp_f32 v63, v63
  s_setprio 2
  v_exp_f32 v32, v32
  v_exp_f32 v33, v33
  s_waitcnt lgkmcnt(1)
  v_smfmac_f32_32x32x32_bf16 v[64:79], v[20:23], v[56:63], v24
  s_mov_b64 exec, s[48:49]
  ds_read_b128 v[20:23], v4 offset:52000
  s_mov_b64 exec, -1
  buffer_load_dwordx4 v[224:227], v2, s[8:11], s37 offen offset:2048 sc1
  v_exp_f32 v34, v34
  v_exp_f32 v35, v35
  v_exp_f32 v36, v36
  v_exp_f32 v37, v37
  v_mfma_f32_32x32x16_bf16 v[48:63], v[12:15], v[8:11], 0
  ds_read_b128 v[12:15], v2 offset:53248
  v_exp_f32 v38, v38
  v_exp_f32 v39, v39
  v_exp_f32 v40, v40
  v_exp_f32 v41, v41
  s_waitcnt vmcnt(9)
  v_mfma_f32_32x32x16_bf16 v[80:95], v[112:115], v[116:119], v[80:95]
  v_exp_f32 v42, v42
  v_exp_f32 v43, v43
  v_exp_f32 v44, v44
  v_exp_f32 v45, v45
  s_waitcnt lgkmcnt(2)
  v_smfmac_f32_32x32x32_bf16 v[64:79], v[16:19], v[32:39], v24
  s_mov_b64 exec, s[48:49]
  ds_read_b128 v[16:19], v3 offset:53040
  s_mov_b64 exec, -1
  v_exp_f32 v46, v46
  v_exp_f32 v47, v47
  s_setprio 1
  v_exp_f32 v48, v48
  v_exp_f32 v49, v49
  s_waitcnt lgkmcnt(1)
  v_smfmac_f32_32x32x32_bf16 v[64:79], v[20:23], v[40:47], v24
  s_mov_b64 exec, s[48:49]
  ds_read_b128 v[20:23], v4 offset:53040
  s_mov_b64 exec, -1
  v_exp_f32 v50, v50
  v_exp_f32 v51, v51
  v_exp_f32 v52, v52
  v_exp_f32 v53, v53
  v_mfma_f32_32x32x16_bf16 v[32:47], v[12:15], v[8:11], 0
  ds_read_b128 v[12:15], v2 offset:54272
  v_exp_f32 v54, v54
  v_exp_f32 v55, v55
  v_exp_f32 v56, v56
  v_exp_f32 v57, v57
  v_mfma_f32_32x32x16_bf16 v[96:111], v[112:115], v[120:123], v[96:111]
  buffer_load_dwordx4 v[112:115], v2, s[8:11], s32 offen offset:0 sc1
  buffer_load_dwordx4 v[116:119], v2, s[8:11], s33 offen offset:0 sc1
  buffer_load_dwordx4 v[120:123], v2, s[8:11], s34 offen offset:0 sc1
  v_exp_f32 v58, v58
  v_exp_f32 v59, v59
  v_exp_f32 v60, v60
  v_exp_f32 v61, v61
  s_waitcnt lgkmcnt(2)
  v_smfmac_f32_32x32x32_bf16 v[64:79], v[16:19], v[48:55], v24
  s_mov_b64 exec, s[48:49]
  ds_read_b128 v[16:19], v3 offset:54080
  s_mov_b64 exec, -1
  v_exp_f32 v62, v62
  v_exp_f32 v63, v63
  s_setprio 0
  v_exp_f32 v32, v32
  v_exp_f32 v33, v33
  s_waitcnt lgkmcnt(1)
  v_smfmac_f32_32x32x32_bf16 v[64:79], v[20:23], v[56:63], v24
  s_mov_b64 exec, s[48:49]
  ds_read_b128 v[20:23], v4 offset:54080
  s_mov_b64 exec, -1
  buffer_load_dwordx4 v[228:231], v2, s[8:11], s37 offen offset:3072 sc1
  s_add_u32 s37, s37, 4096
  v_exp_f32 v34, v34
  v_exp_f32 v35, v35
  v_exp_f32 v36, v36
  v_exp_f32 v37, v37
  v_mfma_f32_32x32x16_bf16 v[48:63], v[12:15], v[8:11], 0
  ds_read_b128 v[12:15], v2 offset:55296
  v_exp_f32 v38, v38
  v_exp_f32 v39, v39
  v_exp_f32 v40, v40
  v_exp_f32 v41, v41
  s_waitcnt vmcnt(9)
  v_mfma_f32_32x32x16_bf16 v[80:95], v[124:127], v[128:131], v[80:95]
  v_exp_f32 v42, v42
  v_exp_f32 v43, v43
  v_exp_f32 v44, v44
  v_exp_f32 v45, v45
  s_waitcnt lgkmcnt(2)
  v_smfmac_f32_32x32x32_bf16 v[64:79], v[16:19], v[32:39], v24
  s_mov_b64 exec, s[48:49]
  ds_read_b128 v[16:19], v3 offset:55120
  s_mov_b64 exec, -1
  v_exp_f32 v46, v46
  v_exp_f32 v47, v47
  s_setprio 3
  v_exp_f32 v48, v48
  v_exp_f32 v49, v49
  s_waitcnt lgkmcnt(1)
  v_smfmac_f32_32x32x32_bf16 v[64:79], v[20:23], v[40:47], v24
  s_mov_b64 exec, s[48:49]
  ds_read_b128 v[20:23], v4 offset:55120
  s_mov_b64 exec, -1
  v_exp_f32 v50, v50
  v_exp_f32 v51, v51
  v_exp_f32 v52, v52
  v_exp_f32 v53, v53
  v_mfma_f32_32x32x16_bf16 v[32:47], v[12:15], v[8:11], 0
  ds_read_b128 v[12:15], v2 offset:56320
  v_exp_f32 v54, v54
  v_exp_f32 v55, v55
  v_exp_f32 v56, v56
  v_exp_f32 v57, v57
  v_mfma_f32_32x32x16_bf16 v[96:111], v[124:127], v[132:135], v[96:111]
  buffer_load_dwordx4 v[124:127], v2, s[8:11], s32 offen offset:1024 sc1
  buffer_load_dwordx4 v[128:131], v2, s[8:11], s33 offen offset:1024 sc1
  buffer_load_dwordx4 v[132:135], v2, s[8:11], s34 offen offset:1024 sc1
  v_exp_f32 v58, v58
  v_exp_f32 v59, v59
  v_exp_f32 v60, v60
  v_exp_f32 v61, v61
  s_waitcnt lgkmcnt(2)
  v_smfmac_f32_32x32x32_bf16 v[64:79], v[16:19], v[48:55], v24
  s_mov_b64 exec, s[48:49]
  ds_read_b128 v[16:19], v3 offset:56160
  s_mov_b64 exec, -1
  v_exp_f32 v62, v62
  v_exp_f32 v63, v63
  s_setprio 2
  v_exp_f32 v32, v32
  v_exp_f32 v33, v33
  s_waitcnt lgkmcnt(1)
  v_smfmac_f32_32x32x32_bf16 v[64:79], v[20:23], v[56:63], v24
  s_mov_b64 exec, s[48:49]
  ds_read_b128 v[20:23], v4 offset:56160
  s_mov_b64 exec, -1
  buffer_load_dwordx4 v[232:235], v2, s[8:11], s37 offen offset:0 sc1
  v_exp_f32 v34, v34
  v_exp_f32 v35, v35
  v_exp_f32 v36, v36
  v_exp_f32 v37, v37
  v_mfma_f32_32x32x16_bf16 v[48:63], v[12:15], v[8:11], 0
  ds_read_b128 v[12:15], v2 offset:57344
  v_exp_f32 v38, v38
  v_exp_f32 v39, v39
  v_exp_f32 v40, v40
  v_exp_f32 v41, v41
  s_waitcnt vmcnt(9)
  v_mfma_f32_32x32x16_bf16 v[80:95], v[136:139], v[140:143], v[80:95]
  v_exp_f32 v42, v42
  v_exp_f32 v43, v43
  v_exp_f32 v44, v44
  v_exp_f32 v45, v45
  s_waitcnt lgkmcnt(2)
  v_smfmac_f32_32x32x32_bf16 v[64:79], v[16:19], v[32:39], v24
  s_mov_b64 exec, s[48:49]
  ds_read_b128 v[16:19], v3 offset:57200
  s_mov_b64 exec, -1
  v_exp_f32 v46, v46
  v_exp_f32 v47, v47
  s_setprio 1
  v_exp_f32 v48, v48
  v_exp_f32 v49, v49
  s_waitcnt lgkmcnt(1)
  v_smfmac_f32_32x32x32_bf16 v[64:79], v[20:23], v[40:47], v24
  s_mov_b64 exec, s[48:49]
  ds_read_b128 v[20:23], v4 offset:57200
  s_mov_b64 exec, -1
  v_exp_f32 v50, v50
  v_exp_f32 v51, v51
  v_exp_f32 v52, v52
  v_exp_f32 v53, v53
  v_mfma_f32_32x32x16_bf16 v[32:47], v[12:15], v[8:11], 0
  ds_read_b128 v[12:15], v2 offset:58368
  v_exp_f32 v54, v54
  v_exp_f32 v55, v55
  v_exp_f32 v56, v56
  v_exp_f32 v57, v57
  v_mfma_f32_32x32x16_bf16 v[96:111], v[136:139], v[144:147], v[96:111]
  buffer_load_dwordx4 v[136:139], v2, s[8:11], s32 offen offset:2048 sc1
  buffer_load_dwordx4 v[140:143], v2, s[8:11], s33 offen offset:2048 sc1
  buffer_load_dwordx4 v[144:147], v2, s[8:11], s34 offen offset:2048 sc1
  v_exp_f32 v58, v58
  v_exp_f32 v59, v59
  v_exp_f32 v60, v60
  v_exp_f32 v61, v61
  s_waitcnt lgkmcnt(2)
  v_smfmac_f32_32x32x32_bf16 v[64:79], v[16:19], v[48:55], v24
  s_mov_b64 exec, s[48:49]
  ds_read_b128 v[16:19], v3 offset:58240
  s_mov_b64 exec, -1
  v_exp_f32 v62, v62
  v_exp_f32 v63, v63
  s_setprio 0
  v_exp_f32 v32, v32
  v_exp_f32 v33, v33
  s_waitcnt lgkmcnt(1)
  v_smfmac_f32_32x32x32_bf16 v[64:79], v[20:23], v[56:63], v24
  s_mov_b64 exec, s[48:49]
  ds_read_b128 v[20:23], v4 offset:58240
  s_mov_b64 exec, -1
  buffer_load_dwordx4 v[236:239], v2, s[8:11], s37 offen offset:1024 sc1
  v_exp_f32 v34, v34
  v_exp_f32 v35, v35
  v_exp_f32 v36, v36
  v_exp_f32 v37, v37
  v_mfma_f32_32x32x16_bf16 v[48:63], v[12:15], v[8:11], 0
  ds_read_b128 v[12:15], v2 offset:59392
  v_exp_f32 v38, v38
  v_exp_f32 v39, v39
  v_exp_f32 v40, v40
  v_exp_f32 v41, v41
  s_waitcnt vmcnt(9)
  v_mfma_f32_32x32x16_bf16 v[80:95], v[112:115], v[116:119], v[80:95]
  v_exp_f32 v42, v42
  v_exp_f32 v43, v43
  v_exp_f32 v44, v44
  v_exp_f32 v45, v45
  s_waitcnt lgkmcnt(2)
  v_smfmac_f32_32x32x32_bf16 v[64:79], v[16:19], v[32:39], v24
  s_mov_b64 exec, s[48:49]
  ds_read_b128 v[16:19], v3 offset:59280
  s_mov_b64 exec, -1
  v_exp_f32 v46, v46
  v_exp_f32 v47, v47
  s_setprio 3
  v_exp_f32 v48, v48
  v_exp_f32 v49, v49
  s_waitcnt lgkmcnt(1)
  v_smfmac_f32_32x32x32_bf16 v[64:79], v[20:23], v[40:47], v24
  s_mov_b64 exec, s[48:49]
  ds_read_b128 v[20:23], v4 offset:59280
  s_mov_b64 exec, -1
  v_exp_f32 v50, v50
  v_exp_f32 v51, v51
  v_exp_f32 v52, v52
  v_exp_f32 v53, v53
  v_mfma_f32_32x32x16_bf16 v[32:47], v[12:15], v[8:11], 0
  ds_read_b128 v[12:15], v2 offset:60416
  v_exp_f32 v54, v54
  v_exp_f32 v55, v55
  v_exp_f32 v56, v56
  v_exp_f32 v57, v57
  v_mfma_f32_32x32x16_bf16 v[96:111], v[112:115], v[120:123], v[96:111]
  buffer_load_dwordx4 v[112:115], v2, s[8:11], s32 offen offset:3072 sc1
  buffer_load_dwordx4 v[116:119], v2, s[8:11], s33 offen offset:3072 sc1
  buffer_load_dwordx4 v[120:123], v2, s[8:11], s34 offen offset:3072 sc1
  s_add_u32 s32, s32, 4096
  s_add_u32 s33, s33, 4096
  s_add_u32 s34, s34, 4096
  v_exp_f32 v58, v58
  v_exp_f32 v59, v59
  v_exp_f32 v60, v60
  v_exp_f32 v61, v61
  s_waitcnt lgkmcnt(2)
  v_smfmac_f32_32x32x32_bf16 v[64:79], v[16:19], v[48:55], v24
  s_mov_b64 exec, s[48:49]
  ds_read_b128 v[16:19], v3 offset:60320
  s_mov_b64 exec, -1
  v_exp_f32 v62, v62
  v_exp_f32 v63, v63
  s_setprio 2
  v_exp_f32 v32, v32
  v_exp_f32 v33, v33
  s_waitcnt lgkmcnt(1)
  v_smfmac_f32_32x32x32_bf16 v[64:79], v[20:23], v[56:63], v24
  s_mov_b64 exec, s[48:49]
  ds_read_b128 v[20:23], v4 offset:60320
  s_mov_b64 exec, -1
  buffer_load_dwordx4 v[240:243], v2, s[8:11], s37 offen offset:2048 sc1
  v_exp_f32 v34, v34
  v_exp_f32 v35, v35
  v_exp_f32 v36, v36
  v_exp_f32 v37, v37
  v_mfma_f32_32x32x16_bf16 v[48:63], v[12:15], v[8:11], 0
  ds_read_b128 v[12:15], v2 offset:61440
  v_exp_f32 v38, v38
  v_exp_f32 v39, v39
  v_exp_f32 v40, v40
  v_exp_f32 v41, v41
  s_waitcnt vmcnt(9)
  v_mfma_f32_32x32x16_bf16 v[80:95], v[124:127], v[128:131], v[80:95]
  v_exp_f32 v42, v42
  v_exp_f32 v43, v43
  v_exp_f32 v44, v44
  v_exp_f32 v45, v45
  s_waitcnt lgkmcnt(2)
  v_smfmac_f32_32x32x32_bf16 v[64:79], v[16:19], v[32:39], v24
  s_mov_b64 exec, s[48:49]
  ds_read_b128 v[16:19], v3 offset:61360
  s_mov_b64 exec, -1
  v_exp_f32 v46, v46
  v_exp_f32 v47, v47
  s_setprio 1
  v_exp_f32 v48, v48
  v_exp_f32 v49, v49
  s_waitcnt lgkmcnt(1)
  v_smfmac_f32_32x32x32_bf16 v[64:79], v[20:23], v[40:47], v24
  s_mov_b64 exec, s[48:49]
  ds_read_b128 v[20:23], v4 offset:61360
  s_mov_b64 exec, -1
  v_and_b32 v5, 31, v1
  v_lshlrev_b32 v5, 10, v5
  v_lshrrev_b32 v6, 5, v1
  v_lshl_add_u32 v25, v6, 3, v5
  buffer_load_dwordx2 v[248:249], v25, s[12:15], s38 offen offset:0
  buffer_load_dwordx2 v[250:251], v25, s[12:15], s38 offen offset:16
  v_exp_f32 v50, v50
  v_exp_f32 v51, v51
  v_exp_f32 v52, v52
  v_exp_f32 v53, v53
  v_mfma_f32_32x32x16_bf16 v[32:47], v[12:15], v[8:11], 0
  ds_read_b128 v[12:15], v2 offset:62464
  v_exp_f32 v54, v54
  v_exp_f32 v55, v55
  v_exp_f32 v56, v56
  v_exp_f32 v57, v57
  v_mfma_f32_32x32x16_bf16 v[96:111], v[124:127], v[132:135], v[96:111]
  v_exp_f32 v58, v58
  v_exp_f32 v59, v59
  v_exp_f32 v60, v60
  v_exp_f32 v61, v61
  s_waitcnt lgkmcnt(2)
  v_smfmac_f32_32x32x32_bf16 v[64:79], v[16:19], v[48:55], v24
  s_mov_b64 exec, s[48:49]
  ds_read_b128 v[16:19], v3 offset:62400
  s_mov_b64 exec, -1
  v_exp_f32 v62, v62
  v_exp_f32 v63, v63
  s_setprio 0
  v_exp_f32 v32, v32
  v_exp_f32 v33, v33
  s_waitcnt lgkmcnt(1)
  v_smfmac_f32_32x32x32_bf16 v[64:79], v[20:23], v[56:63], v24
  s_mov_b64 exec, s[48:49]
  ds_read_b128 v[20:23], v4 offset:62400
  s_mov_b64 exec, -1
  buffer_load_dwordx4 v[244:247], v2, s[8:11], s37 offen offset:3072 sc1
  s_add_u32 s37, s37, 4096
  v_exp_f32 v34, v34
  v_exp_f32 v35, v35
  v_exp_f32 v36, v36
  v_exp_f32 v37, v37
  v_mfma_f32_32x32x16_bf16 v[48:63], v[12:15], v[8:11], 0
  ds_read_b128 v[12:15], v2 offset:63488
  v_exp_f32 v38, v38
  v_exp_f32 v39, v39
  v_exp_f32 v40, v40
  v_exp_f32 v41, v41
  s_waitcnt vmcnt(8)
  v_mfma_f32_32x32x16_bf16 v[80:95], v[136:139], v[140:143], v[80:95]
  v_exp_f32 v42, v42
  v_exp_f32 v43, v43
  v_exp_f32 v44, v44
  v_exp_f32 v45, v45
  s_waitcnt lgkmcnt(2)
  v_smfmac_f32_32x32x32_bf16 v[64:79], v[16:19], v[32:39], v24
  s_mov_b64 exec, s[48:49]
  ds_read_b128 v[16:19], v3 offset:63440
  s_mov_b64 exec, -1
  v_exp_f32 v46, v46
  v_exp_f32 v47, v47
  s_setprio 3
  v_exp_f32 v48, v48
  v_exp_f32 v49, v49
  s_waitcnt lgkmcnt(1)
  v_smfmac_f32_32x32x32_bf16 v[64:79], v[20:23], v[40:47], v24
  s_mov_b64 exec, s[48:49]
  ds_read_b128 v[20:23], v4 offset:63440
  s_mov_b64 exec, -1
  v_exp_f32 v50, v50
  v_exp_f32 v51, v51
  v_exp_f32 v52, v52
  v_exp_f32 v53, v53
  v_mfma_f32_32x32x16_bf16 v[32:47], v[12:15], v[8:11], 0
  ds_read_b128 v[12:15], v2 offset:64512
  v_exp_f32 v54, v54
  v_exp_f32 v55, v55
  v_exp_f32 v56, v56
  v_exp_f32 v57, v57
  v_mfma_f32_32x32x16_bf16 v[96:111], v[136:139], v[144:147], v[96:111]
  v_exp_f32 v58, v58
  v_exp_f32 v59, v59
  v_exp_f32 v60, v60
  v_exp_f32 v61, v61
  s_waitcnt lgkmcnt(2)
  v_smfmac_f32_32x32x32_bf16 v[64:79], v[16:19], v[48:55], v24
  s_mov_b64 exec, s[48:49]
  ds_read_b128 v[16:19], v3 offset:64480
  s_mov_b64 exec, -1
  v_exp_f32 v62, v62
  v_exp_f32 v63, v63
  s_setprio 2
  v_exp_f32 v32, v32
  v_exp_f32 v33, v33
  s_waitcnt lgkmcnt(1)
  v_smfmac_f32_32x32x32_bf16 v[64:79], v[20:23], v[56:63], v24
  s_mov_b64 exec, s[48:49]
  ds_read_b128 v[20:23], v4 offset:64480
  s_mov_b64 exec, -1
  v_exp_f32 v34, v34
  v_exp_f32 v35, v35
  v_exp_f32 v36, v36
  v_exp_f32 v37, v37
  v_mfma_f32_32x32x16_bf16 v[48:63], v[12:15], v[8:11], 0
  v_exp_f32 v38, v38
  v_exp_f32 v39, v39
  v_exp_f32 v40, v40
  v_exp_f32 v41, v41
  s_waitcnt vmcnt(4)
  v_mfma_f32_32x32x16_bf16 v[80:95], v[112:115], v[116:119], v[80:95]
  v_exp_f32 v42, v42
  v_exp_f32 v43, v43
  v_exp_f32 v44, v44
  v_exp_f32 v45, v45
  s_waitcnt lgkmcnt(1)
  v_smfmac_f32_32x32x32_bf16 v[64:79], v[16:19], v[32:39], v24
  s_mov_b64 exec, s[48:49]
  ds_read_b128 v[16:19], v3 offset:65520
  s_mov_b64 exec, -1
  v_exp_f32 v46, v46
  v_exp_f32 v47, v47
  s_setprio 1
  v_exp_f32 v48, v48
  v_exp_f32 v49, v49
  s_waitcnt lgkmcnt(1)
  v_smfmac_f32_32x32x32_bf16 v[64:79], v[20:23], v[40:47], v24
  s_mov_b64 exec, s[48:49]
  ds_read_b128 v[20:23], v4 offset:65520
  s_mov_b64 exec, -1
  v_exp_f32 v50, v50
  v_exp_f32 v51, v51
  v_exp_f32 v52, v52
  v_exp_f32 v53, v53
  v_exp_f32 v54, v54
  v_exp_f32 v55, v55
  v_exp_f32 v56, v56
  v_exp_f32 v57, v57
  v_mfma_f32_32x32x16_bf16 v[96:111], v[112:115], v[120:123], v[96:111]
  v_exp_f32 v58, v58
  v_exp_f32 v59, v59
  v_exp_f32 v60, v60
  v_exp_f32 v61, v61
  s_waitcnt lgkmcnt(1)
  v_smfmac_f32_32x32x32_bf16 v[64:79], v[16:19], v[48:55], v24
  v_exp_f32 v62, v62
  v_exp_f32 v63, v63
  s_setprio 0
  s_waitcnt lgkmcnt(0)
  v_smfmac_f32_32x32x32_bf16 v[64:79], v[20:23], v[56:63], v24
  s_nop 11
  v_mov_b32 v152, v72
  v_mov_b32 v153, v72
  s_nop 1
  v_permlane32_swap_b32 v152, v153
  v_add_f32 v153, |v64|, |v65|
  v_add_f32 v153, |v66|, v153
  v_add_f32 v153, |v67|, v153
  v_add_f32 v153, |v68|, v153
  v_add_f32 v153, |v69|, v153
  v_add_f32 v153, |v70|, v153
  v_add_f32 v153, |v71|, v153
  s_mov_b32 s44, 0x17800000
  s_mov_b32 s45, 0x71800000
  s_mov_b32 s46, 0x7f61b1e6
  v_cmp_le_f32 s[40:41], s44, v152
  v_cmp_ge_f32 s[42:43], s45, v152
  s_nop 3
  s_and_b64 s[40:41], s[40:41], s[42:43]
  v_cmp_ge_f32 s[42:43], s46, v153
  s_nop 3
  s_and_b64 s[40:41], s[40:41], s[42:43]
  s_cmp_eq_u64 s[40:41], -1
  s_cbranch_scc0 L_k2_slow
L_k2_fin:
  s_nop 3
  v_mov_b32 v152, v72
  v_mov_b32 v153, v72
  s_nop 1
  v_permlane32_swap_b32 v152, v153
  v_rcp_f32 v153, v152
  s_nop 0
  v_mul_f32 v64, v64, v153
  v_mul_f32 v65, v65, v153
  v_mul_f32 v66, v66, v153
  v_mul_f32 v67, v67, v153
  v_mul_f32 v68, v68, v153
  v_mul_f32 v69, v69, v153
  v_mul_f32 v70, v70, v153
  v_mul_f32 v71, v71, v153
  v_cvt_pk_bf16_f32 v156, v64, v65
  v_cvt_pk_bf16_f32 v157, v66, v67
  v_cvt_pk_bf16_f32 v158, v68, v69
  v_cvt_pk_bf16_f32 v159, v70, v71
  buffer_store_dwordx4 v[156:159], v2, s[8:11], s36 offen sc1
  s_lshl_b32 s47, s30, 5
  s_add_u32 s47, s47, s29
  s_lshl_b32 s47, s47, 7
  s_add_u32 s47, s47, 21233664
  v_mov_b32 v152, 1
  v_and_b32 v153, 31, v1
  v_lshlrev_b32 v153, 2, v153
  s_waitcnt vmcnt(0) lgkmcnt(0)
  buffer_store_dword v152, v153, s[8:11], s47 offen sc1
  s_barrier
  ds_write_b128 v150, v[80:83] offset:0
  ds_write_b128 v150, v[84:87] offset:1024
  ds_write_b128 v150, v[88:91] offset:2048
  ds_write_b128 v150, v[92:95] offset:3072
  ds_write_b128 v150, v[96:99] offset:4096
  ds_write_b128 v150, v[100:103] offset:5120
  ds_write_b128 v150, v[104:107] offset:6144
  ds_write_b128 v150, v[108:111] offset:7168
  v_and_b32 v153, 3, v1
  v_bfe_u32 v154, v1, 2, 1
  v_lshl_add_u32 v153, v154, 5, v153
  v_lshlrev_b32 v153, 7, v153
  s_sub_u32 s42, s39, 16777216
  s_lshr_b32 s42, s42, 3
  s_lshl_b32 s43, s28, 9
  s_add_u32 s42, s42, s43
  s_add_u32 s42, s42, 21233664
  v_mov_b32 v154, 1
  s_waitcnt lgkmcnt(0)
  s_barrier
  buffer_load_dword v152, v153, s[8:11], s42 offen sc1
  ds_read_b128 v[80:83], v148 offset:0
  ds_read_b128 v[84:87], v148 offset:1024
  ds_read_b128 v[88:91], v148 offset:16384
  ds_read_b128 v[92:95], v148 offset:17408
  ds_read_b128 v[96:99], v148 offset:32768
  ds_read_b128 v[100:103], v148 offset:33792
  ds_read_b128 v[104:107], v148 offset:49152
  ds_read_b128 v[108:111], v148 offset:50176
  s_waitcnt lgkmcnt(0)
  v_add_f32 v80, v80, v88
  v_add_f32 v81, v81, v89
  v_add_f32 v82, v82, v90
  v_add_f32 v83, v83, v91
  v_add_f32 v84, v84, v92
  v_add_f32 v85, v85, v93
  v_add_f32 v86, v86, v94
  v_add_f32 v87, v87, v95
  v_add_f32 v96, v96, v104
  v_add_f32 v97, v97, v105
  v_add_f32 v98, v98, v106
  v_add_f32 v99, v99, v107
  v_add_f32 v100, v100, v108
  v_add_f32 v101, v101, v109
  v_add_f32 v102, v102, v110
  v_add_f32 v103, v103, v111
  v_add_f32 v80, v80, v96
  v_add_f32 v81, v81, v97
  v_add_f32 v82, v82, v98
  v_add_f32 v83, v83, v99
  v_add_f32 v84, v84, v100
  v_add_f32 v85, v85, v101
  v_add_f32 v86, v86, v102
  v_add_f32 v87, v87, v103
  v_mul_f32 v88, 0xbfb8aa3b, v80
  v_mul_f32 v89, 0xbfb8aa3b, v81
  v_mul_f32 v90, 0xbfb8aa3b, v82
  v_mul_f32 v91, 0xbfb8aa3b, v83
  v_mul_f32 v92, 0xbfb8aa3b, v84
  v_mul_f32 v93, 0xbfb8aa3b, v85
  v_mul_f32 v94, 0xbfb8aa3b, v86
  v_mul_f32 v95, 0xbfb8aa3b, v87
  v_exp_f32 v88, v88
  v_exp_f32 v89, v89
  v_exp_f32 v90, v90
  v_exp_f32 v91, v91
  v_exp_f32 v92, v92
  v_exp_f32 v93, v93
  v_exp_f32 v94, v94
  v_exp_f32 v95, v95
  v_add_f32 v88, 1.0, v88
  v_add_f32 v89, 1.0, v89
  v_add_f32 v90, 1.0, v90
  v_add_f32 v91, 1.0, v91
  v_add_f32 v92, 1.0, v92
  v_add_f32 v93, 1.0, v93
  v_add_f32 v94, 1.0, v94
  v_add_f32 v95, 1.0, v95
  v_rcp_f32 v88, v88
  v_rcp_f32 v89, v89
  v_rcp_f32 v90, v90
  v_rcp_f32 v91, v91
  v_rcp_f32 v92, v92
  v_rcp_f32 v93, v93
  v_rcp_f32 v94, v94
  v_rcp_f32 v95, v95
  v_mul_f32 v80, v80, v88
  v_mul_f32 v81, v81, v89
  v_mul_f32 v82, v82, v90
  v_mul_f32 v83, v83, v91
  v_mul_f32 v84, v84, v92
  v_mul_f32 v85, v85, v93
  v_mul_f32 v86, v86, v94
  v_mul_f32 v87, v87, v95
  v_lshlrev_b32 v96, 16, v248
  v_and_b32 v97, 0xffff0000, v248
  v_lshlrev_b32 v98, 16, v249
  v_and_b32 v99, 0xffff0000, v249
  v_lshlrev_b32 v100, 16, v250
  v_and_b32 v101, 0xffff0000, v250
  v_lshlrev_b32 v102, 16, v251
  v_and_b32 v103, 0xffff0000, v251
  s_waitcnt vmcnt(0)
  v_cmp_eq_u32 vcc, v152, v154
  s_nop 3
  s_cmp_eq_u64 vcc, exec
  s_cbranch_scc1 L_k2_rdy
  s_mov_b32 s46, 0
L_k2_spin:
  buffer_load_dword v152, v153, s[8:11], s42 offen sc1
  s_waitcnt vmcnt(0)
  v_cmp_eq_u32 vcc, v152, v154
  s_nop 3
  s_cmp_eq_u64 vcc, exec
  s_cbranch_scc1 L_k2_rdy
  s_sleep 2
  s_add_u32 s46, s46, 1
  s_cmp_lt_u32 s46, 262144
  s_cbranch_scc1 L_k2_spin
L_k2_rdy:
  s_lshl_b32 s42, s28, 12
  s_add_u32 s43, s42, s39
  s_add_u32 m0, s42, 0
  s_add_u32 s44, s43, 0
  buffer_load_dwordx4 v2, s[8:11], s44 offen offset:0 sc1 lds
  buffer_load_dwordx4 v2, s[8:11], s44 offen offset:1024 sc1 lds
  buffer_load_dwordx4 v2, s[8:11], s44 offen offset:2048 sc1 lds
  buffer_load_dwordx4 v2, s[8:11], s44 offen offset:3072 sc1 lds
  s_add_u32 m0, s42, 32768
  s_add_u32 s44, s43, 32768
  buffer_load_dwordx4 v2, s[8:11], s44 offen offset:0 sc1 lds
  buffer_load_dwordx4 v2, s[8:11], s44 offen offset:1024 sc1 lds
  buffer_load_dwordx4 v2, s[8:11], s44 offen offset:2048 sc1 lds
  buffer_load_dwordx4 v2, s[8:11], s44 offen offset:3072 sc1 lds
  s_lshr_b32 s42, s28, 2
  s_lshl_b32 s42, s42, 15
  s_bfe_u32 s43, s28, 0x10001
  s_lshl_b32 s44, s43, 14
  s_add_u32 s42, s42, s44
  v_add_u32 v152, s42, v2
  s_lshl_b32 s42, s28, 11
  s_add_u32 s42, s42, 65536
  v_add_u32 v153, s42, v2
  s_xor_b32 s42, s28, 2
  s_lshl_b32 s42, s42, 11
  s_add_u32 s42, s42, 65536
  v_add_u32 v154, s42, v2
  s_waitcnt vmcnt(0)
  s_barrier
  ds_read_b128 v[32:35], v152 offset:0
  ds_read_b128 v[36:39], v152 offset:1024
  ds_read_b128 v[40:43], v152 offset:2048
  ds_read_b128 v[44:47], v152 offset:3072
  ds_read_b128 v[48:51], v152 offset:4096
  ds_read_b128 v[52:55], v152 offset:5120
  ds_read_b128 v[56:59], v152 offset:6144
  ds_read_b128 v[60:63], v152 offset:7168
  s_waitcnt lgkmcnt(7)
  v_mfma_f32_32x32x16_bf16 v[64:79], v[184:187], v[32:35], 0
  ds_read_b128 v[32:35], v152 offset:8192
  s_waitcnt lgkmcnt(7)
  v_mfma_f32_32x32x16_bf16 v[64:79], v[188:191], v[36:39], v[64:79]
  ds_read_b128 v[36:39], v152 offset:9216
  s_waitcnt lgkmcnt(7)
  v_mfma_f32_32x32x16_bf16 v[64:79], v[192:195], v[40:43], v[64:79]
  ds_read_b128 v[40:43], v152 offset:10240
  s_waitcnt lgkmcnt(7)
  v_mfma_f32_32x32x16_bf16 v[64:79], v[196:199], v[44:47], v[64:79]
  ds_read_b128 v[44:47], v152 offset:11264
  s_waitcnt lgkmcnt(7)
  v_mfma_f32_32x32x16_bf16 v[64:79], v[200:203], v[48:51], v[64:79]
  ds_read_b128 v[48:51], v152 offset:12288
  s_waitcnt lgkmcnt(7)
  v_mfma_f32_32x32x16_bf16 v[64:79], v[204:207], v[52:55], v[64:79]
  ds_read_b128 v[52:55], v152 offset:13312
  s_waitcnt lgkmcnt(7)
  v_mfma_f32_32x32x16_bf16 v[64:79], v[208:211], v[56:59], v[64:79]
  ds_read_b128 v[56:59], v152 offset:14336
  s_waitcnt lgkmcnt(7)
  v_mfma_f32_32x32x16_bf16 v[64:79], v[212:215], v[60:63], v[64:79]
  ds_read_b128 v[60:63], v152 offset:15360
  s_waitcnt lgkmcnt(7)
  v_mfma_f32_32x32x16_bf16 v[64:79], v[216:219], v[32:35], v[64:79]
  s_waitcnt lgkmcnt(6)
  v_mfma_f32_32x32x16_bf16 v[64:79], v[220:223], v[36:39], v[64:79]
  s_waitcnt lgkmcnt(5)
  v_mfma_f32_32x32x16_bf16 v[64:79], v[224:227], v[40:43], v[64:79]
  s_waitcnt lgkmcnt(4)
  v_mfma_f32_32x32x16_bf16 v[64:79], v[228:231], v[44:47], v[64:79]
  s_waitcnt lgkmcnt(3)
  v_mfma_f32_32x32x16_bf16 v[64:79], v[232:235], v[48:51], v[64:79]
  s_waitcnt lgkmcnt(2)
  v_mfma_f32_32x32x16_bf16 v[64:79], v[236:239], v[52:55], v[64:79]
  s_waitcnt lgkmcnt(1)
  v_mfma_f32_32x32x16_bf16 v[64:79], v[240:243], v[56:59], v[64:79]
  s_waitcnt lgkmcnt(0)
  v_mfma_f32_32x32x16_bf16 v[64:79], v[244:247], v[60:63], v[64:79]
  s_bfe_u32 s43, s28, 0x10001
  s_cmp_eq_u32 s43, 0
  s_cbranch_scc0 L_k2_kh1
  s_nop 15
  ds_write_b128 v153, v[72:75]
  ds_write_b128 v153, v[76:79] offset:1024
  s_branch L_k2_khj
L_k2_kh1:
  s_nop 15
  ds_write_b128 v153, v[64:67]
  ds_write_b128 v153, v[68:71] offset:1024
  s_waitcnt lgkmcnt(0)
  v_mov_b32 v64, v72
  v_mov_b32 v65, v73
  v_mov_b32 v66, v74
  v_mov_b32 v67, v75
  v_mov_b32 v68, v76
  v_mov_b32 v69, v77
  v_mov_b32 v70, v78
  v_mov_b32 v71, v79
L_k2_khj:
  s_waitcnt lgkmcnt(0)
  s_barrier
  ds_read_b128 v[32:35], v154
  ds_read_b128 v[36:39], v154 offset:1024
  s_waitcnt lgkmcnt(0)
  s_nop 3
  v_add_f32 v64, v64, v32
  v_add_f32 v65, v65, v33
  v_add_f32 v66, v66, v34
  v_add_f32 v67, v67, v35
  v_add_f32 v68, v68, v36
  v_add_f32 v69, v69, v37
  v_add_f32 v70, v70, v38
  v_add_f32 v71, v71, v39
  v_fma_f32 v64, v64, v80, v96
  v_fma_f32 v65, v65, v81, v97
  v_fma_f32 v66, v66, v82, v98
  v_fma_f32 v67, v67, v83, v99
  v_fma_f32 v68, v68, v84, v100
  v_fma_f32 v69, v69, v85, v101
  v_fma_f32 v70, v70, v86, v102
  v_fma_f32 v71, v71, v87, v103
  v_cvt_pk_bf16_f32 v40, v64, v65
  v_cvt_pk_bf16_f32 v41, v66, v67
  v_cvt_pk_bf16_f32 v42, v68, v69
  v_cvt_pk_bf16_f32 v43, v70, v71
  buffer_store_dwordx2 v[40:41], v25, s[16:19], s38 offen offset:0
  buffer_store_dwordx2 v[42:43], v25, s[16:19], s38 offen offset:16
  s_endpgm
L_k2_slow:
  s_waitcnt vmcnt(0) lgkmcnt(0)
  v_mov_b32 v160, 0xff800000
  s_add_u32 s40, s31, 2097152
  s_mov_b32 s41, 0
L_k2_p1:
  buffer_load_dwordx4 v[12:15], v2, s[8:11], s40 offen
  s_waitcnt vmcnt(0)
  v_mfma_f32_32x32x16_bf16 v[32:47], v[12:15], v[8:11], 0
  s_nop 15
  v_max_f32 v160, v160, v32
  v_max_f32 v160, v160, v33
  v_max_f32 v160, v160, v34
  v_max_f32 v160, v160, v35
  v_max_f32 v160, v160, v36
  v_max_f32 v160, v160, v37
  v_max_f32 v160, v160, v38
  v_max_f32 v160, v160, v39
  v_max_f32 v160, v160, v40
  v_max_f32 v160, v160, v41
  v_max_f32 v160, v160, v42
  v_max_f32 v160, v160, v43
  v_max_f32 v160, v160, v44
  v_max_f32 v160, v160, v45
  v_max_f32 v160, v160, v46
  v_max_f32 v160, v160, v47
  s_add_u32 s40, s40, 1024
  s_add_u32 s41, s41, 1
  s_cmp_lt_u32 s41, 64
  s_cbranch_scc1 L_k2_p1
  v_mov_b32 v161, v160
  s_nop 1
  v_permlane32_swap_b32 v160, v161
  v_max_f32 v160, v160, v161
  v_sub_f32 v168, 0, v160
  v_sub_f32 v169, 0, v160
  v_sub_f32 v170, 0, v160
  v_sub_f32 v171, 0, v160
  v_sub_f32 v172, 0, v160
  v_sub_f32 v173, 0, v160
  v_sub_f32 v174, 0, v160
  v_sub_f32 v175, 0, v160
  v_sub_f32 v176, 0, v160
  v_sub_f32 v177, 0, v160
  v_sub_f32 v178, 0, v160
  v_sub_f32 v179, 0, v160
  v_sub_f32 v180, 0, v160
  v_sub_f32 v181, 0, v160
  v_sub_f32 v182, 0, v160
  v_sub_f32 v183, 0, v160
  v_mov_b32 v64, 0
  v_mov_b32 v65, 0
  v_mov_b32 v66, 0
  v_mov_b32 v67, 0
  v_mov_b32 v68, 0
  v_mov_b32 v69, 0
  v_mov_b32 v70, 0
  v_mov_b32 v71, 0
  v_mov_b32 v72, 0
  v_mov_b32 v73, 0
  v_mov_b32 v74, 0
  v_mov_b32 v75, 0
  v_mov_b32 v76, 0
  v_mov_b32 v77, 0
  v_mov_b32 v78, 0
  v_mov_b32 v79, 0
  v_and_b32 v5, 31, v1
  v_lshrrev_b32 v6, 5, v1
  v_lshlrev_b32 v7, 8, v6
  v_and_b32 v152, 15, v5
  v_lshl_add_u32 v152, v152, 4, v7
  v_mov_b32 v153, 0x3f803f80
  v_cmp_gt_u32 s[46:47], 16, v5
  s_add_u32 s40, s31, 2097152
  s_add_u32 s42, s31, 4194304
  s_mov_b32 s41, 0
L_k2_p2:
  buffer_load_dwordx4 v[12:15], v2, s[8:11], s40 offen
  buffer_load_dwordx4 v[16:19], v152, s[8:11], s42 offen
  buffer_load_dwordx4 v[20:23], v152, s[8:11], s42 offen offset:512
  s_waitcnt vmcnt(0)
  v_mfma_f32_32x32x16_bf16 v[32:47], v[12:15], v[8:11], v[168:183]
  v_cndmask_b32 v16, v153, v16, s[46:47]
  v_cndmask_b32 v17, v153, v17, s[46:47]
  v_cndmask_b32 v18, v153, v18, s[46:47]
  v_cndmask_b32 v19, v153, v19, s[46:47]
  v_cndmask_b32 v20, v153, v20, s[46:47]
  v_cndmask_b32 v21, v153, v21, s[46:47]
  v_cndmask_b32 v22, v153, v22, s[46:47]
  v_cndmask_b32 v23, v153, v23, s[46:47]
  s_nop 15
  v_exp_f32 v32, v32
  v_exp_f32 v33, v33
  v_exp_f32 v34, v34
  v_exp_f32 v35, v35
  v_exp_f32 v36, v36
  v_exp_f32 v37, v37
  v_exp_f32 v38, v38
  v_exp_f32 v39, v39
  v_exp_f32 v40, v40
  v_exp_f32 v41, v41
  v_exp_f32 v42, v42
  v_exp_f32 v43, v43
  v_exp_f32 v44, v44
  v_exp_f32 v45, v45
  v_exp_f32 v46, v46
  v_exp_f32 v47, v47
  s_nop 1
  v_smfmac_f32_32x32x32_bf16 v[64:79], v[16:19], v[32:39], v24
  v_smfmac_f32_32x32x32_bf16 v[64:79], v[20:23], v[40:47], v24
  s_add_u32 s40, s40, 1024
  s_add_u32 s42, s42, 1024
  s_add_u32 s41, s41, 1
  s_cmp_lt_u32 s41, 64
  s_nop 15
  s_cbranch_scc1 L_k2_p2
  s_nop 15
  s_branch L_k2_fin
L_k1_end:
  s_endpgm
.section .rodata,"a"
.p2align 6
.amdhsa_kernel recurrent_scan__mha_block__swiglu_ffn__prompt_kernel
  .amdhsa_next_free_vgpr 256
  .amdhsa_next_free_sgpr 76
  .amdhsa_accum_offset 256
  .amdhsa_group_segment_fixed_size 0
  .amdhsa_kernarg_size 80
  .amdhsa_user_sgpr_count 2
  .amdhsa_user_sgpr_kernarg_segment_ptr 1
  .amdhsa_system_sgpr_workgroup_id_x 1
  .amdhsa_float_denorm_mode_32 3
  .amdhsa_ieee_mode 0
  .amdhsa_dx10_clamp 0
.end_amdhsa_kernel
```
